```python
import torch

def _softmax(x, axis=-1):
    return torch.softmax(x, dim=axis)

def _gelu(x):
    return torch.nn.functional.gelu(x, approximate='tanh')

def _silu(x):
    return torch.nn.functional.silu(x)

def _sigmoid(x):
    return torch.sigmoid(x)

def _layernorm(x, axis=-1, eps=1e-05):
    m = x.mean(dim=axis, keepdim=True)
    v = x.var(dim=axis, keepdim=True, unbiased=False)
    return (x - m) / torch.sqrt(v + eps)

def _scatter_add(tgt, idx, src, axis=0):
    return tgt.clone().index_add_(axis, idx, src)

def _segment_sum(src, seg, n):
    out = torch.zeros((n,) + src.shape[1:], dtype=src.dtype)
    return out.index_add_(0, seg, src)

def _pad(x, pw):
    flat = tuple((v for pair in reversed(pw) for v in pair))
    return torch.nn.functional.pad(x, flat)
kernel_name = 'adaLN_cond__grouped_kv_mqa__dense_activation_silu__prompt'

def setup_inputs():

    _w = lambda a: (lambda t: t.to(torch.bfloat16) if t.is_floating_point() else t)(torch.as_tensor(a))

    def _A_setup():
        B, S, D, H = (1, 2048, 512, 32)
        Dh = D // H
        return {'x': _w((lambda *s: torch.randn(*s, dtype=torch.bfloat16) * 0.05)(B, S, D)), 'wq': _w((lambda *s: torch.randn(*s, dtype=torch.bfloat16) * 0.05)(D, H * Dh)), 'wk': _w((lambda *s: torch.randn(*s, dtype=torch.bfloat16) * 0.05)(D, Dh)), 'wv': _w((lambda *s: torch.randn(*s, dtype=torch.bfloat16) * 0.05)(D, Dh)), 'wo': _w((lambda *s: torch.randn(*s, dtype=torch.bfloat16) * 0.05)(H * Dh, D))}
    _A_in = _A_setup()

    def _B_setup():
        B, S, D, F = (1, 2048, 512, 1792)
        return {'x': _w((lambda *s: torch.randn(*s, dtype=torch.bfloat16) * 0.05)(B, S, D)), 'w1': _w((lambda *s: torch.randn(*s, dtype=torch.bfloat16) * 6.4)(D, F) * D ** (-0.5)), 'w2': _w((lambda *s: torch.randn(*s, dtype=torch.bfloat16) * 0.2)(F, D) * F ** (-0.5))}
    _B_in = _B_setup()
    return {'A_x': _A_in['x'], 'A_wq': _A_in['wq'], 'A_wk': _A_in['wk'], 'A_wv': _A_in['wv'], 'A_wo': _A_in['wo'], 'B_x': _B_in['x'], 'B_w1': _B_in['w1'], 'B_w2': _B_in['w2'], 'c': _w((lambda *s: torch.randn(*s, dtype=torch.bfloat16) * 0.1)(1, 512) * 8.0), 'w_mod': _w((lambda *s: torch.randn(*s, dtype=torch.bfloat16) * 0.1)(512, 6 * 512) * 512 ** (-0.5) * 8.0)}

def reference(A_x, A_wq, A_wk, A_wv, A_wo, B_x, B_w1, B_w2, c, w_mod):

    def _A_ref(x, wq, wk, wv, wo):
        B, S, D = x.shape
        H = 32
        Dh = D // H
        q = (lambda x, *d: x.permute(*d))((x @ wq).reshape(B, S, H, Dh), 0, 2, 1, 3)
        k = x @ wk
        v = x @ wv
        scores = torch.einsum('bhqd,bkd->bhqk', q, k) * Dh ** (-0.5)
        p = _softmax(scores, axis=-1)
        o = torch.einsum('bhqk,bkd->bhqd', p, v)
        return (lambda x, *d: x.permute(*d))(o, 0, 2, 1, 3).reshape(B, S, H * Dh) @ wo

    def _B_ref(x, w1, w2):
        h = torch.einsum('bsd,df->bsf', x, w1)
        h = _silu(h)
        out = torch.einsum('bsf,fd->bsd', h, w2)
        return out
    x = A_x
    mod = (_silu(c) @ w_mod).reshape(c.shape[0], 6, 1, -1)
    sa, ca, ga, sb, cb, gb = (mod[:, 0].clone(), mod[:, 1].clone(), mod[:, 2].clone(), mod[:, 3].clone(), mod[:, 4].clone(), mod[:, 5].clone())
    h = _layernorm(x, axis=-1) * (1 + ca) + sa
    x = x + ga * _A_ref(h, A_wq, A_wk, A_wv, A_wo)
    h = _layernorm(x, axis=-1) * (1 + cb) + sb
    x = x + gb * _B_ref(h, B_w1, B_w2)
    return x
```

```asm
; @launch kernel=fused_kernel grid=(256,1,1) block=(512,1,1) lds=163840
.amdgcn_target "amdgcn-amd-amdhsa--gfx950"
.text
.globl fused_kernel
.p2align 8
.type fused_kernel,@function
fused_kernel:
    s_cmp_ge_u32 s2, 256
    s_cbranch_scc1 .end_fused_kernel_1
    s_load_dwordx2 s[96:97], s[0:1], 72
    s_load_dwordx2 s[16:17], s[0:1], 64
    s_load_dwordx2 s[8:9], s[0:1], 96
    s_load_dwordx2 s[12:13], s[0:1], 0
    s_load_dwordx2 s[92:93], s[0:1], 88
    s_load_dwordx2 s[20:21], s[0:1], 8
    s_load_dwordx2 s[32:33], s[0:1], 32
    s_load_dwordx4 s[56:59], s[0:1], 16
    s_getpc_b64 s[44:45]
.pc_fused_kernel_11:
    s_mov_b32 s46, code_end_label-.pc_fused_kernel_11
    s_mov_b32 s47, 0x20000
    s_lshr_b32 s39, s2, 3
    s_lshl_b32 s36, s39, 11
    v_lshlrev_b32 v10, 2, v0
    s_cbranch_scc0 .pc_fused_kernel_11s
    buffer_load_dword a143, v10, s[44:47], s36 offen
.pc_fused_kernel_11s:
    v_lshrrev_b32 v1, 6, v0
    v_and_b32 v0, 63, v0
    v_readfirstlane_b32 s3, v1
    v_lshlrev_b32 v1, 4, v0
    v_lshlrev_b32 v2, 2, v0
    v_lshrrev_b32 v12, 1, v0
    v_mul_u32_u24 v12, 6144, v12
    v_and_b32 v13, 16, v1
    v_add_u32 v12, v12, v13
    v_and_b32 v3, 28, v2
    v_lshrrev_b32 v13, 5, v0
    v_and_b32 v7, 496, v1
    v_lshl_add_u32 v7, v13, 12, v7
    v_mov_b32 v80, 0
    v_mov_b32 v81, 0
    v_mov_b32 v82, 0
    v_mov_b32 v83, 0
    v_mov_b32 v107, 1
    s_mov_b32 s98, 3145728
    s_mov_b32 s99, 0x20000
    s_mov_b32 s18, 1024
    s_mov_b32 s19, 0x20000
    s_mov_b32 s14, 2097152
    s_mov_b32 s15, 0x20000
    s_mov_b32 s22, 524288
    s_mov_b32 s23, 0x20000
    s_mov_b32 s10, 33554432
    s_mov_b32 s11, 0x20000
    s_mov_b32 s34, 524288
    s_mov_b32 s35, 0x20000
    s_mov_b32 s94, 256
    s_mov_b32 s95, 0x20000
    s_mov_b32 s26, 16384
    s_mov_b32 s27, 0x20000
    s_and_b32 s38, s2, 7
    s_and_b32 s60, s39, 7
    s_lshr_b32 s5, s39, 3
    s_lshl_b32 s36, s38, 3
    s_add_u32 s36, s36, s60
    s_mul_i32 s37, s5, 786432
    s_lshl_b32 s6, s36, 5
    s_add_u32 s37, s37, s6
    s_lshl_b32 s6, s5, 8
    s_lshl_b32 s61, s38, 2
    s_add_u32 s61, s61, s5
    s_lshl_b32 s44, s61, 16
    s_lshl_b32 s45, s3, 11
    s_add_u32 s44, s44, s45
    s_lshl_b32 s47, s60, 13
    s_and_b32 s47, s47, 0xc000
    s_add_u32 s46, s44, s47
    s_mul_i32 s4, s38, 1474560
    s_add_u32 s4, s4, 16777216
    s_mov_b32 m0, 73728
    s_lshl_b32 s36, s36, 6
    s_xor_b32 s36, s36, 2048
    s_lshl_b32 s42, s5, 12
    s_add_u32 s36, s36, s42
    s_add_u32 s36, s36, 5373952
    s_lshl_b32 s100, s3, 9
    s_add_u32 s100, s100, 5373952
    s_add_u32 s101, s100, 8192
    s_mul_i32 s48, s38, 3072
    s_add_u32 s48, s48, 5390336
    s_lshl_b32 s28, s39, 3
    s_add_u32 s28, s28, s3
    s_cmp_lg_u32 s3, 0
    s_waitcnt lgkmcnt(0)
    s_cbranch_scc1 .ng_fused_kernel_12
    buffer_load_dword v84, v2, s[16:19], s6 offen
    buffer_load_dwordx4 v12, s[96:99], s37 offen offset:0 lds
    s_add_u32 s37, s37, 195584
    buffer_load_dwordx4 v12, s[96:99], s37 offen offset:1024 lds
    s_add_u32 s37, s37, 195584
    buffer_load_dwordx4 v12, s[96:99], s37 offen offset:2048 lds
    s_add_u32 s37, s37, 195584
    buffer_load_dwordx4 v12, s[96:99], s37 offen offset:3072 lds
    buffer_load_dword v85, v2, s[8:11], s36 offen sc1
.ng_fused_kernel_12:
    buffer_load_dwordx4 v[32:35], v7, s[8:11], s100 offen sc1
    buffer_load_dwordx4 v[40:43], v7, s[8:11], s101 offen sc1
    s_barrier
    buffer_load_dwordx4 v[20:23], v1, s[12:15], s46 offen offset:0
    buffer_load_dwordx4 v[28:31], v1, s[12:15], s46 offen offset:1024
    s_cmp_lg_u32 s28, 1
    s_cbranch_scc1 .nz_fused_kernel_13
    buffer_store_dwordx4 v[80:83], v1, s[8:11], s48 offen offset:0 sc1
    buffer_store_dwordx4 v[80:83], v1, s[8:11], s48 offen offset:1024 sc1
    buffer_store_dwordx4 v[80:83], v1, s[8:11], s48 offen offset:2048 sc1
.nz_fused_kernel_13:
    v_bfe_u32 v6, v0, 4, 1
    v_lshlrev_b32 v6, 1, v6
    v_xor_b32 v6, v6, v0
    v_and_b32 v6, 7, v6
    v_lshrrev_b32 v5, 3, v0
    v_lshlrev_b32 v5, 10, v5
    v_lshl_add_u32 v5, v6, 4, v5
    s_lshl_b32 s6, s3, 16
    s_lshl_b32 s40, s60, 7
    s_add_u32 s6, s6, s40
    v_add_u32 v5, s6, v5
    v_xor_b32 v6, 64, v5
    v_add_u32 v6, 7168, v6
    s_lshl_b32 s5, s5, 14
    s_lshl_b32 s6, s3, 13
    s_add_u32 s6, s6, 98304
    s_bitcmp1_b32 s39, 0
    s_cselect_b32 s24, s58, s56
    s_cselect_b32 s25, s59, s57
    s_cmp_lg_u32 s3, 5
    s_cbranch_scc1 .skip_fused_kernel_14
    v_lshrrev_b32 v94, 2, v0
    v_lshlrev_b32 v94, 10, v94
    v_and_b32 v95, 3, v0
    v_lshl_add_u32 v94, v95, 4, v94
    v_add_u32 v95, 15360, v94
    s_lshl_b32 s40, s38, 16
    s_lshr_b32 s41, s39, 4
    s_lshl_b32 s41, s41, 15
    s_add_u32 s40, s40, s41
    s_and_b32 s41, s39, 15
    s_lshl_b32 s41, s41, 6
    s_add_u32 s40, s40, s41
    s_mov_b32 m0, 69632
    s_lshl_b32 s41, s39, 8
    buffer_load_dwordx4 v94, s[32:35], s40 offen lds
    buffer_load_dwordx4 v95, s[32:35], s40 offen offset:1024 lds
.skip_fused_kernel_14:
    s_cmp_lg_u32 s3, 6
    s_cbranch_scc1 .skip_fused_kernel_15
    v_lshlrev_b32 v14, 7, v0
    s_lshr_b32 s40, s39, 1
    s_lshl_b32 s40, s40, 10
    s_mov_b64 exec, 0xff
    buffer_load_dword a142, v14, s[24:27], s40 offen
    s_mov_b64 exec, -1
    s_lshl_b32 s40, s61, 16
    s_add_u32 s40, s40, 2097152
    buffer_load_dword a140, off, s[8:11], s40 sc1
    buffer_load_dword a141, off, s[92:95], 0 offset:128 sc1
.skip_fused_kernel_15:
    s_cmp_lg_u32 s3, 7
    s_cbranch_scc1 .skip_fused_kernel_16
    buffer_load_dwordx4 a[132:135], v1, s[16:19], 0 offen
.skip_fused_kernel_16:
    v_mov_b32 v96, 0
    v_mov_b32 v97, 0
    v_mov_b32 v98, 0
    v_mov_b32 v99, 0x3afe3f80
    v_mov_b32 v100, 0
    v_mov_b32 v101, 0
    v_mov_b32 v102, 0
    v_mov_b32 v103, 0
    s_mov_b64 exec, 0x110000
    v_mov_b32 v103, 0x3f803f80
    s_mov_b64 exec, -1
    s_nop 0
    v_mfma_f32_32x32x16_bf16 a[32:47], v[96:99], v[100:103], 0
    v_mfma_f32_32x32x16_bf16 a[48:63], v[96:99], v[100:103], 0
    v_mfma_f32_32x32x16_bf16 a[64:79], v[96:99], v[100:103], 0
    v_mfma_f32_32x32x16_bf16 a[80:95], v[96:99], v[100:103], 0
    s_mov_b32 s29, s60
    s_and_b32 s37, s60, 1
    s_lshr_b32 s40, s60, 1
    s_add_u32 s41, s40, s3
    s_and_b32 s41, s41, 3
    s_lshl_b32 s43, s61, 2
    s_add_u32 s40, s40, s43
    s_add_u32 s41, s41, s43
    s_lshr_b32 s43, s3, 2
    s_lshl_b32 s56, s41, 14
    s_lshl_b32 s7, s60, 10
    s_add_u32 s56, s56, s7
    s_lshl_b32 s7, s43, 8
    s_add_u32 s56, s56, s7
    s_add_u32 s56, s56, 2097152
    s_bfe_u32 s57, s40, 0x30001
    s_lshl_b32 s57, s57, 14
    s_lshl_b32 s7, s38, 11
    s_add_u32 s57, s57, s7
    s_and_b32 s7, s40, 1
    s_lshl_b32 s7, s7, 8
    s_lshl_b32 s7, s7, s37
    s_add_u32 s57, s57, s7
    s_lshl_b32 s7, s37, 10
    s_add_u32 s57, s57, s7
    s_add_u32 s57, s57, 5242880
    s_lshl_b32 s58, s38, 7
    s_lshl_b32 s7, s39, 2
    s_add_u32 s58, s58, s7
    s_add_u32 s58, s58, 5390336
    s_lshl_b32 s59, s38, 10
    s_lshl_b32 s7, s3, 7
    s_add_u32 s59, s59, s7
    s_add_u32 s59, s59, 5390336
    s_lshl_b32 s61, s40, 10
    s_add_u32 s61, s61, 5505024
    s_lshl_b32 s60, s29, 1
    s_add_u32 s60, s60, s43
    s_lshl_b32 s60, s60, 6
    s_lshl_b32 s7, s41, 10
    s_add_u32 s60, s60, s7
    s_add_u32 s60, s60, 5505024
    s_lshl_b32 s7, s3, 5
    v_xor_b32 v10, s7, v1
    v_add_u32 v10, s45, v10
    v_xor_b32 v11, 16, v10
    v_add_u32 v11, 1024, v11
    v_and_b32 v88, 15, v0
    v_lshrrev_b32 v89, 4, v0
    v_xor_b32 v90, v88, v89
    v_lshlrev_b32 v90, 4, v90
    v_lshl_add_u32 v90, v88, 10, v90
    s_and_b32 s7, s3, 3
    s_lshl_b32 s7, s7, 14
    v_add_u32 v12, s7, v90
    v_xor_b32 v13, 64, v12
    v_xor_b32 v14, 128, v12
    v_xor_b32 v15, 192, v12
    v_lshrrev_b32 v90, 2, v88
    v_lshl_add_u32 v90, v89, 3, v90
    v_and_b32 v91, 3, v0
    v_lshlrev_b32 v91, 3, v91
    v_lshl_add_u32 v109, v90, 5, v91
    v_add_u32 v109, 73728, v109
    v_lshl_add_u32 v91, v90, 7, v91
    v_bfe_u32 v90, v0, 3, 2
    s_lshl_b32 s7, s43, 1
    v_xor_b32 v90, s7, v90
    v_lshl_add_u32 v91, v90, 5, v91
    v_add_u32 v104, 98304, v91
    v_xor_b32 v105, 32, v104
    v_lshrrev_b32 v90, 1, v89
    v_and_b32 v91, 1, v89
    v_lshlrev_b32 v91, 3, v91
    v_and_b32 v92, 7, v0
    v_lshl_add_u32 v92, v92, 4, v91
    v_lshl_add_u32 v92, v90, 9, v92
    v_lshrrev_b32 v93, 3, v88
    v_lshl_add_u32 v106, v93, 13, v92
    v_xor_b32 v93, s37, v93
    v_lshl_add_u32 v110, v93, 10, v92
    s_lshl_b32 s7, s43, 8
    s_add_u32 s7, s7, 65536
    v_add_u32 v110, s7, v110
    v_and_b32 v92, 3, v88
    v_bfe_u32 v93, v88, 2, 1
    v_lshl_add_u32 v92, v93, 3, v92
    v_lshrrev_b32 v93, 3, v88
    v_lshl_add_u32 v92, v93, 2, v92
    v_lshl_add_u32 v92, v90, 5, v92
    v_lshl_add_u32 v93, v90, 4, v88
    s_cmp_eq_u32 s37, 0
    s_cselect_b64 vcc, -1, 0
    v_cndmask_b32 v92, v93, v92, vcc
    v_lshl_add_u32 v108, v92, 4, v91
    v_and_b32 v111, 124, v2
    v_and_b32 v92, 1, v0
    v_lshlrev_b32 v92, 10, v92
    v_lshl_add_u32 v92, v90, 3, v92
    v_bfe_u32 v93, v0, 1, 4
    v_lshl_add_u32 v92, v93, 4, v92
    s_lshl_b32 s7, s43, 11
    s_and_b32 s40, s3, 3
    s_lshl_b32 s40, s40, 8
    s_add_u32 s7, s7, s40
    s_add_u32 s7, s7, 77824
    v_add_u32 v8, s7, v92
    s_mov_b32 s16, 64
    s_cmp_lt_u32 s3, 4
    s_cselect_b32 s18, 1.0, 0
    s_mov_b32 s7, 200000
    s_cmp_lg_u32 s3, 0
    s_cbranch_scc1 .skip_fused_kernel_17
    s_setprio 3
    v_add_u32 v94, 67584, v2
    v_lshlrev_b32 v95, 4, v89
    v_add_u32 v95, 67584, v95
    s_waitcnt vmcnt(9)
    v_lshlrev_b32 v88, 16, v84
    v_and_b32 v89, 0xffff0000, v84
    v_mul_f32 v90, 0xbfb8aa3b, v88
    v_mul_f32 v91, 0xbfb8aa3b, v89
    v_exp_f32 v90, v90
    v_exp_f32 v91, v91
    v_add_f32 v90, 1.0, v90
    v_add_f32 v91, 1.0, v91
    v_rcp_f32 v90, v90
    v_rcp_f32 v91, v91
    v_mul_f32 v88, v88, v90
    v_mul_f32 v89, v89, v91
    v_cvt_pk_bf16_f32 v88, v88, v89
    ds_write_b32 v94, v88
    s_waitcnt lgkmcnt(0)
    ds_read_b128 a[112:115], v95 offset:0
    ds_read_b128 a[116:119], v95 offset:64
    ds_read_b128 a[120:123], v95 offset:128
    ds_read_b128 a[124:127], v95 offset:192
    s_waitcnt vmcnt(8)
    ds_read_b64_tr_b16 a[96:97], v109 offset:0
    ds_read_b64_tr_b16 a[98:99], v109 offset:128
    s_waitcnt vmcnt(7)
    ds_read_b64_tr_b16 a[100:101], v109 offset:1024
    ds_read_b64_tr_b16 a[102:103], v109 offset:1152
    s_waitcnt vmcnt(6)
    ds_read_b64_tr_b16 a[104:105], v109 offset:2048
    ds_read_b64_tr_b16 a[106:107], v109 offset:2176
    s_waitcnt vmcnt(5)
    ds_read_b64_tr_b16 a[108:109], v109 offset:3072
    ds_read_b64_tr_b16 a[110:111], v109 offset:3200
    s_waitcnt lgkmcnt(6)
    v_mfma_f32_16x16x32_bf16 v[96:99], a[112:115], a[96:99], 0
    s_waitcnt lgkmcnt(4)
    v_mfma_f32_16x16x32_bf16 v[96:99], a[116:119], a[100:103], v[96:99]
    s_waitcnt lgkmcnt(2)
    v_mfma_f32_16x16x32_bf16 v[96:99], a[120:123], a[104:107], v[96:99]
    s_waitcnt lgkmcnt(0)
    v_mfma_f32_16x16x32_bf16 v[96:99], a[124:127], a[108:111], v[96:99]
    s_waitcnt vmcnt(4)
    v_not_b32 v85, v85
    s_nop 5
    v_bfi_b32 v96, 3, v85, v96
    s_mov_b64 exec, 0xffff
    buffer_store_dword v96, v2, s[8:11], s36 offen sc1
    s_mov_b64 exec, -1
    v_xor_b32 v85, 1, v96
    v_xor_b32 v84, 2, v96
    v_accvgpr_write_b32 a112, v85
    v_accvgpr_write_b32 a113, v84
    s_setprio 0
.skip_fused_kernel_17:
    s_cmp_eq_u32 s3, 6
    s_waitcnt vmcnt(3)
    s_cbranch_scc1 .x0_fused_kernel_18
    s_cmp_eq_u32 s28, 1
    s_waitcnt vmcnt(3)
    s_cbranch_scc1 .x0_fused_kernel_18
    s_cmp_eq_u32 s3, 5
    s_waitcnt vmcnt(2)
    s_cbranch_scc1 .x0_fused_kernel_18
    s_lshr_b32 s40, 129, s3
    s_bitcmp1_b32 s40, 0
    s_waitcnt vmcnt(1)
    s_cbranch_scc1 .x0_fused_kernel_18
    s_waitcnt vmcnt(0)
.x0_fused_kernel_18:
    s_add_u32 s47, s47, 0x4000
    s_and_b32 s47, s47, 0xc000
    s_add_u32 s46, s44, s47
    buffer_load_dwordx4 v[36:39], v1, s[12:15], s46 offen offset:0
    buffer_load_dwordx4 v[44:47], v1, s[12:15], s46 offen offset:1024
    s_add_u32 s47, s47, 0x4000
    s_and_b32 s47, s47, 0xc000
    s_add_u32 s46, s44, s47
    buffer_load_dwordx4 v[52:55], v1, s[12:15], s46 offen offset:0
    buffer_load_dwordx4 v[60:63], v1, s[12:15], s46 offen offset:1024
    s_add_u32 s47, s47, 0x4000
    s_and_b32 s47, s47, 0xc000
    s_add_u32 s46, s44, s47
    buffer_load_dwordx4 v[68:71], v1, s[12:15], s46 offen offset:0
    buffer_load_dwordx4 v[76:79], v1, s[12:15], s46 offen offset:1024
    s_lshr_b32 m0, s5, 3
    s_add_u32 m0, m0, s6
    s_nop 0
    buffer_load_dwordx4 v5, s[20:23], s5 offen lds
    buffer_load_dwordx4 v6, s[20:23], s5 offen offset:1024 lds
    s_cmp_lg_u32 s28, 1
    s_cbranch_scc1 .nzf_fused_kernel_19
    s_lshl_b32 s48, s38, 2
    s_waitcnt vmcnt(8)
    buffer_store_dword v107, off, s[92:95], s48 sc1
.nzf_fused_kernel_19:
    s_add_u32 m0, s45, 81920
    s_nop 0
    buffer_load_dwordx4 v1, s[24:27], s45 offen lds
    buffer_load_dwordx4 v1, s[24:27], s45 offen offset:1024 lds
    s_cmp_lg_u32 s3, 5
    s_cbranch_scc1 .skip_fused_kernel_20
    s_lshl_b32 s41, s39, 8
    s_add_u32 s41, s41, s4
    s_add_u32 s41, s41, 1441792
    buffer_store_dword v80, v2, s[8:11], s41 offen sc1
    s_getreg_b32 s41, hwreg(HW_REG_XCC_ID, 0, 4)
    s_or_b32 s41, s41, 0x100
    s_lshl_b32 s40, s39, 2
    s_add_u32 s40, s40, s4
    s_add_u32 s40, s40, 1449984
    v_mov_b32 v95, s41
    buffer_store_dword v95, off, s[8:11], s40 sc1
    v_and_b32 v94, 3, v0
    v_lshlrev_b32 v94, 10, v94
    v_bfe_u32 v95, v0, 2, 1
    v_lshl_add_u32 v94, v95, 6, v94
    s_andn2_b32 s40, s61, 3072
    s_lshl_b32 s41, s29, 7
    s_add_u32 s40, s40, s41
    s_mov_b64 exec, 0xff
    buffer_store_dword v80, v94, s[8:11], s40 offen sc1
    s_mov_b64 exec, -1
.skip_fused_kernel_20:
    v_lshlrev_b32 v9, 30, v32
    v_alignbit_b32 v9, v33, v9, 2
    v_alignbit_b32 v9, v34, v9, 2
    v_alignbit_b32 v9, v35, v9, 2
    v_alignbit_b32 v9, v40, v9, 2
    v_alignbit_b32 v9, v41, v9, 2
    v_alignbit_b32 v9, v42, v9, 2
    v_alignbit_b32 v9, v43, v9, 2
    s_cmp_lg_u32 s3, 5
    s_cbranch_scc1 .skip_fused_kernel_21
    v_lshrrev_b32 v94, 2, v0
    v_lshlrev_b32 v94, 6, v94
    v_and_b32 v95, 3, v0
    v_lshl_add_u32 v94, v95, 3, v94
    v_add_u32 v94, 69632, v94
    s_lshl_b32 s19, s38, 16
    s_lshl_b32 s40, s39, 11
    s_add_u32 s19, s19, s40
    s_add_u32 s19, s19, 4194304
    s_waitcnt vmcnt(13)
    ds_read_b64_tr_b16 a[96:97], v94 offset:0
    ds_read_b64_tr_b16 a[98:99], v94 offset:1024
    ds_read_b64_tr_b16 a[100:101], v94 offset:32
    ds_read_b64_tr_b16 a[102:103], v94 offset:1056
    s_waitcnt lgkmcnt(0)
    buffer_store_dwordx4 a[96:99], v1, s[8:11], s19 offen offset:0 sc1
    buffer_store_dwordx4 a[100:103], v1, s[8:11], s19 offen offset:1024 sc1
.skip_fused_kernel_21:
    v_lshlrev_b32 v16, 16, v20
    v_and_b32 v17, 0xffff0000, v20
    v_lshlrev_b32 v18, 16, v21
    v_and_b32 v19, 0xffff0000, v21
    v_lshlrev_b32 v20, 16, v22
    v_and_b32 v21, 0xffff0000, v22
    v_lshlrev_b32 v22, 16, v23
    v_and_b32 v23, 0xffff0000, v23
    v_pk_add_f32 v[88:89], v[16:17], v[18:19]
    v_pk_add_f32 v[90:91], v[20:21], v[22:23]
    v_pk_mul_f32 v[92:93], v[16:17], v[16:17]
    v_pk_add_f32 v[88:89], v[88:89], v[90:91]
    v_pk_fma_f32 v[92:93], v[18:19], v[18:19], v[92:93]
    v_pk_fma_f32 v[92:93], v[20:21], v[20:21], v[92:93]
    v_add_f32 v80, v88, v89
    v_pk_fma_f32 v[92:93], v[22:23], v[22:23], v[92:93]
    v_add_f32 v96, v92, v93
    v_lshlrev_b32 v24, 16, v28
    v_and_b32 v25, 0xffff0000, v28
    v_lshlrev_b32 v26, 16, v29
    v_and_b32 v27, 0xffff0000, v29
    v_lshlrev_b32 v28, 16, v30
    v_and_b32 v29, 0xffff0000, v30
    v_lshlrev_b32 v30, 16, v31
    v_and_b32 v31, 0xffff0000, v31
    v_pk_add_f32 v[88:89], v[24:25], v[26:27]
    v_pk_add_f32 v[90:91], v[28:29], v[30:31]
    v_pk_mul_f32 v[92:93], v[24:25], v[24:25]
    v_pk_add_f32 v[88:89], v[88:89], v[90:91]
    v_pk_fma_f32 v[92:93], v[26:27], v[26:27], v[92:93]
    v_pk_fma_f32 v[92:93], v[28:29], v[28:29], v[92:93]
    v_add_f32 v81, v88, v89
    v_pk_fma_f32 v[92:93], v[30:31], v[30:31], v[92:93]
    v_add_f32 v97, v92, v93
    v_permlane32_swap_b32 v80, v96
    s_nop 0
    v_permlane32_swap_b32 v81, v97
    v_add_f32 v80, v80, v96
    v_add_f32 v81, v81, v97
    s_nop 1
    v_permlane16_swap_b32 v80, v81
    v_add_f32 v80, v80, v81
    s_nop 1
    v_add_f32_dpp v80, v80, v80 row_ror:8 row_mask:0xf bank_mask:0xf
    s_nop 1
    v_add_f32_dpp v80, v80, v80 row_half_mirror row_mask:0xf bank_mask:0xf
    s_nop 1
    v_add_f32_dpp v80, v80, v80 quad_perm:[1,0,3,2] row_mask:0xf bank_mask:0xf
    s_nop 1
    v_add_f32_dpp v80, v80, v80 quad_perm:[2,3,0,1] row_mask:0xf bank_mask:0xf
    v_mov_b32 v96, v80
    s_nop 1
    v_permlane32_swap_b32 v80, v96
    v_mul_f32 v80, 0x3b000000, v80
    v_mul_f32 v96, 0x3b000000, v96
    v_fma_f32 v96, -v80, v80, v96
    v_max_f32 v96, 0, v96
    v_cvt_pk_bf16_f32 v96, v96, v80
    v_and_b32 v80, 0xffff0000, v96
    v_lshlrev_b32 v96, 16, v96
    v_add_f32 v96, 0x3727c5ac, v96
    v_cvt_pk_bf16_f32 v96, v96, v96
    v_lshlrev_b32 v96, 16, v96
    v_sqrt_f32 v96, v96
    s_nop 0
    v_cvt_pk_bf16_f32 v96, v96, v96
    v_lshlrev_b32 v96, 16, v96
    v_rcp_f32 v88, v96
    s_nop 0
    v_mul_f32 v89, -v80, v88
    v_readlane_b32 s40, v88, 0
    v_readlane_b32 s41, v89, 0
    v_readlane_b32 s42, v88, 16
    v_readlane_b32 s43, v89, 16
    v_pk_fma_f32 v[16:17], v[16:17], s[40:41], s[40:41] op_sel:[0,0,1] op_sel_hi:[1,0,1]
    v_pk_fma_f32 v[18:19], v[18:19], s[40:41], s[40:41] op_sel:[0,0,1] op_sel_hi:[1,0,1]
    v_pk_fma_f32 v[20:21], v[20:21], s[40:41], s[40:41] op_sel:[0,0,1] op_sel_hi:[1,0,1]
    v_pk_fma_f32 v[22:23], v[22:23], s[40:41], s[40:41] op_sel:[0,0,1] op_sel_hi:[1,0,1]
    v_pk_fma_f32 v[24:25], v[24:25], s[42:43], s[42:43] op_sel:[0,0,1] op_sel_hi:[1,0,1]
    v_pk_fma_f32 v[26:27], v[26:27], s[42:43], s[42:43] op_sel:[0,0,1] op_sel_hi:[1,0,1]
    v_pk_fma_f32 v[28:29], v[28:29], s[42:43], s[42:43] op_sel:[0,0,1] op_sel_hi:[1,0,1]
    v_pk_fma_f32 v[30:31], v[30:31], s[42:43], s[42:43] op_sel:[0,0,1] op_sel_hi:[1,0,1]
    s_waitcnt vmcnt(9)
    v_lshlrev_b32 v32, 16, v36
    v_and_b32 v33, 0xffff0000, v36
    v_lshlrev_b32 v34, 16, v37
    v_and_b32 v35, 0xffff0000, v37
    v_lshlrev_b32 v36, 16, v38
    v_and_b32 v37, 0xffff0000, v38
    v_lshlrev_b32 v38, 16, v39
    v_and_b32 v39, 0xffff0000, v39
    v_pk_add_f32 v[88:89], v[32:33], v[34:35]
    v_pk_add_f32 v[90:91], v[36:37], v[38:39]
    v_pk_mul_f32 v[92:93], v[32:33], v[32:33]
    v_pk_add_f32 v[88:89], v[88:89], v[90:91]
    v_pk_fma_f32 v[92:93], v[34:35], v[34:35], v[92:93]
    v_pk_fma_f32 v[92:93], v[36:37], v[36:37], v[92:93]
    v_add_f32 v82, v88, v89
    v_pk_fma_f32 v[92:93], v[38:39], v[38:39], v[92:93]
    v_add_f32 v98, v92, v93
    s_waitcnt vmcnt(8)
    v_lshlrev_b32 v40, 16, v44
    v_and_b32 v41, 0xffff0000, v44
    v_lshlrev_b32 v42, 16, v45
    v_and_b32 v43, 0xffff0000, v45
    v_lshlrev_b32 v44, 16, v46
    v_and_b32 v45, 0xffff0000, v46
    v_lshlrev_b32 v46, 16, v47
    v_and_b32 v47, 0xffff0000, v47
    v_pk_add_f32 v[88:89], v[40:41], v[42:43]
    v_pk_add_f32 v[90:91], v[44:45], v[46:47]
    v_pk_mul_f32 v[92:93], v[40:41], v[40:41]
    v_pk_add_f32 v[88:89], v[88:89], v[90:91]
    v_pk_fma_f32 v[92:93], v[42:43], v[42:43], v[92:93]
    v_pk_fma_f32 v[92:93], v[44:45], v[44:45], v[92:93]
    v_add_f32 v83, v88, v89
    v_pk_fma_f32 v[92:93], v[46:47], v[46:47], v[92:93]
    v_add_f32 v99, v92, v93
    s_cmp_lg_u32 s3, 7
    s_cbranch_scc1 .skip_fused_kernel_22
    buffer_load_dword v4, v3, s[92:95], 0 offen sc1
.skip_fused_kernel_22:
    buffer_load_dwordx4 v[64:67], v7, s[8:11], s100 offen sc1
    buffer_load_dwordx4 v[72:75], v7, s[8:11], s101 offen sc1
    s_waitcnt vmcnt(9)
    v_lshlrev_b32 v48, 16, v52
    v_and_b32 v49, 0xffff0000, v52
    v_lshlrev_b32 v50, 16, v53
    v_and_b32 v51, 0xffff0000, v53
    v_lshlrev_b32 v52, 16, v54
    v_and_b32 v53, 0xffff0000, v54
    v_lshlrev_b32 v54, 16, v55
    v_and_b32 v55, 0xffff0000, v55
    v_pk_add_f32 v[88:89], v[48:49], v[50:51]
    v_pk_add_f32 v[90:91], v[52:53], v[54:55]
    v_pk_mul_f32 v[92:93], v[48:49], v[48:49]
    v_pk_add_f32 v[88:89], v[88:89], v[90:91]
    v_pk_fma_f32 v[92:93], v[50:51], v[50:51], v[92:93]
    v_pk_fma_f32 v[92:93], v[52:53], v[52:53], v[92:93]
    v_add_f32 v84, v88, v89
    v_pk_fma_f32 v[92:93], v[54:55], v[54:55], v[92:93]
    v_add_f32 v100, v92, v93
    s_waitcnt vmcnt(8)
    v_lshlrev_b32 v56, 16, v60
    v_and_b32 v57, 0xffff0000, v60
    v_lshlrev_b32 v58, 16, v61
    v_and_b32 v59, 0xffff0000, v61
    v_lshlrev_b32 v60, 16, v62
    v_and_b32 v61, 0xffff0000, v62
    v_lshlrev_b32 v62, 16, v63
    v_and_b32 v63, 0xffff0000, v63
    v_pk_add_f32 v[88:89], v[56:57], v[58:59]
    v_pk_add_f32 v[90:91], v[60:61], v[62:63]
    v_pk_mul_f32 v[92:93], v[56:57], v[56:57]
    v_pk_add_f32 v[88:89], v[88:89], v[90:91]
    v_pk_fma_f32 v[92:93], v[58:59], v[58:59], v[92:93]
    v_pk_fma_f32 v[92:93], v[60:61], v[60:61], v[92:93]
    v_add_f32 v85, v88, v89
    v_pk_fma_f32 v[92:93], v[62:63], v[62:63], v[92:93]
    v_add_f32 v101, v92, v93
    s_waitcnt vmcnt(0)
.mod_fused_kernel_23:
    v_lshlrev_b32 v88, 30, v64
    v_alignbit_b32 v88, v65, v88, 2
    v_alignbit_b32 v88, v66, v88, 2
    v_alignbit_b32 v88, v67, v88, 2
    v_alignbit_b32 v88, v72, v88, 2
    v_alignbit_b32 v88, v73, v88, 2
    v_alignbit_b32 v88, v74, v88, 2
    v_alignbit_b32 v88, v75, v88, 2
    v_xor_b32 v88, v88, v9
    v_lshl_or_b32 v88, v88, 1, v88
    v_or_b32 v88, 0x5555ffff, v88
    v_and_b32 v64, -4, v64
    v_and_b32 v72, -4, v72
    v_and_b32 v65, -4, v65
    v_and_b32 v73, -4, v73
    v_and_b32 v66, -4, v66
    v_and_b32 v74, -4, v74
    v_and_b32 v67, -4, v67
    v_and_b32 v75, -4, v75
    v_cmp_eq_u32 s[30:31], -1, v88
    v_pk_add_f32 v[90:91], v[64:65], v[72:73]
    v_pk_add_f32 v[92:93], v[66:67], v[74:75]
    s_cmp_lg_u64 s[30:31], -1
    s_cbranch_scc1 .modspin_fused_kernel_24
.modgo_fused_kernel_25:
    v_permlane32_swap_b32 v90, v92
    v_permlane32_swap_b32 v91, v93
    v_pk_add_f32 v[90:91], v[90:91], v[92:93]
    v_cvt_pk_bf16_f32 v92, v90, v91
    v_lshlrev_b32 v90, 16, v92
    v_and_b32 v91, 0xffff0000, v92
    v_pk_add_f32 v[90:91], v[90:91], s[18:19] op_sel_hi:[1,0]
    v_cvt_pk_bf16_f32 v92, v90, v91
    v_lshlrev_b32 v90, 16, v92
    v_and_b32 v91, 0xffff0000, v92
    ds_write_b64 v8, v[90:91]
    v_add_u32 v8, 77824, v1
    s_waitcnt lgkmcnt(0)
    s_barrier
    ds_read_b128 v[88:91], v8 offset:0
    ds_read_b128 v[64:67], v8 offset:2048
    ds_read_b128 v[92:95], v8 offset:1024
    ds_read_b128 v[72:75], v8 offset:3072
    s_waitcnt lgkmcnt(2)
    v_pk_fma_f32 v[16:17], v[16:17], v[88:89], v[64:65]
    v_pk_fma_f32 v[18:19], v[18:19], v[90:91], v[66:67]
    s_waitcnt lgkmcnt(0)
    v_pk_fma_f32 v[20:21], v[20:21], v[92:93], v[72:73]
    v_pk_fma_f32 v[22:23], v[22:23], v[94:95], v[74:75]
    v_cvt_pk_bf16_f32 v16, v16, v17
    v_cvt_pk_bf16_f32 v17, v18, v19
    v_cvt_pk_bf16_f32 v18, v20, v21
    v_cvt_pk_bf16_f32 v19, v22, v23
    ds_write_b128 v10, v[16:19] offset:0
    v_pk_fma_f32 v[24:25], v[24:25], v[88:89], v[64:65]
    v_pk_fma_f32 v[26:27], v[26:27], v[90:91], v[66:67]
    v_pk_fma_f32 v[28:29], v[28:29], v[92:93], v[72:73]
    v_pk_fma_f32 v[30:31], v[30:31], v[94:95], v[74:75]
    v_cvt_pk_bf16_f32 v24, v24, v25
    v_cvt_pk_bf16_f32 v25, v26, v27
    v_cvt_pk_bf16_f32 v26, v28, v29
    v_cvt_pk_bf16_f32 v27, v30, v31
    ds_write_b128 v11, v[24:27] offset:0
    s_cmp_lg_u32 s3, 0
    s_cbranch_scc1 .skip_fused_kernel_28
    s_mov_b64 exec, 0xffff
    buffer_store_dword a112, v2, s[8:11], s36 offen sc1
    s_mov_b64 exec, -1
.skip_fused_kernel_28:
    s_cmp_lg_u32 s3, 7
    s_cbranch_scc1 .skip_fused_kernel_29
    s_waitcnt vmcnt(0)
    v_cmp_eq_u32 s[30:31], 1, v4
    s_nop 1
    s_cmp_lg_u64 s[30:31], -1
    s_cbranch_scc1 .spin_fused_kernel_30
.ready_fused_kernel_31:
.skip_fused_kernel_29:
    s_cmp_lg_u32 s3, 4
    s_waitcnt lgkmcnt(0)
    s_cbranch_scc1 .kvp_fused_kernel_33
    s_setprio 3
    ds_read_b64_tr_b16 a[0:1], v109 offset:8192
    ds_read_b64_tr_b16 a[2:3], v109 offset:8320
    ds_read_b64_tr_b16 a[4:5], v109 offset:9216
    ds_read_b64_tr_b16 a[6:7], v109 offset:9344
    ds_read_b64_tr_b16 a[8:9], v109 offset:10240
    ds_read_b64_tr_b16 a[10:11], v109 offset:10368
    ds_read_b64_tr_b16 a[12:13], v109 offset:11264
    ds_read_b64_tr_b16 a[14:15], v109 offset:11392
    ds_read_b64_tr_b16 a[16:17], v109 offset:12288
    ds_read_b64_tr_b16 a[18:19], v109 offset:12416
    ds_read_b64_tr_b16 a[20:21], v109 offset:13312
    ds_read_b64_tr_b16 a[22:23], v109 offset:13440
    ds_read_b64_tr_b16 a[24:25], v109 offset:14336
    ds_read_b64_tr_b16 a[26:27], v109 offset:14464
    ds_read_b64_tr_b16 a[28:29], v109 offset:15360
    ds_read_b64_tr_b16 a[30:31], v109 offset:15488
    ds_read_b64_tr_b16 a[96:97], v109 offset:16384
    ds_read_b64_tr_b16 a[98:99], v109 offset:16512
    ds_read_b64_tr_b16 a[100:101], v109 offset:17408
    ds_read_b64_tr_b16 a[102:103], v109 offset:17536
    ds_read_b64_tr_b16 a[104:105], v109 offset:18432
    ds_read_b64_tr_b16 a[106:107], v109 offset:18560
    ds_read_b64_tr_b16 a[108:109], v109 offset:19456
    ds_read_b64_tr_b16 a[110:111], v109 offset:19584
    ds_read_b64_tr_b16 a[112:113], v109 offset:20480
    ds_read_b64_tr_b16 a[114:115], v109 offset:20608
    ds_read_b64_tr_b16 a[116:117], v109 offset:21504
    ds_read_b64_tr_b16 a[118:119], v109 offset:21632
    ds_read_b64_tr_b16 a[120:121], v109 offset:22528
    ds_read_b64_tr_b16 a[122:123], v109 offset:22656
    ds_read_b64_tr_b16 a[124:125], v109 offset:23552
    ds_read_b64_tr_b16 a[126:127], v109 offset:23680
.kvp_fused_kernel_33:
    s_barrier
    s_cmp_lg_u32 s3, 4
    s_cbranch_scc1 .skip_fused_kernel_34
    s_setprio 3
    ds_read_b128 v[16:19], v12 offset:0
    ds_read_b128 v[20:23], v13 offset:0
    ds_read_b128 v[24:27], v14 offset:0
    ds_read_b128 v[28:31], v15 offset:0
    ds_read_b128 a[128:131], v12 offset:256
    ds_read_b128 a[132:135], v13 offset:256
    ds_read_b128 a[136:139], v14 offset:256
    ds_read_b128 a[140:143], v15 offset:256
    s_cmp_lg_u32 s37, 0
    s_cbranch_scc1 .vv_fused_kernel_35
    s_waitcnt lgkmcnt(7)
    v_mfma_f32_16x16x32_bf16 v[64:67], a[0:3], v[16:19], 0
    ds_read_b128 v[16:19], v12 offset:512
    s_waitcnt lgkmcnt(7)
    v_mfma_f32_16x16x32_bf16 v[72:75], a[4:7], v[20:23], 0
    ds_read_b128 v[20:23], v13 offset:512
    s_waitcnt lgkmcnt(7)
    v_mfma_f32_16x16x32_bf16 v[64:67], a[8:11], v[24:27], v[64:67]
    ds_read_b128 v[24:27], v14 offset:512
    s_waitcnt lgkmcnt(7)
    v_mfma_f32_16x16x32_bf16 v[72:75], a[12:15], v[28:31], v[72:75]
    ds_read_b128 v[28:31], v15 offset:512
    s_waitcnt lgkmcnt(7)
    v_mfma_f32_16x16x32_bf16 v[64:67], a[16:19], a[128:131], v[64:67]
    ds_read_b128 a[128:131], v12 offset:768
    s_waitcnt lgkmcnt(7)
    v_mfma_f32_16x16x32_bf16 v[72:75], a[20:23], a[132:135], v[72:75]
    ds_read_b128 a[132:135], v13 offset:768
    s_waitcnt lgkmcnt(7)
    v_mfma_f32_16x16x32_bf16 v[64:67], a[24:27], a[136:139], v[64:67]
    ds_read_b128 a[136:139], v14 offset:768
    s_waitcnt lgkmcnt(7)
    v_mfma_f32_16x16x32_bf16 v[72:75], a[28:31], a[140:143], v[72:75]
    ds_read_b128 a[140:143], v15 offset:768
    s_waitcnt lgkmcnt(7)
    v_mfma_f32_16x16x32_bf16 v[64:67], a[96:99], v[16:19], v[64:67]
    s_waitcnt lgkmcnt(6)
    v_mfma_f32_16x16x32_bf16 v[72:75], a[100:103], v[20:23], v[72:75]
    s_waitcnt lgkmcnt(5)
    v_mfma_f32_16x16x32_bf16 v[64:67], a[104:107], v[24:27], v[64:67]
    s_waitcnt lgkmcnt(4)
    v_mfma_f32_16x16x32_bf16 v[72:75], a[108:111], v[28:31], v[72:75]
    s_waitcnt lgkmcnt(3)
    v_mfma_f32_16x16x32_bf16 v[64:67], a[112:115], a[128:131], v[64:67]
    s_waitcnt lgkmcnt(2)
    v_mfma_f32_16x16x32_bf16 v[72:75], a[116:119], a[132:135], v[72:75]
    s_waitcnt lgkmcnt(1)
    v_mfma_f32_16x16x32_bf16 v[64:67], a[120:123], a[136:139], v[64:67]
    s_waitcnt lgkmcnt(0)
    v_mfma_f32_16x16x32_bf16 v[72:75], a[124:127], a[140:143], v[72:75]
    s_branch .kve_fused_kernel_36
.modspin_fused_kernel_24:
    s_sub_u32 s16, s16, 1
    s_cbranch_scc1 .own_fused_kernel_26
    s_cmp_lg_u32 s3, 0
    s_cbranch_scc1 .modspin_fused_kernel_24t
    s_mov_b64 exec, 0xffff
    buffer_store_dword a112, v2, s[8:11], s36 offen sc1
    s_mov_b64 exec, -1
.modspin_fused_kernel_24t:
    s_sleep 1
    buffer_load_dwordx4 v[64:67], v7, s[8:11], s100 offen sc1
    buffer_load_dwordx4 v[72:75], v7, s[8:11], s101 offen sc1
    s_waitcnt vmcnt(0)
    s_branch .mod_fused_kernel_23
.spin_fused_kernel_30:
    s_sleep 1
    buffer_load_dword v4, v3, s[92:95], 0 offen sc1
    s_waitcnt vmcnt(0)
    v_cmp_eq_u32 s[30:31], 1, v4
    s_nop 1
    s_cmp_eq_u64 s[30:31], -1
    s_cbranch_scc1 .seen_fused_kernel_32
    s_sub_u32 s7, s7, 1
    s_cbranch_scc0 .spin_fused_kernel_30
    s_mov_b32 s7, 0
.seen_fused_kernel_32:
    s_branch .ready_fused_kernel_31
.vv_fused_kernel_35:
    s_waitcnt lgkmcnt(7)
    v_mfma_f32_16x16x32_bf16 v[64:67], v[16:19], a[0:3], 0
    ds_read_b128 v[16:19], v12 offset:512
    s_waitcnt lgkmcnt(7)
    v_mfma_f32_16x16x32_bf16 v[72:75], v[20:23], a[4:7], 0
    ds_read_b128 v[20:23], v13 offset:512
    s_waitcnt lgkmcnt(7)
    v_mfma_f32_16x16x32_bf16 v[64:67], v[24:27], a[8:11], v[64:67]
    ds_read_b128 v[24:27], v14 offset:512
    s_waitcnt lgkmcnt(7)
    v_mfma_f32_16x16x32_bf16 v[72:75], v[28:31], a[12:15], v[72:75]
    ds_read_b128 v[28:31], v15 offset:512
    s_waitcnt lgkmcnt(7)
    v_mfma_f32_16x16x32_bf16 v[64:67], a[128:131], a[16:19], v[64:67]
    ds_read_b128 a[128:131], v12 offset:768
    s_waitcnt lgkmcnt(7)
    v_mfma_f32_16x16x32_bf16 v[72:75], a[132:135], a[20:23], v[72:75]
    ds_read_b128 a[132:135], v13 offset:768
    s_waitcnt lgkmcnt(7)
    v_mfma_f32_16x16x32_bf16 v[64:67], a[136:139], a[24:27], v[64:67]
    ds_read_b128 a[136:139], v14 offset:768
    s_waitcnt lgkmcnt(7)
    v_mfma_f32_16x16x32_bf16 v[72:75], a[140:143], a[28:31], v[72:75]
    ds_read_b128 a[140:143], v15 offset:768
    s_waitcnt lgkmcnt(7)
    v_mfma_f32_16x16x32_bf16 v[64:67], v[16:19], a[96:99], v[64:67]
    s_waitcnt lgkmcnt(6)
    v_mfma_f32_16x16x32_bf16 v[72:75], v[20:23], a[100:103], v[72:75]
    s_waitcnt lgkmcnt(5)
    v_mfma_f32_16x16x32_bf16 v[64:67], v[24:27], a[104:107], v[64:67]
    s_waitcnt lgkmcnt(4)
    v_mfma_f32_16x16x32_bf16 v[72:75], v[28:31], a[108:111], v[72:75]
    s_waitcnt lgkmcnt(3)
    v_mfma_f32_16x16x32_bf16 v[64:67], a[128:131], a[112:115], v[64:67]
    s_waitcnt lgkmcnt(2)
    v_mfma_f32_16x16x32_bf16 v[72:75], a[132:135], a[116:119], v[72:75]
    s_waitcnt lgkmcnt(1)
    v_mfma_f32_16x16x32_bf16 v[64:67], a[136:139], a[120:123], v[64:67]
    s_waitcnt lgkmcnt(0)
    v_mfma_f32_16x16x32_bf16 v[72:75], a[140:143], a[124:127], v[72:75]
.kve_fused_kernel_36:
    s_nop 7
    v_pk_add_f32 v[64:65], v[64:65], v[72:73]
    v_pk_add_f32 v[66:67], v[66:67], v[74:75]
    v_cvt_pk_bf16_f32 v16, v64, v65
    v_cvt_pk_bf16_f32 v17, v66, v67
    buffer_store_dwordx2 v[16:17], v108, s[8:11], s57 offen sc1
.skip_fused_kernel_34:
    s_cmp_lg_u32 s3, 7
    s_cbranch_scc1 .skip_fused_kernel_37
    s_mov_b32 s40, 73728
    v_accvgpr_read_b32 v20, a132
    v_accvgpr_read_b32 v21, a133
    v_accvgpr_read_b32 v22, a134
    v_accvgpr_read_b32 v23, a135
    v_lshlrev_b32 v16, 16, v20
    v_and_b32 v17, 0xffff0000, v20
    v_lshlrev_b32 v18, 16, v21
    v_and_b32 v19, 0xffff0000, v21
    v_lshlrev_b32 v20, 16, v22
    v_and_b32 v21, 0xffff0000, v22
    v_lshlrev_b32 v22, 16, v23
    v_and_b32 v23, 0xffff0000, v23
    v_mul_f32 v24, 0xbfb8aa3b, v16
    v_mul_f32 v25, 0xbfb8aa3b, v17
    v_mul_f32 v26, 0xbfb8aa3b, v18
    v_mul_f32 v27, 0xbfb8aa3b, v19
    v_mul_f32 v28, 0xbfb8aa3b, v20
    v_mul_f32 v29, 0xbfb8aa3b, v21
    v_mul_f32 v30, 0xbfb8aa3b, v22
    v_mul_f32 v31, 0xbfb8aa3b, v23
    v_exp_f32 v24, v24
    v_exp_f32 v25, v25
    v_exp_f32 v26, v26
    v_exp_f32 v27, v27
    v_exp_f32 v28, v28
    v_exp_f32 v29, v29
    v_exp_f32 v30, v30
    v_exp_f32 v31, v31
    v_add_f32 v24, 1.0, v24
    v_add_f32 v25, 1.0, v25
    v_add_f32 v26, 1.0, v26
    v_add_f32 v27, 1.0, v27
    v_add_f32 v28, 1.0, v28
    v_add_f32 v29, 1.0, v29
    v_add_f32 v30, 1.0, v30
    v_add_f32 v31, 1.0, v31
    v_rcp_f32 v24, v24
    v_rcp_f32 v25, v25
    v_rcp_f32 v26, v26
    v_rcp_f32 v27, v27
    v_rcp_f32 v28, v28
    v_rcp_f32 v29, v29
    v_rcp_f32 v30, v30
    v_rcp_f32 v31, v31
    v_mul_f32 v16, v16, v24
    v_mul_f32 v17, v17, v25
    v_mul_f32 v18, v18, v26
    v_mul_f32 v19, v19, v27
    v_mul_f32 v20, v20, v28
    v_mul_f32 v21, v21, v29
    v_mul_f32 v22, v22, v30
    v_mul_f32 v23, v23, v31
    v_cvt_pk_bf16_f32 v24, v16, v18
    v_cvt_pk_bf16_f32 v25, v20, v22
    v_cvt_pk_bf16_f32 v26, v17, v19
    v_cvt_pk_bf16_f32 v27, v21, v23
    v_bfe_u32 v16, v0, 1, 2
    v_lshlrev_b32 v16, 8, v16
    v_bfe_u32 v17, v0, 3, 2
    v_lshl_add_u32 v16, v17, 6, v16
    v_and_b32 v17, 32, v0
    v_and_b32 v18, 1, v0
    v_lshl_add_u32 v16, v18, 3, v16
    v_add3_u32 v16, v16, v17, s40
    ds_write_b64 v16, v[24:25]
    ds_write_b64 v16, v[26:27] offset:16
.skip_fused_kernel_37:
    s_add_u32 s5, s5, 0x4000
    s_and_b32 s5, s5, 0xc000
    s_lshr_b32 m0, s5, 3
    s_add_u32 m0, m0, s6
    s_nop 0
    buffer_load_dwordx4 v5, s[20:23], s5 offen lds
    buffer_load_dwordx4 v6, s[20:23], s5 offen offset:1024 lds
    s_waitcnt vmcnt(9)
    v_lshlrev_b32 v64, 16, v68
    v_and_b32 v65, 0xffff0000, v68
    v_lshlrev_b32 v66, 16, v69
    v_and_b32 v67, 0xffff0000, v69
    v_lshlrev_b32 v68, 16, v70
    v_and_b32 v69, 0xffff0000, v70
    v_lshlrev_b32 v70, 16, v71
    v_and_b32 v71, 0xffff0000, v71
    v_pk_add_f32 v[88:89], v[64:65], v[66:67]
    v_pk_add_f32 v[90:91], v[68:69], v[70:71]
    v_pk_mul_f32 v[92:93], v[64:65], v[64:65]
    v_pk_add_f32 v[88:89], v[88:89], v[90:91]
    v_pk_fma_f32 v[92:93], v[66:67], v[66:67], v[92:93]
    v_pk_fma_f32 v[92:93], v[68:69], v[68:69], v[92:93]
    v_add_f32 v86, v88, v89
    v_pk_fma_f32 v[92:93], v[70:71], v[70:71], v[92:93]
    v_add_f32 v102, v92, v93
    s_add_u32 s5, s5, 0x4000
    s_and_b32 s5, s5, 0xc000
    s_lshr_b32 m0, s5, 3
    s_add_u32 m0, m0, s6
    s_nop 0
    buffer_load_dwordx4 v5, s[20:23], s5 offen lds
    buffer_load_dwordx4 v6, s[20:23], s5 offen offset:1024 lds
    s_waitcnt vmcnt(10)
    v_lshlrev_b32 v72, 16, v76
    v_and_b32 v73, 0xffff0000, v76
    v_lshlrev_b32 v74, 16, v77
    v_and_b32 v75, 0xffff0000, v77
    v_lshlrev_b32 v76, 16, v78
    v_and_b32 v77, 0xffff0000, v78
    v_lshlrev_b32 v78, 16, v79
    v_and_b32 v79, 0xffff0000, v79
    v_pk_add_f32 v[88:89], v[72:73], v[74:75]
    v_pk_add_f32 v[90:91], v[76:77], v[78:79]
    v_pk_mul_f32 v[92:93], v[72:73], v[72:73]
    v_pk_add_f32 v[88:89], v[88:89], v[90:91]
    v_pk_fma_f32 v[92:93], v[74:75], v[74:75], v[92:93]
    v_pk_fma_f32 v[92:93], v[76:77], v[76:77], v[92:93]
    v_add_f32 v87, v88, v89
    v_pk_fma_f32 v[92:93], v[78:79], v[78:79], v[92:93]
    v_add_f32 v103, v92, v93
    s_add_u32 s5, s5, 0x4000
    s_and_b32 s5, s5, 0xc000
    s_lshr_b32 m0, s5, 3
    s_add_u32 m0, m0, s6
    s_nop 0
    buffer_load_dwordx4 v5, s[20:23], s5 offen lds
    buffer_load_dwordx4 v6, s[20:23], s5 offen offset:1024 lds
    s_cmp_lg_u32 s3, 4
    s_cbranch_scc1 .skip_fused_kernel_38
    v_lshlrev_b32 v18, 10, v0
    s_mov_b64 exec, 255
    s_waitcnt vmcnt(6)
    buffer_store_dword v107, v18, s[8:11], s58 offen sc1
    s_mov_b64 exec, -1
    s_setprio 0
.skip_fused_kernel_38:
    v_permlane32_swap_b32 v80, v84
    v_permlane32_swap_b32 v81, v85
    v_permlane32_swap_b32 v82, v86
    v_permlane32_swap_b32 v83, v87
    v_add_f32 v80, v80, v84
    v_add_f32 v81, v81, v85
    v_add_f32 v82, v82, v86
    v_add_f32 v83, v83, v87
    s_nop 0
    v_permlane16_swap_b32 v80, v82
    v_permlane16_swap_b32 v81, v83
    v_add_f32 v80, v80, v82
    v_add_f32 v81, v81, v83
    s_nop 0
    v_add_f32_dpp v80, v80, v80 row_ror:8 row_mask:0xf bank_mask:0x3
    s_nop 1
    v_add_f32_dpp v80, v81, v81 row_ror:8 row_mask:0xf bank_mask:0xc
    s_nop 1
    v_add_f32_dpp v80, v80, v80 row_half_mirror row_mask:0xf bank_mask:0xf
    s_nop 1
    v_add_f32_dpp v80, v80, v80 quad_perm:[1,0,3,2] row_mask:0xf bank_mask:0xf
    s_nop 1
    v_add_f32_dpp v80, v80, v80 quad_perm:[2,3,0,1] row_mask:0xf bank_mask:0xf
    v_permlane32_swap_b32 v96, v100
    v_permlane32_swap_b32 v97, v101
    v_permlane32_swap_b32 v98, v102
    v_permlane32_swap_b32 v99, v103
    v_add_f32 v96, v96, v100
    v_add_f32 v97, v97, v101
    v_add_f32 v98, v98, v102
    v_add_f32 v99, v99, v103
    s_nop 0
    v_permlane16_swap_b32 v96, v98
    v_permlane16_swap_b32 v97, v99
    v_add_f32 v96, v96, v98
    v_add_f32 v97, v97, v99
    s_nop 0
    v_add_f32_dpp v96, v96, v96 row_ror:8 row_mask:0xf bank_mask:0x3
    s_nop 1
    v_add_f32_dpp v96, v97, v97 row_ror:8 row_mask:0xf bank_mask:0xc
    s_nop 1
    v_add_f32_dpp v96, v96, v96 row_half_mirror row_mask:0xf bank_mask:0xf
    s_nop 1
    v_add_f32_dpp v96, v96, v96 quad_perm:[1,0,3,2] row_mask:0xf bank_mask:0xf
    s_nop 1
    v_add_f32_dpp v96, v96, v96 quad_perm:[2,3,0,1] row_mask:0xf bank_mask:0xf
    v_mul_f32 v80, 0x3b000000, v80
    v_mul_f32 v96, 0x3b000000, v96
    v_fma_f32 v96, -v80, v80, v96
    v_max_f32 v96, 0, v96
    v_cvt_pk_bf16_f32 v96, v96, v80
    v_and_b32 v80, 0xffff0000, v96
    v_lshlrev_b32 v96, 16, v96
    v_add_f32 v96, 0x3727c5ac, v96
    v_cvt_pk_bf16_f32 v96, v96, v96
    v_lshlrev_b32 v96, 16, v96
    v_sqrt_f32 v96, v96
    s_nop 0
    v_cvt_pk_bf16_f32 v96, v96, v96
    v_lshlrev_b32 v96, 16, v96
    v_rcp_f32 v88, v96
    s_nop 0
    v_mul_f32 v89, -v80, v88
    v_readlane_b32 s44, v88, 16
    v_readlane_b32 s45, v89, 16
    v_readlane_b32 s46, v88, 24
    v_readlane_b32 s47, v89, 24
    v_readlane_b32 s48, v88, 32
    v_readlane_b32 s49, v89, 32
    v_readlane_b32 s50, v88, 40
    v_readlane_b32 s51, v89, 40
    v_readlane_b32 s52, v88, 48
    v_readlane_b32 s53, v89, 48
    v_readlane_b32 s54, v88, 56
    v_readlane_b32 s55, v89, 56
    ds_read_b128 v[80:83], v8 offset:0
    ds_read_b128 v[88:91], v8 offset:2048
    ds_read_b128 v[84:87], v8 offset:1024
    ds_read_b128 v[92:95], v8 offset:3072
    v_pk_fma_f32 v[32:33], v[32:33], s[44:45], s[44:45] op_sel:[0,0,1] op_sel_hi:[1,0,1]
    v_pk_fma_f32 v[34:35], v[34:35], s[44:45], s[44:45] op_sel:[0,0,1] op_sel_hi:[1,0,1]
    v_pk_fma_f32 v[36:37], v[36:37], s[44:45], s[44:45] op_sel:[0,0,1] op_sel_hi:[1,0,1]
    v_pk_fma_f32 v[38:39], v[38:39], s[44:45], s[44:45] op_sel:[0,0,1] op_sel_hi:[1,0,1]
    v_pk_fma_f32 v[40:41], v[40:41], s[46:47], s[46:47] op_sel:[0,0,1] op_sel_hi:[1,0,1]
    v_pk_fma_f32 v[42:43], v[42:43], s[46:47], s[46:47] op_sel:[0,0,1] op_sel_hi:[1,0,1]
    v_pk_fma_f32 v[44:45], v[44:45], s[46:47], s[46:47] op_sel:[0,0,1] op_sel_hi:[1,0,1]
    v_pk_fma_f32 v[46:47], v[46:47], s[46:47], s[46:47] op_sel:[0,0,1] op_sel_hi:[1,0,1]
    v_pk_fma_f32 v[48:49], v[48:49], s[48:49], s[48:49] op_sel:[0,0,1] op_sel_hi:[1,0,1]
    v_pk_fma_f32 v[50:51], v[50:51], s[48:49], s[48:49] op_sel:[0,0,1] op_sel_hi:[1,0,1]
    v_pk_fma_f32 v[52:53], v[52:53], s[48:49], s[48:49] op_sel:[0,0,1] op_sel_hi:[1,0,1]
    v_pk_fma_f32 v[54:55], v[54:55], s[48:49], s[48:49] op_sel:[0,0,1] op_sel_hi:[1,0,1]
    v_pk_fma_f32 v[56:57], v[56:57], s[50:51], s[50:51] op_sel:[0,0,1] op_sel_hi:[1,0,1]
    v_pk_fma_f32 v[58:59], v[58:59], s[50:51], s[50:51] op_sel:[0,0,1] op_sel_hi:[1,0,1]
    v_pk_fma_f32 v[60:61], v[60:61], s[50:51], s[50:51] op_sel:[0,0,1] op_sel_hi:[1,0,1]
    v_pk_fma_f32 v[62:63], v[62:63], s[50:51], s[50:51] op_sel:[0,0,1] op_sel_hi:[1,0,1]
    v_pk_fma_f32 v[64:65], v[64:65], s[52:53], s[52:53] op_sel:[0,0,1] op_sel_hi:[1,0,1]
    v_pk_fma_f32 v[66:67], v[66:67], s[52:53], s[52:53] op_sel:[0,0,1] op_sel_hi:[1,0,1]
    v_pk_fma_f32 v[68:69], v[68:69], s[52:53], s[52:53] op_sel:[0,0,1] op_sel_hi:[1,0,1]
    v_pk_fma_f32 v[70:71], v[70:71], s[52:53], s[52:53] op_sel:[0,0,1] op_sel_hi:[1,0,1]
    v_pk_fma_f32 v[72:73], v[72:73], s[54:55], s[54:55] op_sel:[0,0,1] op_sel_hi:[1,0,1]
    v_pk_fma_f32 v[74:75], v[74:75], s[54:55], s[54:55] op_sel:[0,0,1] op_sel_hi:[1,0,1]
    v_pk_fma_f32 v[76:77], v[76:77], s[54:55], s[54:55] op_sel:[0,0,1] op_sel_hi:[1,0,1]
    v_pk_fma_f32 v[78:79], v[78:79], s[54:55], s[54:55] op_sel:[0,0,1] op_sel_hi:[1,0,1]
    s_waitcnt lgkmcnt(2)
    v_pk_fma_f32 v[32:33], v[32:33], v[80:81], v[88:89]
    v_pk_fma_f32 v[34:35], v[34:35], v[82:83], v[90:91]
    s_waitcnt lgkmcnt(0)
    v_pk_fma_f32 v[36:37], v[36:37], v[84:85], v[92:93]
    v_pk_fma_f32 v[38:39], v[38:39], v[86:87], v[94:95]
    v_cvt_pk_bf16_f32 v32, v32, v33
    v_cvt_pk_bf16_f32 v33, v34, v35
    v_cvt_pk_bf16_f32 v34, v36, v37
    v_cvt_pk_bf16_f32 v35, v38, v39
    ds_write_b128 v10, v[32:35] offset:16384
    s_load_dwordx2 s[48:49], s[0:1], 48
    s_load_dwordx2 s[52:53], s[0:1], 56
    s_mov_b32 s50, 1835008
    s_mov_b32 s51, 0x20000
    s_mov_b32 s54, 1835008
    s_mov_b32 s55, 0x20000
    v_pk_fma_f32 v[40:41], v[40:41], v[80:81], v[88:89]
    v_pk_fma_f32 v[42:43], v[42:43], v[82:83], v[90:91]
    v_pk_fma_f32 v[44:45], v[44:45], v[84:85], v[92:93]
    v_pk_fma_f32 v[46:47], v[46:47], v[86:87], v[94:95]
    v_cvt_pk_bf16_f32 v40, v40, v41
    v_cvt_pk_bf16_f32 v41, v42, v43
    v_cvt_pk_bf16_f32 v42, v44, v45
    v_cvt_pk_bf16_f32 v43, v46, v47
    ds_write_b128 v11, v[40:43] offset:16384
    v_pk_fma_f32 v[48:49], v[48:49], v[80:81], v[88:89]
    v_pk_fma_f32 v[50:51], v[50:51], v[82:83], v[90:91]
    v_pk_fma_f32 v[52:53], v[52:53], v[84:85], v[92:93]
    v_pk_fma_f32 v[54:55], v[54:55], v[86:87], v[94:95]
    v_cvt_pk_bf16_f32 v48, v48, v49
    v_cvt_pk_bf16_f32 v49, v50, v51
    v_cvt_pk_bf16_f32 v50, v52, v53
    v_cvt_pk_bf16_f32 v51, v54, v55
    ds_write_b128 v10, v[48:51] offset:32768
    v_pk_fma_f32 v[56:57], v[56:57], v[80:81], v[88:89]
    v_pk_fma_f32 v[58:59], v[58:59], v[82:83], v[90:91]
    v_pk_fma_f32 v[60:61], v[60:61], v[84:85], v[92:93]
    v_pk_fma_f32 v[62:63], v[62:63], v[86:87], v[94:95]
    v_cvt_pk_bf16_f32 v56, v56, v57
    v_cvt_pk_bf16_f32 v57, v58, v59
    v_cvt_pk_bf16_f32 v58, v60, v61
    v_cvt_pk_bf16_f32 v59, v62, v63
    ds_write_b128 v11, v[56:59] offset:32768
    v_pk_fma_f32 v[64:65], v[64:65], v[80:81], v[88:89]
    v_pk_fma_f32 v[66:67], v[66:67], v[82:83], v[90:91]
    v_pk_fma_f32 v[68:69], v[68:69], v[84:85], v[92:93]
    v_pk_fma_f32 v[70:71], v[70:71], v[86:87], v[94:95]
    v_cvt_pk_bf16_f32 v64, v64, v65
    v_cvt_pk_bf16_f32 v65, v66, v67
    v_cvt_pk_bf16_f32 v66, v68, v69
    v_cvt_pk_bf16_f32 v67, v70, v71
    ds_write_b128 v10, v[64:67] offset:49152
    v_pk_fma_f32 v[72:73], v[72:73], v[80:81], v[88:89]
    v_pk_fma_f32 v[74:75], v[74:75], v[82:83], v[90:91]
    v_pk_fma_f32 v[76:77], v[76:77], v[84:85], v[92:93]
    v_pk_fma_f32 v[78:79], v[78:79], v[86:87], v[94:95]
    v_cvt_pk_bf16_f32 v72, v72, v73
    v_cvt_pk_bf16_f32 v73, v74, v75
    v_cvt_pk_bf16_f32 v74, v76, v77
    v_cvt_pk_bf16_f32 v75, v78, v79
    ds_write_b128 v11, v[72:75] offset:49152
    s_waitcnt vmcnt(0) lgkmcnt(0)
    s_cmp_lg_u32 s3, 6
    s_cbranch_scc1 .skip_fused_kernel_39
    v_lshrrev_b32 v96, 2, v0
    v_mul_u32_u24 v96, 6144, v96
    v_and_b32 v97, 3, v0
    v_lshl_add_u32 v96, v97, 7, v96
    s_mul_i32 s40, s39, 98304
    s_lshl_b32 s41, s38, 9
    s_add_u32 s40, s40, s41
    s_mov_b32 m0, 92160
    s_nop 0
    buffer_load_dword v96, s[96:99], s40 offen offset:2048 lds
.skip_fused_kernel_39:
    s_barrier
    s_cmp_lg_u32 s3, 0
    s_cbranch_scc1 .skip_fused_kernel_40
    s_mov_b64 exec, 0xffff
    buffer_store_dword a113, v2, s[8:11], s36 offen sc1
    s_mov_b64 exec, -1
.skip_fused_kernel_40:
    ds_read_b128 v[16:19], v12 offset:0
    ds_read_b64_tr_b16 v[20:21], v104 offset:0
    ds_read_b64_tr_b16 v[22:23], v104 offset:512
    ds_read_b64_tr_b16 v[24:25], v105 offset:0
    ds_read_b64_tr_b16 v[26:27], v105 offset:512
    ds_read_b128 v[28:31], v13 offset:0
    ds_read_b64_tr_b16 v[32:33], v104 offset:4096
    ds_read_b64_tr_b16 v[34:35], v104 offset:4608
    ds_read_b64_tr_b16 v[36:37], v105 offset:4096
    ds_read_b64_tr_b16 v[38:39], v105 offset:4608
    ds_read_b128 v[40:43], v14 offset:0
    ds_read_b64_tr_b16 v[44:45], v104 offset:8192
    ds_read_b64_tr_b16 v[46:47], v104 offset:8704
    ds_read_b64_tr_b16 v[48:49], v105 offset:8192
    ds_read_b64_tr_b16 v[50:51], v105 offset:8704
    s_waitcnt lgkmcnt(10)
    v_mfma_f32_16x16x32_bf16 v[96:99], v[20:23], v[16:19], 0
    v_mfma_f32_16x16x32_bf16 v[100:103], v[24:27], v[16:19], 0
    s_mov_b32 s22, 0xffff
    s_mov_b32 s23, 0xffff
    s_mov_b32 s19, 0x12800000
    s_mov_b32 s20, 1090519040
    s_and_b32 s21, s2, 7
    ds_read_b128 v[16:19], v15 offset:0
    ds_read_b64_tr_b16 v[20:21], v104 offset:12288
    ds_read_b64_tr_b16 v[22:23], v104 offset:12800
    ds_read_b64_tr_b16 v[24:25], v105 offset:12288
    ds_read_b64_tr_b16 v[26:27], v105 offset:12800
    s_waitcnt lgkmcnt(10)
    v_mfma_f32_16x16x32_bf16 v[96:99], v[32:35], v[28:31], v[96:99]
    v_mfma_f32_16x16x32_bf16 v[100:103], v[36:39], v[28:31], v[100:103]
    s_lshl_b32 s21, s21, 5
    s_lshr_b32 s35, s2, 3
    s_add_u32 s21, s21, s35
    s_lshl_b32 s28, s21, 13
    s_cmp_lt_u32 s3, 4
    ds_read_b128 v[28:31], v12 offset:256
    ds_read_b64_tr_b16 v[32:33], v104 offset:16384
    ds_read_b64_tr_b16 v[34:35], v104 offset:16896
    ds_read_b64_tr_b16 v[36:37], v105 offset:16384
    ds_read_b64_tr_b16 v[38:39], v105 offset:16896
    s_waitcnt lgkmcnt(10)
    v_mfma_f32_16x16x32_bf16 v[96:99], v[44:47], v[40:43], v[96:99]
    v_mfma_f32_16x16x32_bf16 v[100:103], v[48:51], v[40:43], v[100:103]
    s_cselect_b64 vcc, -1, 0
    v_lshrrev_b32 v5, 5, v0
    v_and_b32 v9, 15, v0
    v_lshlrev_b32 v9, 4, v9
    v_lshl_add_u32 v9, v5, 8, v9
    ds_read_b128 v[40:43], v13 offset:256
    ds_read_b64_tr_b16 v[44:45], v104 offset:20480
    ds_read_b64_tr_b16 v[46:47], v104 offset:20992
    ds_read_b64_tr_b16 v[48:49], v105 offset:20480
    ds_read_b64_tr_b16 v[50:51], v105 offset:20992
    s_waitcnt lgkmcnt(10)
    v_mfma_f32_16x16x32_bf16 v[96:99], v[20:23], v[16:19], v[96:99]
    v_mfma_f32_16x16x32_bf16 v[100:103], v[24:27], v[16:19], v[100:103]
    s_add_u32 s34, s28, 2097152
    s_add_u32 s32, s29, 1
    s_and_b32 s32, s32, 7
    s_lshl_b32 s32, s32, 10
    s_add_u32 s32, s32, s34
    ds_read_b128 v[16:19], v14 offset:256
    ds_read_b64_tr_b16 v[20:21], v104 offset:24576
    ds_read_b64_tr_b16 v[22:23], v104 offset:25088
    ds_read_b64_tr_b16 v[24:25], v105 offset:24576
    ds_read_b64_tr_b16 v[26:27], v105 offset:25088
    s_waitcnt lgkmcnt(10)
    v_mfma_f32_16x16x32_bf16 v[96:99], v[32:35], v[28:31], v[96:99]
    v_mfma_f32_16x16x32_bf16 v[100:103], v[36:39], v[28:31], v[100:103]
    s_add_u32 s33, s29, s3
    s_and_b32 s33, s33, 7
    s_lshl_b32 s33, s33, 10
    s_add_u32 s34, s34, s33
    s_lshl_b32 s33, s3, 10
    ds_read_b128 v[28:31], v15 offset:256
    ds_read_b64_tr_b16 v[32:33], v104 offset:28672
    ds_read_b64_tr_b16 v[34:35], v104 offset:29184
    ds_read_b64_tr_b16 v[36:37], v105 offset:28672
    ds_read_b64_tr_b16 v[38:39], v105 offset:29184
    s_waitcnt lgkmcnt(10)
    v_mfma_f32_16x16x32_bf16 v[96:99], v[44:47], v[40:43], v[96:99]
    v_mfma_f32_16x16x32_bf16 v[100:103], v[48:51], v[40:43], v[100:103]
    s_lshl_b32 s36, s3, 11
    s_lshl_b32 s35, s29, 14
    s_add_u32 s36, s36, s35
    s_add_u32 s36, s36, 5242880
    s_lshl_b32 s17, s3, 12
    ds_read_b128 v[40:43], v12 offset:512
    ds_read_b64_tr_b16 v[44:45], v104 offset:32768
    ds_read_b64_tr_b16 v[46:47], v104 offset:33280
    ds_read_b64_tr_b16 v[48:49], v105 offset:32768
    ds_read_b64_tr_b16 v[50:51], v105 offset:33280
    s_waitcnt lgkmcnt(10)
    v_mfma_f32_16x16x32_bf16 v[96:99], v[20:23], v[16:19], v[96:99]
    v_mfma_f32_16x16x32_bf16 v[100:103], v[24:27], v[16:19], v[100:103]
    s_lshl_b32 s35, s29, 16
    s_add_u32 s17, s17, s35
    s_add_u32 s17, s17, 4194304
    s_add_u32 s18, s17, 32768
    s_lshl_b32 s35, s3, 11
    ds_read_b128 v[16:19], v13 offset:512
    ds_read_b64_tr_b16 v[20:21], v104 offset:36864
    ds_read_b64_tr_b16 v[22:23], v104 offset:37376
    ds_read_b64_tr_b16 v[24:25], v105 offset:36864
    ds_read_b64_tr_b16 v[26:27], v105 offset:37376
    s_waitcnt lgkmcnt(10)
    v_mfma_f32_16x16x32_bf16 v[96:99], v[32:35], v[28:31], v[96:99]
    v_mfma_f32_16x16x32_bf16 v[100:103], v[36:39], v[28:31], v[100:103]
    s_bitset1_b32 s35, 15
    v_add_u32 v2, s35, v1
    v_and_b32 v3, 31, v0
    v_lshlrev_b32 v3, 5, v3
    s_lshl_b32 s35, s3, 2
    ds_read_b128 v[28:31], v14 offset:512
    ds_read_b64_tr_b16 v[32:33], v104 offset:40960
    ds_read_b64_tr_b16 v[34:35], v104 offset:41472
    ds_read_b64_tr_b16 v[36:37], v105 offset:40960
    ds_read_b64_tr_b16 v[38:39], v105 offset:41472
    s_waitcnt lgkmcnt(10)
    v_mfma_f32_16x16x32_bf16 v[96:99], v[44:47], v[40:43], v[96:99]
    v_mfma_f32_16x16x32_bf16 v[100:103], v[48:51], v[40:43], v[100:103]
    s_bitset1_b32 s35, 15
    v_add_u32 v3, s35, v3
    s_lshl_b32 s35, s3, 9
    s_bitset1_b32 s35, 15
    v_lshl_add_u32 v4, v0, 3, s35
    ds_read_b128 v[40:43], v15 offset:512
    ds_read_b64_tr_b16 v[44:45], v104 offset:45056
    ds_read_b64_tr_b16 v[46:47], v104 offset:45568
    ds_read_b64_tr_b16 v[48:49], v105 offset:45056
    ds_read_b64_tr_b16 v[50:51], v105 offset:45568
    s_waitcnt lgkmcnt(10)
    v_mfma_f32_16x16x32_bf16 v[96:99], v[20:23], v[16:19], v[96:99]
    v_mfma_f32_16x16x32_bf16 v[100:103], v[24:27], v[16:19], v[100:103]
    v_lshrrev_b32 v5, 1, v0
    v_lshrrev_b32 v6, 4, v5
    v_lshlrev_b32 v6, 9, v6
    v_and_b32 v7, 7, v5
    v_lshl_add_u32 v6, v7, 4, v6
    ds_read_b128 v[16:19], v12 offset:768
    ds_read_b64_tr_b16 v[20:21], v104 offset:49152
    ds_read_b64_tr_b16 v[22:23], v104 offset:49664
    ds_read_b64_tr_b16 v[24:25], v105 offset:49152
    ds_read_b64_tr_b16 v[26:27], v105 offset:49664
    s_waitcnt lgkmcnt(10)
    v_mfma_f32_16x16x32_bf16 v[96:99], v[32:35], v[28:31], v[96:99]
    v_mfma_f32_16x16x32_bf16 v[100:103], v[36:39], v[28:31], v[100:103]
    v_bfe_u32 v7, v5, 3, 1
    v_lshl_add_u32 v6, v7, 3, v6
    v_and_b32 v7, 1, v0
    v_lshl_add_u32 v6, v7, 2, v6
    s_lshl_b32 s35, s3, 7
    buffer_load_dword v88, v111, s[8:11], s59 offen sc1
    ds_read_b128 v[28:31], v13 offset:768
    ds_read_b64_tr_b16 v[32:33], v104 offset:53248
    ds_read_b64_tr_b16 v[34:35], v104 offset:53760
    ds_read_b64_tr_b16 v[36:37], v105 offset:53248
    ds_read_b64_tr_b16 v[38:39], v105 offset:53760
    s_waitcnt lgkmcnt(10)
    v_mfma_f32_16x16x32_bf16 v[96:99], v[44:47], v[40:43], v[96:99]
    v_mfma_f32_16x16x32_bf16 v[100:103], v[48:51], v[40:43], v[100:103]
    s_bitset1_b32 s35, 15
    v_add_u32 v6, s35, v6
    s_mov_b32 s35, 32768
    v_lshl_add_u32 v5, v5, 5, s35
    v_lshrrev_b32 v7, 4, v0
    ds_read_b128 v[40:43], v14 offset:768
    ds_read_b64_tr_b16 v[44:45], v104 offset:57344
    ds_read_b64_tr_b16 v[46:47], v104 offset:57856
    ds_read_b64_tr_b16 v[48:49], v105 offset:57344
    ds_read_b64_tr_b16 v[50:51], v105 offset:57856
    s_waitcnt lgkmcnt(10)
    v_mfma_f32_16x16x32_bf16 v[96:99], v[20:23], v[16:19], v[96:99]
    v_mfma_f32_16x16x32_bf16 v[100:103], v[24:27], v[16:19], v[100:103]
    v_lshlrev_b32 v7, 3, v7
    v_and_b32 v8, 7, v0
    v_add_u32 v7, v7, v8
    v_lshl_add_u32 v7, v7, 4, s35
    v_add_u32 v8, 65536, v1
    ds_read_b128 v[16:19], v15 offset:768
    ds_read_b64_tr_b16 v[20:21], v104 offset:61440
    ds_read_b64_tr_b16 v[22:23], v104 offset:61952
    ds_read_b64_tr_b16 v[24:25], v105 offset:61440
    ds_read_b64_tr_b16 v[26:27], v105 offset:61952
    s_waitcnt lgkmcnt(10)
    v_mfma_f32_16x16x32_bf16 v[96:99], v[32:35], v[28:31], v[96:99]
    v_mfma_f32_16x16x32_bf16 v[100:103], v[36:39], v[28:31], v[100:103]
    s_mov_b32 s16, 2
    s_mov_b64 s[24:25], 0
    s_waitcnt lgkmcnt(5)
    v_mfma_f32_16x16x32_bf16 v[96:99], v[44:47], v[40:43], v[96:99]
    v_mfma_f32_16x16x32_bf16 v[100:103], v[48:51], v[40:43], v[100:103]
    s_waitcnt lgkmcnt(0)
    v_mfma_f32_16x16x32_bf16 v[96:99], v[20:23], v[16:19], v[96:99]
    v_mfma_f32_16x16x32_bf16 v[100:103], v[24:27], v[16:19], v[100:103]
    v_mov_b32 v74, 0
    v_mov_b32 v75, 0
    v_mov_b32 v76, 0
    v_mov_b32 v77, 0
    s_nop 1
    v_mfma_f32_32x32x16_bf16 v[54:69], v[74:77], v[74:77], 0
    v_mul_f32 v96, 0x3eb8aa3b, v96
    v_mul_f32 v97, 0x3eb8aa3b, v97
    v_mul_f32 v98, 0x3eb8aa3b, v98
    v_mul_f32 v99, 0x3eb8aa3b, v99
    v_mul_f32 v100, 0x3eb8aa3b, v100
    v_mul_f32 v101, 0x3eb8aa3b, v101
    v_mul_f32 v102, 0x3eb8aa3b, v102
    v_mul_f32 v103, 0x3eb8aa3b, v103
    v_cvt_pk_bf16_f32 v96, v96, v97
    v_cvt_pk_bf16_f32 v97, v98, v99
    v_cvt_pk_bf16_f32 v98, v100, v101
    v_cvt_pk_bf16_f32 v99, v102, v103
    buffer_store_dwordx2 v[96:97], v106, s[8:11], s56 offen offset:0 sc1
    buffer_store_dwordx2 v[98:99], v106, s[8:11], s56 offen offset:128 sc1
    s_and_b32 s44, s3, 3
    s_cbranch_scc1 .nq0_fused_kernel_41
    ds_write_b64 v110, v[96:97]
    ds_write_b64 v110, v[98:99] offset:128
.nq0_fused_kernel_41:
    s_waitcnt vmcnt(2)
    v_cmp_eq_u32 s[30:31], 1, v88
    s_nop 1
    s_cmp_lg_u64 s[30:31], -1
    s_cbranch_scc1 .spin_fused_kernel_42
.ready_fused_kernel_43:
    buffer_load_dwordx4 a[0:3], v1, s[8:11], s36 offen sc1
    s_mov_b64 exec, s[22:23]
    buffer_load_dwordx4 a[32:35], v9, s[8:11], s36 offen offset:1024 sc1
    buffer_load_dwordx4 a[36:39], v9, s[8:11], s36 offen offset:1536 sc1
    s_mov_b64 exec, -1
    s_add_u32 s37, s36, 16384
    s_bitset0_b32 s37, 17
    buffer_load_dwordx4 a[4:7], v1, s[8:11], s37 offen sc1
    s_mov_b64 exec, s[22:23]
    buffer_load_dwordx4 a[40:43], v9, s[8:11], s37 offen offset:1024 sc1
    buffer_load_dwordx4 a[44:47], v9, s[8:11], s37 offen offset:1536 sc1
    s_mov_b64 exec, -1
    s_add_u32 s36, s37, 16384
    s_bitset0_b32 s36, 17
    buffer_load_dwordx4 a[8:11], v1, s[8:11], s36 offen sc1
    s_bfe_u32 s35, s34, 0x3000a
    s_bfe_u32 s38, s32, 0x3000a
    s_lshl_b32 s35, s35, 7
    s_lshl_b32 s38, s38, 7
    v_and_b32 v105, 1, v0
    v_lshl_add_u32 v105, v105, 6, s35
    s_sub_u32 s38, s38, s35
    v_bfe_u32 v106, v0, 1, 1
    v_mad_i32_i24 v105, v106, s38, v105
    v_lshlrev_b32 v110, 2, v0
    v_or_b32 v110, 0x10000, v110
    ds_write_b32 v110, v74 offset:9984
    s_waitcnt lgkmcnt(0)
    s_barrier
    ds_read_b128 v[50:53], v8
    ds_write_b32 v74, v74 offset:30720
    v_add_u32 v8, 2048, v8
    s_waitcnt vmcnt(6)
    buffer_store_dword v107, off, s[8:11], s60 sc1
    s_waitcnt lgkmcnt(0)
    v_mfma_f32_32x32x16_bf16 v[10:25], a[0:3], v[50:53], 0
    s_nop 11
    v_exp_f32 v10, v10
    v_exp_f32 v11, v11
    v_exp_f32 v12, v12
    v_exp_f32 v13, v13
    v_exp_f32 v14, v14
    s_setprio 3
    s_mov_b64 exec, s[22:23]
    buffer_load_dwordx4 a[48:51], v9, s[8:11], s36 offen offset:1024 sc1
    buffer_load_dwordx4 a[52:55], v9, s[8:11], s36 offen offset:1536 sc1
    s_mov_b64 exec, -1
    s_add_u32 s37, s36, 16384
    s_bitset0_b32 s37, 17
    buffer_load_dwordx4 a[12:15], v1, s[8:11], s37 offen sc1
    v_exp_f32 v15, v15
    v_exp_f32 v16, v16
    v_exp_f32 v17, v17
    s_waitcnt vmcnt(7)
    v_mfma_f32_32x32x16_bf16 v[26:41], a[4:7], v[50:53], 0
    v_cvt_pk_bf16_f32 v42, v10, v11
    v_cvt_pk_bf16_f32 v43, v12, v13
    v_cvt_pk_bf16_f32 v44, v14, v15
    v_cvt_pk_bf16_f32 v45, v16, v17
    v_exp_f32 v18, v18
    v_exp_f32 v19, v19
    v_exp_f32 v20, v20
    v_exp_f32 v21, v21
    s_waitcnt vmcnt(8)
    v_mfma_f32_32x32x16_bf16 a[96:111], a[32:35], v[42:45], 0
    v_exp_f32 v22, v22
    v_exp_f32 v23, v23
    v_cvt_pk_bf16_f32 v46, v18, v19
    v_cvt_pk_bf16_f32 v47, v20, v21
    v_exp_f32 v24, v24
    v_exp_f32 v25, v25
    v_cvt_pk_bf16_f32 v48, v22, v23
    v_cvt_pk_bf16_f32 v49, v24, v25
    v_exp_f32 v26, v26
    v_exp_f32 v27, v27
    v_mfma_f32_32x32x16_bf16 a[96:111], a[36:39], v[46:49], a[96:111]
    v_exp_f32 v28, v28
    v_exp_f32 v29, v29
    v_exp_f32 v30, v30
    s_mov_b64 exec, s[22:23]
    buffer_load_dwordx4 a[56:59], v9, s[8:11], s37 offen offset:1024 sc1
    buffer_load_dwordx4 a[60:63], v9, s[8:11], s37 offen offset:1536 sc1
    s_mov_b64 exec, -1
    s_add_u32 s36, s37, 16384
    s_bitset0_b32 s36, 17
    buffer_load_dwordx4 a[16:19], v1, s[8:11], s36 offen sc1
    v_exp_f32 v31, v31
    v_exp_f32 v32, v32
    v_exp_f32 v33, v33
    s_waitcnt vmcnt(7)
    v_mfma_f32_32x32x16_bf16 v[10:25], a[8:11], v[50:53], 0
    v_cvt_pk_bf16_f32 v42, v26, v27
    v_cvt_pk_bf16_f32 v43, v28, v29
    v_cvt_pk_bf16_f32 v44, v30, v31
    v_cvt_pk_bf16_f32 v45, v32, v33
    v_exp_f32 v34, v34
    v_exp_f32 v35, v35
    v_exp_f32 v36, v36
    v_exp_f32 v37, v37
    s_waitcnt vmcnt(8)
    v_mfma_f32_32x32x16_bf16 a[96:111], a[40:43], v[42:45], a[96:111]
    v_exp_f32 v38, v38
    v_exp_f32 v39, v39
    v_cvt_pk_bf16_f32 v46, v34, v35
    v_cvt_pk_bf16_f32 v47, v36, v37
    v_exp_f32 v40, v40
    v_exp_f32 v41, v41
    v_cvt_pk_bf16_f32 v48, v38, v39
    v_cvt_pk_bf16_f32 v49, v40, v41
    v_exp_f32 v10, v10
    v_exp_f32 v11, v11
    v_mfma_f32_32x32x16_bf16 a[96:111], a[44:47], v[46:49], a[96:111]
    v_exp_f32 v12, v12
    v_exp_f32 v13, v13
    v_exp_f32 v14, v14
    s_mov_b64 exec, s[22:23]
    buffer_load_dwordx4 a[64:67], v9, s[8:11], s36 offen offset:1024 sc1
    buffer_load_dwordx4 a[68:71], v9, s[8:11], s36 offen offset:1536 sc1
    s_mov_b64 exec, -1
    s_add_u32 s37, s36, 16384
    s_bitset0_b32 s37, 17
    buffer_load_dwordx4 a[20:23], v1, s[8:11], s37 offen sc1
    buffer_load_dword v106, v105, s[8:11], s61 offen sc1
    v_exp_f32 v15, v15
    v_exp_f32 v16, v16
    v_exp_f32 v17, v17
    s_waitcnt vmcnt(7)
    v_mfma_f32_32x32x16_bf16 v[26:41], a[12:15], v[50:53], 0
    v_cvt_pk_bf16_f32 v42, v10, v11
    v_cvt_pk_bf16_f32 v43, v12, v13
    v_cvt_pk_bf16_f32 v44, v14, v15
    v_cvt_pk_bf16_f32 v45, v16, v17
    v_exp_f32 v18, v18
    v_exp_f32 v19, v19
    v_exp_f32 v20, v20
    v_exp_f32 v21, v21
    s_waitcnt vmcnt(8)
    v_mfma_f32_32x32x16_bf16 a[96:111], a[48:51], v[42:45], a[96:111]
    v_exp_f32 v22, v22
    v_exp_f32 v23, v23
    v_cvt_pk_bf16_f32 v46, v18, v19
    v_cvt_pk_bf16_f32 v47, v20, v21
    v_exp_f32 v24, v24
    v_exp_f32 v25, v25
    v_cvt_pk_bf16_f32 v48, v22, v23
    v_cvt_pk_bf16_f32 v49, v24, v25
    v_exp_f32 v26, v26
    v_exp_f32 v27, v27
    v_mfma_f32_32x32x16_bf16 a[96:111], a[52:55], v[46:49], a[96:111]
    v_exp_f32 v28, v28
    v_exp_f32 v29, v29
    v_exp_f32 v30, v30
    s_mov_b64 exec, s[22:23]
    buffer_load_dwordx4 a[72:75], v9, s[8:11], s37 offen offset:1024 sc1
    buffer_load_dwordx4 a[76:79], v9, s[8:11], s37 offen offset:1536 sc1
    s_mov_b64 exec, -1
    s_add_u32 s36, s37, 16384
    s_bitset0_b32 s36, 17
    buffer_load_dwordx4 a[24:27], v1, s[8:11], s36 offen sc1
    v_exp_f32 v31, v31
    v_exp_f32 v32, v32
    v_exp_f32 v33, v33
    s_waitcnt vmcnt(7)
    v_mfma_f32_32x32x16_bf16 v[10:25], a[16:19], v[50:53], 0
    v_cvt_pk_bf16_f32 v42, v26, v27
    v_cvt_pk_bf16_f32 v43, v28, v29
    v_cvt_pk_bf16_f32 v44, v30, v31
    v_cvt_pk_bf16_f32 v45, v32, v33
    v_exp_f32 v34, v34
    v_exp_f32 v35, v35
    v_exp_f32 v36, v36
    v_exp_f32 v37, v37
    s_waitcnt vmcnt(8)
    v_mfma_f32_32x32x16_bf16 a[96:111], a[56:59], v[42:45], a[96:111]
    v_exp_f32 v38, v38
    v_exp_f32 v39, v39
    v_cvt_pk_bf16_f32 v46, v34, v35
    v_cvt_pk_bf16_f32 v47, v36, v37
    v_exp_f32 v40, v40
    v_exp_f32 v41, v41
    v_cvt_pk_bf16_f32 v48, v38, v39
    v_cvt_pk_bf16_f32 v49, v40, v41
    v_exp_f32 v10, v10
    v_exp_f32 v11, v11
    v_mfma_f32_32x32x16_bf16 a[96:111], a[60:63], v[46:49], a[96:111]
    v_exp_f32 v12, v12
    v_exp_f32 v13, v13
    v_exp_f32 v14, v14
    s_mov_b64 exec, s[22:23]
    buffer_load_dwordx4 a[80:83], v9, s[8:11], s36 offen offset:1024 sc1
    buffer_load_dwordx4 a[84:87], v9, s[8:11], s36 offen offset:1536 sc1
    s_mov_b64 exec, -1
    s_add_u32 s37, s36, 16384
    s_bitset0_b32 s37, 17
    buffer_load_dwordx4 a[28:31], v1, s[8:11], s37 offen sc1
    s_waitcnt vmcnt(6)
    v_cmp_eq_u32 s[30:31], 1, v106
    s_nop 1
    s_cmp_lg_u64 s[30:31], -1
    s_cbranch_scc1 .spin_fused_kernel_45
.ready_fused_kernel_46:
    s_add_u32 m0, s33, 65536
    buffer_load_dwordx4 v[94:97], v1, s[8:11], s32 offen sc1
    buffer_load_dwordx4 v1, s[8:11], s34 offen sc1 lds
    v_exp_f32 v15, v15
    v_exp_f32 v16, v16
    v_exp_f32 v17, v17
    s_waitcnt vmcnt(9)
    v_mfma_f32_32x32x16_bf16 v[26:41], a[20:23], v[50:53], 0
    v_cvt_pk_bf16_f32 v42, v10, v11
    v_cvt_pk_bf16_f32 v43, v12, v13
    v_cvt_pk_bf16_f32 v44, v14, v15
    v_cvt_pk_bf16_f32 v45, v16, v17
    v_exp_f32 v18, v18
    v_exp_f32 v19, v19
    v_exp_f32 v20, v20
    v_exp_f32 v21, v21
    s_waitcnt vmcnt(10)
    v_mfma_f32_32x32x16_bf16 a[96:111], a[64:67], v[42:45], a[96:111]
    v_exp_f32 v22, v22
    v_exp_f32 v23, v23
    v_cvt_pk_bf16_f32 v46, v18, v19
    v_cvt_pk_bf16_f32 v47, v20, v21
    v_exp_f32 v24, v24
    v_exp_f32 v25, v25
    v_cvt_pk_bf16_f32 v48, v22, v23
    v_cvt_pk_bf16_f32 v49, v24, v25
    v_exp_f32 v26, v26
    v_exp_f32 v27, v27
    v_mfma_f32_32x32x16_bf16 a[96:111], a[68:71], v[46:49], a[96:111]
    v_exp_f32 v28, v28
    v_exp_f32 v29, v29
    v_exp_f32 v30, v30
    s_setprio 2
    s_mov_b64 exec, s[22:23]
    buffer_load_dwordx4 a[88:91], v9, s[8:11], s37 offen offset:1024 sc1
    buffer_load_dwordx4 a[92:95], v9, s[8:11], s37 offen offset:1536 sc1
    s_mov_b64 exec, -1
    v_exp_f32 v31, v31
    v_exp_f32 v32, v32
    v_exp_f32 v33, v33
    s_waitcnt vmcnt(7)
    v_mfma_f32_32x32x16_bf16 v[10:25], a[24:27], v[50:53], 0
    v_cvt_pk_bf16_f32 v42, v26, v27
    v_cvt_pk_bf16_f32 v43, v28, v29
    v_cvt_pk_bf16_f32 v44, v30, v31
    v_cvt_pk_bf16_f32 v45, v32, v33
    v_exp_f32 v34, v34
    v_exp_f32 v35, v35
    v_exp_f32 v36, v36
    v_exp_f32 v37, v37
    s_waitcnt vmcnt(8)
    v_mfma_f32_32x32x16_bf16 a[96:111], a[72:75], v[42:45], a[96:111]
    v_exp_f32 v38, v38
    v_exp_f32 v39, v39
    v_cvt_pk_bf16_f32 v46, v34, v35
    v_cvt_pk_bf16_f32 v47, v36, v37
    v_exp_f32 v40, v40
    v_exp_f32 v41, v41
    v_cvt_pk_bf16_f32 v48, v38, v39
    v_cvt_pk_bf16_f32 v49, v40, v41
    v_exp_f32 v10, v10
    v_exp_f32 v11, v11
    v_mfma_f32_32x32x16_bf16 a[96:111], a[76:79], v[46:49], a[96:111]
    v_exp_f32 v12, v12
    v_exp_f32 v13, v13
    v_exp_f32 v14, v14
    s_add_u32 s35, s33, 20480
    s_mov_b32 m0, s35
    s_lshl_b32 s35, s3, 7
    s_add_u32 s35, s35, s28
    v_lshrrev_b32 v9, 3, v0
    v_lshlrev_b32 v9, 10, v9
    v_and_b32 v70, 7, v0
    v_lshl_add_u32 v9, v70, 4, v9
    buffer_load_dwordx4 v9, s[12:15], s35 offen lds
    s_add_u32 m0, s33, 53248
    s_mul_i32 s35, s3, 393216
    s_lshl_b32 s34, s21, 4
    s_add_u32 s34, s34, s35
    v_mul_u32_u24 v70, 6144, v0
    s_add_u32 s34, s34, 2048
    s_add_u32 s57, s33, 5406720
    buffer_load_dwordx4 v70, s[96:99], s34 offen lds
    s_cmp_eq_u32 s3, 7
    s_cselect_b32 s56, 12, 0
    s_add_u32 s35, s33, 0xffffb000
    v_add_u32 v109, s35, v109
    s_lshl_b32 s35, s3, 4
    s_lshl_b64 s[58:59], 0xff, s35
    v_exp_f32 v15, v15
    v_exp_f32 v16, v16
    v_exp_f32 v17, v17
    s_waitcnt vmcnt(6)
    v_mfma_f32_32x32x16_bf16 v[26:41], a[28:31], v[50:53], 0
    v_cvt_pk_bf16_f32 v42, v10, v11
    v_cvt_pk_bf16_f32 v43, v12, v13
    v_cvt_pk_bf16_f32 v44, v14, v15
    v_cvt_pk_bf16_f32 v45, v16, v17
    v_exp_f32 v18, v18
    v_exp_f32 v19, v19
    v_exp_f32 v20, v20
    v_exp_f32 v21, v21
    s_waitcnt vmcnt(7)
    v_mfma_f32_32x32x16_bf16 a[96:111], a[80:83], v[42:45], a[96:111]
    v_exp_f32 v22, v22
    v_exp_f32 v23, v23
    v_cvt_pk_bf16_f32 v46, v18, v19
    v_cvt_pk_bf16_f32 v47, v20, v21
    v_exp_f32 v24, v24
    v_exp_f32 v25, v25
    v_cvt_pk_bf16_f32 v48, v22, v23
    v_cvt_pk_bf16_f32 v49, v24, v25
    v_exp_f32 v26, v26
    v_exp_f32 v27, v27
    v_mfma_f32_32x32x16_bf16 a[96:111], a[84:87], v[46:49], a[96:111]
    v_exp_f32 v28, v28
    v_exp_f32 v29, v29
    v_exp_f32 v30, v30
    s_setprio 1
    v_exp_f32 v31, v31
    v_exp_f32 v32, v32
    v_exp_f32 v33, v33
    s_waitcnt vmcnt(4)
    v_pk_mov_b32 v[50:51], v[94:95], v[94:95] op_sel:[0,1]
    v_pk_mov_b32 v[52:53], v[96:97], v[96:97] op_sel:[0,1]
    s_nop 1
    v_mfma_f32_32x32x16_bf16 v[10:25], a[0:3], v[50:53], 0
    v_cvt_pk_bf16_f32 v42, v26, v27
    v_cvt_pk_bf16_f32 v43, v28, v29
    v_cvt_pk_bf16_f32 v44, v30, v31
    v_cvt_pk_bf16_f32 v45, v32, v33
    v_exp_f32 v34, v34
    v_exp_f32 v35, v35
    v_exp_f32 v36, v36
    v_exp_f32 v37, v37
    s_waitcnt vmcnt(2)
    v_mfma_f32_32x32x16_bf16 a[96:111], a[88:91], v[42:45], a[96:111]
    v_bfe_u32 v70, v0, 4, 1
    v_lshlrev_b32 v70, 2, v70
    v_xor_b32 v70, v70, v0
    v_and_b32 v70, 7, v70
    v_lshrrev_b32 v108, 3, v0
    v_mul_u32_u24 v108, 3584, v108
    v_lshl_add_u32 v108, v70, 4, v108
    s_lshr_b32 s40, s39, 1
    s_min_u32 s40, s40, 13
    s_lshl_b32 s40, s40, 8
    s_mul_i32 s41, s3, 57344
    s_add_u32 s40, s40, s41
    s_add_u32 s42, s40, 128
    s_add_u32 s43, s42, 27648
    s_lshl_b32 s44, s3, 11
    s_add_u32 m0, s44, 81920
    s_add_u32 s44, s44, 98304
    buffer_load_dwordx4 v108, s[48:51], s42 offen lds
    buffer_load_dwordx4 v108, s[48:51], s43 offen offset:1024 lds
    s_and_b32 s43, s39, 1
    s_lshl_b32 s43, 458752, s43
    s_add_u32 s42, s42, s43
    s_mov_b32 s43, 28672
    s_mov_b32 s45, 16384
    s_add_u32 s41, s40, 27648
    s_getreg_b32 s46, hwreg(HW_REG_XCC_ID, 0, 4)
    s_or_b32 s46, s46, 0x100
    s_add_u32 s38, s4, 1449984
    s_mul_i32 s61, s39, 45056
    s_min_u32 s61, s61, 1380352
    s_add_u32 s61, s61, s4
    s_mul_i32 s39, s39, 57344
    s_mul_i32 s35, s3, 1280
    s_add_u32 s39, s39, s35
    s_add_u32 s61, s61, s35
    v_lshlrev_b32 v9, 7, v0
    v_add_u32 v70, 6, v0
    v_lshrrev_b32 v70, 4, v70
    v_lshl_add_u32 v9, v70, 26, v9
    v_exp_f32 v38, v38
    v_exp_f32 v39, v39
    v_cvt_pk_bf16_f32 v46, v34, v35
    v_cvt_pk_bf16_f32 v47, v36, v37
    v_exp_f32 v40, v40
    v_exp_f32 v41, v41
    v_cvt_pk_bf16_f32 v48, v38, v39
    v_cvt_pk_bf16_f32 v49, v40, v41
    v_exp_f32 v10, v10
    v_exp_f32 v11, v11
    v_mfma_f32_32x32x16_bf16 a[96:111], a[92:95], v[46:49], a[96:111]
    s_mov_b32 s60, 8
    s_cbranch_vccz .nr_fused_kernel_49
    v_exp_f32 v12, v12
    v_exp_f32 v13, v13
    v_exp_f32 v14, v14
    v_exp_f32 v15, v15
    v_exp_f32 v16, v16
    v_exp_f32 v17, v17
    v_mfma_f32_32x32x16_bf16 v[26:41], a[4:7], v[50:53], 0
    v_cvt_pk_bf16_f32 v42, v10, v11
    v_cvt_pk_bf16_f32 v43, v12, v13
    v_cvt_pk_bf16_f32 v44, v14, v15
    v_cvt_pk_bf16_f32 v45, v16, v17
    v_exp_f32 v18, v18
    v_exp_f32 v19, v19
    v_exp_f32 v20, v20
    v_exp_f32 v21, v21
    ds_write_b128 v2, a[96:99] offset:0
    ds_write_b128 v2, a[100:103] offset:1024
    ds_write_b32 v3, a104 offset:16384
    ds_add_u32 v110, v107 offset:9984
    v_mfma_f32_32x32x16_bf16 a[96:111], a[32:35], v[42:45], 0
    v_xor_b32 v2, 32768, v2
    v_xor_b32 v3, 32768, v3
    s_setprio 0
    v_exp_f32 v22, v22
    v_exp_f32 v23, v23
    v_cvt_pk_bf16_f32 v46, v18, v19
    v_cvt_pk_bf16_f32 v47, v20, v21
    v_exp_f32 v24, v24
    v_exp_f32 v25, v25
    v_cvt_pk_bf16_f32 v48, v22, v23
    v_cvt_pk_bf16_f32 v49, v24, v25
    v_exp_f32 v26, v26
    v_exp_f32 v27, v27
    v_mfma_f32_32x32x16_bf16 a[96:111], a[36:39], v[46:49], a[96:111]
    v_exp_f32 v28, v28
    v_exp_f32 v29, v29
    v_exp_f32 v30, v30
    v_exp_f32 v31, v31
    v_exp_f32 v32, v32
    v_exp_f32 v33, v33
    v_mfma_f32_32x32x16_bf16 v[10:25], a[8:11], v[50:53], 0
    s_mov_b32 m0, s44
    v_cvt_pk_bf16_f32 v42, v26, v27
    v_cvt_pk_bf16_f32 v43, v28, v29
    v_cvt_pk_bf16_f32 v44, v30, v31
    v_cvt_pk_bf16_f32 v45, v32, v33
    v_exp_f32 v34, v34
    v_exp_f32 v35, v35
    v_exp_f32 v36, v36
    v_exp_f32 v37, v37
    v_mfma_f32_32x32x16_bf16 a[96:111], a[40:43], v[42:45], a[96:111]
    ds_read_b32 v111, v110 offset:9984
    buffer_load_dwordx4 v108, s[48:51], s40 offen lds
    s_add_u32 s40, s40, 458752
    s_add_u32 s44, s44, s45
    v_exp_f32 v38, v38
    v_exp_f32 v39, v39
    v_cvt_pk_bf16_f32 v46, v34, v35
    v_cvt_pk_bf16_f32 v47, v36, v37
    buffer_load_dwordx4 v108, s[48:51], s41 offen offset:1024 lds
    v_exp_f32 v40, v40
    v_exp_f32 v41, v41
    v_cvt_pk_bf16_f32 v48, v38, v39
    v_cvt_pk_bf16_f32 v49, v40, v41
    v_exp_f32 v10, v10
    v_exp_f32 v11, v11
    v_mfma_f32_32x32x16_bf16 a[96:111], a[44:47], v[46:49], a[96:111]
    s_waitcnt lgkmcnt(0)
    v_cmp_gt_u32 vcc, s60, v111
    s_mov_b32 m0, s43
    v_exp_f32 v12, v12
    v_exp_f32 v13, v13
    v_exp_f32 v14, v14
.sbc_fused_kernel_50:
    s_nop 0
    s_cbranch_vccnz .sbs_fused_kernel_51
    s_add_u32 s60, s60, 8
    buffer_load_dword v9, s[52:55], s39 offen lds
    s_add_u32 s39, s39, 10240
    s_add_u32 s41, s40, 27648
    v_exp_f32 v15, v15
    v_exp_f32 v16, v16
    v_exp_f32 v17, v17
    v_mfma_f32_32x32x16_bf16 v[26:41], a[12:15], v[50:53], 0
    ds_read_b64 v[70:71], v4 offset:0
    s_setprio 3
    v_cvt_pk_bf16_f32 v42, v10, v11
    v_cvt_pk_bf16_f32 v43, v12, v13
    v_cvt_pk_bf16_f32 v44, v14, v15
    v_cvt_pk_bf16_f32 v45, v16, v17
    v_exp_f32 v18, v18
    v_exp_f32 v19, v19
    v_exp_f32 v20, v20
    v_exp_f32 v21, v21
    v_mfma_f32_32x32x16_bf16 a[96:111], a[48:51], v[42:45], a[96:111]
    ds_read_b64 v[72:73], v4 offset:2048
    v_exp_f32 v22, v22
    v_exp_f32 v23, v23
    v_cvt_pk_bf16_f32 v46, v18, v19
    v_cvt_pk_bf16_f32 v47, v20, v21
    ds_read_b64 v[74:75], v4 offset:4096
    v_exp_f32 v24, v24
    v_exp_f32 v25, v25
    v_cvt_pk_bf16_f32 v48, v22, v23
    v_cvt_pk_bf16_f32 v49, v24, v25
    v_exp_f32 v26, v26
    v_exp_f32 v27, v27
    v_mfma_f32_32x32x16_bf16 a[96:111], a[52:55], v[46:49], a[96:111]
    ds_read_b64 v[76:77], v4 offset:6144
    v_exp_f32 v28, v28
    v_exp_f32 v29, v29
    v_exp_f32 v30, v30
    buffer_load_dwordx4 a[112:115], v1, s[8:11], s17 offen offset:0 sc1
    v_exp_f32 v31, v31
    v_exp_f32 v32, v32
    v_exp_f32 v33, v33
    v_mfma_f32_32x32x16_bf16 v[10:25], a[16:19], v[50:53], 0
    ds_read_b64 v[78:79], v4 offset:8192
    v_cvt_pk_bf16_f32 v42, v26, v27
    v_cvt_pk_bf16_f32 v43, v28, v29
    v_cvt_pk_bf16_f32 v44, v30, v31
    v_cvt_pk_bf16_f32 v45, v32, v33
    v_exp_f32 v34, v34
    v_exp_f32 v35, v35
    v_exp_f32 v36, v36
    v_exp_f32 v37, v37
    v_mfma_f32_32x32x16_bf16 a[96:111], a[56:59], v[42:45], a[96:111]
    ds_read_b64 v[80:81], v4 offset:10240
    v_exp_f32 v38, v38
    v_exp_f32 v39, v39
    v_cvt_pk_bf16_f32 v46, v34, v35
    v_cvt_pk_bf16_f32 v47, v36, v37
    buffer_load_dwordx4 a[116:119], v1, s[8:11], s17 offen offset:1024 sc1
    v_exp_f32 v40, v40
    v_exp_f32 v41, v41
    v_cvt_pk_bf16_f32 v48, v38, v39
    v_cvt_pk_bf16_f32 v49, v40, v41
    v_exp_f32 v10, v10
    v_exp_f32 v11, v11
    v_mfma_f32_32x32x16_bf16 a[96:111], a[60:63], v[46:49], a[96:111]
    ds_read_b64 v[82:83], v4 offset:12288
    v_exp_f32 v12, v12
    v_exp_f32 v13, v13
    v_exp_f32 v14, v14
    buffer_load_dwordx4 a[120:123], v1, s[8:11], s17 offen offset:2048 sc1
    v_exp_f32 v15, v15
    v_exp_f32 v16, v16
    v_exp_f32 v17, v17
    v_mfma_f32_32x32x16_bf16 v[26:41], a[20:23], v[50:53], 0
    ds_read_b64 v[84:85], v4 offset:14336
    v_cvt_pk_bf16_f32 v42, v10, v11
    v_cvt_pk_bf16_f32 v43, v12, v13
    v_cvt_pk_bf16_f32 v44, v14, v15
    v_cvt_pk_bf16_f32 v45, v16, v17
    v_exp_f32 v18, v18
    v_exp_f32 v19, v19
    v_exp_f32 v20, v20
    v_exp_f32 v21, v21
    v_mfma_f32_32x32x16_bf16 a[96:111], a[64:67], v[42:45], a[96:111]
    ds_read_b128 v[86:89], v5 offset:16384
    v_exp_f32 v22, v22
    v_exp_f32 v23, v23
    v_cvt_pk_bf16_f32 v46, v18, v19
    v_cvt_pk_bf16_f32 v47, v20, v21
    buffer_load_dwordx4 a[124:127], v1, s[8:11], s17 offen offset:3072 sc1
    v_exp_f32 v24, v24
    v_exp_f32 v25, v25
    v_cvt_pk_bf16_f32 v48, v22, v23
    v_cvt_pk_bf16_f32 v49, v24, v25
    v_exp_f32 v26, v26
    v_exp_f32 v27, v27
    v_mfma_f32_32x32x16_bf16 a[96:111], a[68:71], v[46:49], a[96:111]
    ds_read_b128 v[90:93], v5 offset:16400
    v_exp_f32 v28, v28
    v_exp_f32 v29, v29
    v_exp_f32 v30, v30
    buffer_load_dwordx4 a[128:131], v1, s[8:11], s18 offen offset:0 sc1
    s_setprio 2
    v_exp_f32 v31, v31
    v_exp_f32 v32, v32
    v_exp_f32 v33, v33
    v_mfma_f32_32x32x16_bf16 v[10:25], a[24:27], v[50:53], 0
    s_waitcnt lgkmcnt(0)
    v_pk_add_f32 v[86:87], v[86:87], v[88:89]
    v_pk_add_f32 v[90:91], v[90:91], v[92:93]
    v_pk_add_f32 v[70:71], v[70:71], v[72:73]
    v_pk_add_f32 v[86:87], v[86:87], v[90:91]
    v_pk_add_f32 v[74:75], v[74:75], v[76:77]
    v_pk_add_f32 v[78:79], v[78:79], v[80:81]
    v_add_f32 v86, v86, v87
    v_pk_add_f32 v[82:83], v[82:83], v[84:85]
    v_rcp_f32 v87, v86
    v_cvt_pk_bf16_f32 v42, v26, v27
    v_cvt_pk_bf16_f32 v43, v28, v29
    v_cvt_pk_bf16_f32 v44, v30, v31
    v_cvt_pk_bf16_f32 v45, v32, v33
    v_exp_f32 v34, v34
    v_exp_f32 v35, v35
    v_exp_f32 v36, v36
    v_exp_f32 v37, v37
    v_mfma_f32_32x32x16_bf16 a[96:111], a[72:75], v[42:45], a[96:111]
    v_exp_f32 v38, v38
    v_exp_f32 v39, v39
    v_cvt_pk_bf16_f32 v46, v34, v35
    v_cvt_pk_bf16_f32 v47, v36, v37
    buffer_load_dwordx4 a[132:135], v1, s[8:11], s18 offen offset:1024 sc1
    v_exp_f32 v40, v40
    v_exp_f32 v41, v41
    v_cvt_pk_bf16_f32 v48, v38, v39
    v_cvt_pk_bf16_f32 v49, v40, v41
    v_exp_f32 v10, v10
    v_exp_f32 v11, v11
    v_mfma_f32_32x32x16_bf16 a[96:111], a[76:79], v[46:49], a[96:111]
    v_pk_add_f32 v[70:71], v[70:71], v[74:75]
    v_pk_add_f32 v[78:79], v[78:79], v[82:83]
    v_subrev_u32 v88, s19, v86
    v_pk_add_f32 v[70:71], v[70:71], v[78:79]
    v_cmp_lt_u32 s[26:27], s20, v88
    v_pk_mul_f32 v[70:71], v[70:71], v[86:87] op_sel:[0,1] op_sel_hi:[1,1]
    v_xor_b32 v4, 32768, v4
    v_xor_b32 v5, 32768, v5
    v_cvt_pk_bf16_f32 v70, v70, v71
    s_or_b64 s[24:25], s[24:25], s[26:27]
    ds_write_b32 v6, v70 offset:17408
    v_xor_b32 v6, 32768, v6
    v_exp_f32 v12, v12
    v_exp_f32 v13, v13
    v_exp_f32 v14, v14
    buffer_load_dwordx4 a[136:139], v1, s[8:11], s18 offen offset:2048 sc1
    s_waitcnt vmcnt(12)
    ds_read_b128 v[94:97], v8 offset:6144
    ds_read_b64_tr_b16 v[98:99], v109 offset:0
    ds_read_b64_tr_b16 v[100:101], v109 offset:128
    v_exp_f32 v15, v15
    v_exp_f32 v16, v16
    v_exp_f32 v17, v17
    v_mfma_f32_32x32x16_bf16 v[26:41], a[28:31], v[50:53], 0
    ds_read_b128 v[50:53], v8
    v_add_u32 v8, 1024, v8
    v_cvt_pk_bf16_f32 v42, v10, v11
    v_cvt_pk_bf16_f32 v43, v12, v13
    v_cvt_pk_bf16_f32 v44, v14, v15
    v_cvt_pk_bf16_f32 v45, v16, v17
    v_exp_f32 v18, v18
    v_exp_f32 v19, v19
    v_exp_f32 v20, v20
    v_exp_f32 v21, v21
    v_mfma_f32_32x32x16_bf16 a[96:111], a[80:83], v[42:45], a[96:111]
    v_exp_f32 v22, v22
    v_exp_f32 v23, v23
    v_cvt_pk_bf16_f32 v46, v18, v19
    v_cvt_pk_bf16_f32 v47, v20, v21
    buffer_load_dwordx4 a[140:143], v1, s[8:11], s18 offen offset:3072 sc1
    v_exp_f32 v24, v24
    v_exp_f32 v25, v25
    v_cvt_pk_bf16_f32 v48, v22, v23
    v_cvt_pk_bf16_f32 v49, v24, v25
    v_exp_f32 v26, v26
    v_exp_f32 v27, v27
    v_mfma_f32_32x32x16_bf16 a[96:111], a[84:87], v[46:49], a[96:111]
    v_exp_f32 v28, v28
    v_exp_f32 v29, v29
    v_exp_f32 v30, v30
    s_add_u32 s17, s17, 65536
    s_bitset0_b32 s17, 19
    s_add_u32 s18, s17, 32768
    s_setprio 1
    v_exp_f32 v31, v31
    v_exp_f32 v32, v32
    v_exp_f32 v33, v33
    s_waitcnt lgkmcnt(0)
    v_mfma_f32_32x32x16_bf16 v[10:25], a[0:3], v[50:53], 0
    v_mfma_f32_16x16x32_bf16 v[102:105], v[94:97], v[98:101], 0
    v_cvt_pk_bf16_f32 v42, v26, v27
    v_cvt_pk_bf16_f32 v43, v28, v29
    v_cvt_pk_bf16_f32 v44, v30, v31
    v_cvt_pk_bf16_f32 v45, v32, v33
    v_exp_f32 v34, v34
    v_exp_f32 v35, v35
    v_exp_f32 v36, v36
    v_exp_f32 v37, v37
    v_mfma_f32_32x32x16_bf16 a[96:111], a[88:91], v[42:45], a[96:111]
    v_exp_f32 v38, v38
    v_exp_f32 v39, v39
    v_cvt_pk_bf16_f32 v46, v34, v35
    v_cvt_pk_bf16_f32 v47, v36, v37
    v_add_f32_dpp v102, v103, v102 row_ror:8 row_mask:0xf bank_mask:0xf
    v_exp_f32 v40, v40
    v_exp_f32 v41, v41
    v_cvt_pk_bf16_f32 v48, v38, v39
    v_cvt_pk_bf16_f32 v49, v40, v41
    v_exp_f32 v10, v10
    v_exp_f32 v11, v11
    v_mfma_f32_32x32x16_bf16 a[96:111], a[92:95], v[46:49], a[96:111]
    s_mov_b64 exec, s[58:59]
    ds_write_b32 v110, v102 offset:11008
    s_mov_b64 exec, -1
.loop_fused_kernel_6:
    v_exp_f32 v12, v12
    v_exp_f32 v13, v13
    v_exp_f32 v14, v14
    v_exp_f32 v15, v15
    v_exp_f32 v16, v16
    v_exp_f32 v17, v17
    v_mfma_f32_32x32x16_bf16 v[26:41], a[4:7], v[50:53], 0
    v_cvt_pk_bf16_f32 v42, v10, v11
    v_cvt_pk_bf16_f32 v43, v12, v13
    v_cvt_pk_bf16_f32 v44, v14, v15
    v_cvt_pk_bf16_f32 v45, v16, v17
    v_exp_f32 v18, v18
    v_exp_f32 v19, v19
    v_exp_f32 v20, v20
    v_exp_f32 v21, v21
    ds_write_b128 v2, a[96:99] offset:0
    ds_write_b128 v2, a[100:103] offset:1024
    ds_write_b32 v3, a104 offset:16384
    ds_add_u32 v110, v107 offset:9984
    v_mfma_f32_32x32x16_bf16 a[96:111], a[32:35], v[42:45], 0
    v_xor_b32 v2, 32768, v2
    v_xor_b32 v3, 32768, v3
    s_setprio 0
    v_exp_f32 v22, v22
    v_exp_f32 v23, v23
    v_cvt_pk_bf16_f32 v46, v18, v19
    v_cvt_pk_bf16_f32 v47, v20, v21
    v_exp_f32 v24, v24
    v_exp_f32 v25, v25
    v_cvt_pk_bf16_f32 v48, v22, v23
    v_cvt_pk_bf16_f32 v49, v24, v25
    v_exp_f32 v26, v26
    v_exp_f32 v27, v27
    v_mfma_f32_32x32x16_bf16 a[96:111], a[36:39], v[46:49], a[96:111]
    v_exp_f32 v28, v28
    v_exp_f32 v29, v29
    v_exp_f32 v30, v30
    v_exp_f32 v31, v31
    v_exp_f32 v32, v32
    v_exp_f32 v33, v33
    v_mfma_f32_32x32x16_bf16 v[10:25], a[8:11], v[50:53], 0
    s_mov_b32 m0, s44
    v_cvt_pk_bf16_f32 v42, v26, v27
    v_cvt_pk_bf16_f32 v43, v28, v29
    v_cvt_pk_bf16_f32 v44, v30, v31
    v_cvt_pk_bf16_f32 v45, v32, v33
    v_exp_f32 v34, v34
    v_exp_f32 v35, v35
    v_exp_f32 v36, v36
    v_exp_f32 v37, v37
    v_mfma_f32_32x32x16_bf16 a[96:111], a[40:43], v[42:45], a[96:111]
    ds_read_b32 v111, v110 offset:9984
    buffer_load_dwordx4 v108, s[48:51], s40 offen lds
    s_add_u32 s40, s40, 458752
    s_add_u32 s44, s44, s45
    v_exp_f32 v38, v38
    v_exp_f32 v39, v39
    v_cvt_pk_bf16_f32 v46, v34, v35
    v_cvt_pk_bf16_f32 v47, v36, v37
    buffer_load_dwordx4 v108, s[48:51], s41 offen offset:1024 lds
    s_cmp_eq_u32 s16, 4
    s_cselect_b32 s40, s42, s40
    v_exp_f32 v40, v40
    v_exp_f32 v41, v41
    v_cvt_pk_bf16_f32 v48, v38, v39
    v_cvt_pk_bf16_f32 v49, v40, v41
    v_exp_f32 v10, v10
    v_exp_f32 v11, v11
    v_mfma_f32_32x32x16_bf16 a[96:111], a[44:47], v[46:49], a[96:111]
    s_waitcnt lgkmcnt(0)
    v_cmp_gt_u32 vcc, s60, v111
    s_cselect_b32 s44, s43, s44
    s_cselect_b32 s45, 0, s45
    s_mov_b32 m0, s43
    v_exp_f32 v12, v12
    v_exp_f32 v13, v13
    v_exp_f32 v14, v14
.sbc_fused_kernel_52:
    s_cbranch_vccnz .sbs_fused_kernel_53
    s_add_u32 s60, s60, 8
    ds_read_b128 v[94:97], v7 offset:17408
    ds_read_b128 v[98:101], v7 offset:17920
    v_xor_b32 v7, 32768, v7
    buffer_load_dword v9, s[52:55], s39 offen lds
    s_add_u32 s39, s39, 10240
    s_add_u32 s41, s40, 27648
    v_exp_f32 v15, v15
    v_exp_f32 v16, v16
    v_exp_f32 v17, v17
    v_mfma_f32_32x32x16_bf16 v[26:41], a[12:15], v[50:53], 0
    ds_read_b64 v[70:71], v4 offset:0
    s_setprio 3
    v_cvt_pk_bf16_f32 v42, v10, v11
    v_cvt_pk_bf16_f32 v43, v12, v13
    v_cvt_pk_bf16_f32 v44, v14, v15
    v_cvt_pk_bf16_f32 v45, v16, v17
    v_exp_f32 v18, v18
    v_exp_f32 v19, v19
    v_exp_f32 v20, v20
    v_exp_f32 v21, v21
    v_mfma_f32_32x32x16_bf16 a[96:111], a[48:51], v[42:45], a[96:111]
    ds_read_b64 v[72:73], v4 offset:2048
    v_exp_f32 v22, v22
    v_exp_f32 v23, v23
    v_cvt_pk_bf16_f32 v46, v18, v19
    v_cvt_pk_bf16_f32 v47, v20, v21
    ds_read_b64 v[74:75], v4 offset:4096
    v_exp_f32 v24, v24
    v_exp_f32 v25, v25
    v_cvt_pk_bf16_f32 v48, v22, v23
    v_cvt_pk_bf16_f32 v49, v24, v25
    v_exp_f32 v26, v26
    v_exp_f32 v27, v27
    v_mfma_f32_32x32x16_bf16 a[96:111], a[52:55], v[46:49], a[96:111]
    ds_read_b64 v[76:77], v4 offset:6144
    v_exp_f32 v28, v28
    v_exp_f32 v29, v29
    v_exp_f32 v30, v30
    s_waitcnt lgkmcnt(4)
    s_waitcnt vmcnt(10)
    v_mfma_f32_16x16x32_bf16 v[54:57], a[112:115], v[94:97], v[54:57]
    buffer_load_dwordx4 a[112:115], v1, s[8:11], s17 offen offset:0 sc1
    v_exp_f32 v31, v31
    v_exp_f32 v32, v32
    v_exp_f32 v33, v33
    v_mfma_f32_32x32x16_bf16 v[10:25], a[16:19], v[50:53], 0
    ds_read_b64 v[78:79], v4 offset:8192
    v_cvt_pk_bf16_f32 v42, v26, v27
    v_cvt_pk_bf16_f32 v43, v28, v29
    v_cvt_pk_bf16_f32 v44, v30, v31
    v_cvt_pk_bf16_f32 v45, v32, v33
    v_exp_f32 v34, v34
    v_exp_f32 v35, v35
    v_exp_f32 v36, v36
    v_exp_f32 v37, v37
    v_mfma_f32_32x32x16_bf16 a[96:111], a[56:59], v[42:45], a[96:111]
    ds_read_b64 v[80:81], v4 offset:10240
    v_exp_f32 v38, v38
    v_exp_f32 v39, v39
    v_cvt_pk_bf16_f32 v46, v34, v35
    v_cvt_pk_bf16_f32 v47, v36, v37
    s_waitcnt vmcnt(10)
    v_mfma_f32_16x16x32_bf16 v[58:61], a[116:119], v[94:97], v[58:61]
    buffer_load_dwordx4 a[116:119], v1, s[8:11], s17 offen offset:1024 sc1
    v_exp_f32 v40, v40
    v_exp_f32 v41, v41
    v_cvt_pk_bf16_f32 v48, v38, v39
    v_cvt_pk_bf16_f32 v49, v40, v41
    v_exp_f32 v10, v10
    v_exp_f32 v11, v11
    v_mfma_f32_32x32x16_bf16 a[96:111], a[60:63], v[46:49], a[96:111]
    ds_read_b64 v[82:83], v4 offset:12288
    v_exp_f32 v12, v12
    v_exp_f32 v13, v13
    v_exp_f32 v14, v14
    s_waitcnt vmcnt(10)
    v_mfma_f32_16x16x32_bf16 v[62:65], a[120:123], v[94:97], v[62:65]
    buffer_load_dwordx4 a[120:123], v1, s[8:11], s17 offen offset:2048 sc1
    v_exp_f32 v15, v15
    v_exp_f32 v16, v16
    v_exp_f32 v17, v17
    v_mfma_f32_32x32x16_bf16 v[26:41], a[20:23], v[50:53], 0
    ds_read_b64 v[84:85], v4 offset:14336
    v_cvt_pk_bf16_f32 v42, v10, v11
    v_cvt_pk_bf16_f32 v43, v12, v13
    v_cvt_pk_bf16_f32 v44, v14, v15
    v_cvt_pk_bf16_f32 v45, v16, v17
    v_exp_f32 v18, v18
    v_exp_f32 v19, v19
    v_exp_f32 v20, v20
    v_exp_f32 v21, v21
    v_mfma_f32_32x32x16_bf16 a[96:111], a[64:67], v[42:45], a[96:111]
    ds_read_b128 v[86:89], v5 offset:16384
    v_exp_f32 v22, v22
    v_exp_f32 v23, v23
    v_cvt_pk_bf16_f32 v46, v18, v19
    v_cvt_pk_bf16_f32 v47, v20, v21
    s_waitcnt vmcnt(10)
    v_mfma_f32_16x16x32_bf16 v[66:69], a[124:127], v[94:97], v[66:69]
    buffer_load_dwordx4 a[124:127], v1, s[8:11], s17 offen offset:3072 sc1
    v_exp_f32 v24, v24
    v_exp_f32 v25, v25
    v_cvt_pk_bf16_f32 v48, v22, v23
    v_cvt_pk_bf16_f32 v49, v24, v25
    v_exp_f32 v26, v26
    v_exp_f32 v27, v27
    v_mfma_f32_32x32x16_bf16 a[96:111], a[68:71], v[46:49], a[96:111]
    ds_read_b128 v[90:93], v5 offset:16400
    v_exp_f32 v28, v28
    v_exp_f32 v29, v29
    v_exp_f32 v30, v30
    s_waitcnt vmcnt(10)
    v_mfma_f32_16x16x32_bf16 v[54:57], a[128:131], v[98:101], v[54:57]
    buffer_load_dwordx4 a[128:131], v1, s[8:11], s18 offen offset:0 sc1
    s_setprio 2
    v_exp_f32 v31, v31
    v_exp_f32 v32, v32
    v_exp_f32 v33, v33
    v_mfma_f32_32x32x16_bf16 v[10:25], a[24:27], v[50:53], 0
    s_waitcnt lgkmcnt(0)
    v_pk_add_f32 v[86:87], v[86:87], v[88:89]
    v_pk_add_f32 v[90:91], v[90:91], v[92:93]
    v_pk_add_f32 v[70:71], v[70:71], v[72:73]
    v_pk_add_f32 v[86:87], v[86:87], v[90:91]
    v_pk_add_f32 v[74:75], v[74:75], v[76:77]
    v_pk_add_f32 v[78:79], v[78:79], v[80:81]
    v_add_f32 v86, v86, v87
    v_pk_add_f32 v[82:83], v[82:83], v[84:85]
    v_rcp_f32 v87, v86
    v_cvt_pk_bf16_f32 v42, v26, v27
    v_cvt_pk_bf16_f32 v43, v28, v29
    v_cvt_pk_bf16_f32 v44, v30, v31
    v_cvt_pk_bf16_f32 v45, v32, v33
    v_exp_f32 v34, v34
    v_exp_f32 v35, v35
    v_exp_f32 v36, v36
    v_exp_f32 v37, v37
    v_mfma_f32_32x32x16_bf16 a[96:111], a[72:75], v[42:45], a[96:111]
    v_exp_f32 v38, v38
    v_exp_f32 v39, v39
    v_cvt_pk_bf16_f32 v46, v34, v35
    v_cvt_pk_bf16_f32 v47, v36, v37
    s_waitcnt vmcnt(10)
    v_mfma_f32_16x16x32_bf16 v[58:61], a[132:135], v[98:101], v[58:61]
    buffer_load_dwordx4 a[132:135], v1, s[8:11], s18 offen offset:1024 sc1
    v_exp_f32 v40, v40
    v_exp_f32 v41, v41
    v_cvt_pk_bf16_f32 v48, v38, v39
    v_cvt_pk_bf16_f32 v49, v40, v41
    v_exp_f32 v10, v10
    v_exp_f32 v11, v11
    v_mfma_f32_32x32x16_bf16 a[96:111], a[76:79], v[46:49], a[96:111]
    v_pk_add_f32 v[70:71], v[70:71], v[74:75]
    v_pk_add_f32 v[78:79], v[78:79], v[82:83]
    v_subrev_u32 v88, s19, v86
    v_pk_add_f32 v[70:71], v[70:71], v[78:79]
    v_cmp_lt_u32 s[26:27], s20, v88
    v_pk_mul_f32 v[70:71], v[70:71], v[86:87] op_sel:[0,1] op_sel_hi:[1,1]
    v_xor_b32 v4, 32768, v4
    v_xor_b32 v5, 32768, v5
    v_cvt_pk_bf16_f32 v70, v70, v71
    s_or_b64 s[24:25], s[24:25], s[26:27]
    ds_write_b32 v6, v70 offset:17408
    v_xor_b32 v6, 32768, v6
    v_exp_f32 v12, v12
    v_exp_f32 v13, v13
    v_exp_f32 v14, v14
    s_waitcnt vmcnt(10)
    v_mfma_f32_16x16x32_bf16 v[62:65], a[136:139], v[98:101], v[62:65]
    buffer_load_dwordx4 a[136:139], v1, s[8:11], s18 offen offset:2048 sc1
    v_exp_f32 v15, v15
    v_exp_f32 v16, v16
    v_exp_f32 v17, v17
    v_mfma_f32_32x32x16_bf16 v[26:41], a[28:31], v[50:53], 0
    ds_read_b128 v[50:53], v8
    v_add_u32 v8, 1024, v8
    v_cvt_pk_bf16_f32 v42, v10, v11
    v_cvt_pk_bf16_f32 v43, v12, v13
    v_cvt_pk_bf16_f32 v44, v14, v15
    v_cvt_pk_bf16_f32 v45, v16, v17
    v_exp_f32 v18, v18
    v_exp_f32 v19, v19
    v_exp_f32 v20, v20
    v_exp_f32 v21, v21
    v_mfma_f32_32x32x16_bf16 a[96:111], a[80:83], v[42:45], a[96:111]
    v_exp_f32 v22, v22
    v_exp_f32 v23, v23
    v_cvt_pk_bf16_f32 v46, v18, v19
    v_cvt_pk_bf16_f32 v47, v20, v21
    s_waitcnt vmcnt(10)
    v_mfma_f32_16x16x32_bf16 v[66:69], a[140:143], v[98:101], v[66:69]
    buffer_load_dwordx4 a[140:143], v1, s[8:11], s18 offen offset:3072 sc1
    v_exp_f32 v24, v24
    v_exp_f32 v25, v25
    v_cvt_pk_bf16_f32 v48, v22, v23
    v_cvt_pk_bf16_f32 v49, v24, v25
    v_exp_f32 v26, v26
    v_exp_f32 v27, v27
    v_mfma_f32_32x32x16_bf16 a[96:111], a[84:87], v[46:49], a[96:111]
    v_exp_f32 v28, v28
    v_exp_f32 v29, v29
    v_exp_f32 v30, v30
    s_add_u32 s17, s17, 65536
    s_bitset0_b32 s17, 19
    s_add_u32 s18, s17, 32768
    s_setprio 1
    v_exp_f32 v31, v31
    v_exp_f32 v32, v32
    v_exp_f32 v33, v33
    s_waitcnt lgkmcnt(0)
    v_mfma_f32_32x32x16_bf16 v[10:25], a[0:3], v[50:53], 0
    v_cvt_pk_bf16_f32 v42, v26, v27
    v_cvt_pk_bf16_f32 v43, v28, v29
    v_cvt_pk_bf16_f32 v44, v30, v31
    v_cvt_pk_bf16_f32 v45, v32, v33
    v_exp_f32 v34, v34
    v_exp_f32 v35, v35
    v_exp_f32 v36, v36
    v_exp_f32 v37, v37
    v_mfma_f32_32x32x16_bf16 a[96:111], a[88:91], v[42:45], a[96:111]
    v_exp_f32 v38, v38
    v_exp_f32 v39, v39
    v_cvt_pk_bf16_f32 v46, v34, v35
    v_cvt_pk_bf16_f32 v47, v36, v37
    v_exp_f32 v40, v40
    v_exp_f32 v41, v41
    v_cvt_pk_bf16_f32 v48, v38, v39
    v_cvt_pk_bf16_f32 v49, v40, v41
    v_exp_f32 v10, v10
    v_exp_f32 v11, v11
    v_mfma_f32_32x32x16_bf16 a[96:111], a[92:95], v[46:49], a[96:111]
    s_add_u32 s16, s16, 1
    s_cmp_lt_u32 s16, 7
    s_cbranch_scc1 .loop_fused_kernel_6
    v_exp_f32 v12, v12
    v_exp_f32 v13, v13
    v_exp_f32 v14, v14
    v_exp_f32 v15, v15
    v_exp_f32 v16, v16
    v_exp_f32 v17, v17
    v_mfma_f32_32x32x16_bf16 v[26:41], a[4:7], v[50:53], 0
    buffer_load_dwordx4 v[102:105], v1, s[8:11], s57 offen sc1
    s_add_u32 s58, s17, 65536
    s_bitset0_b32 s58, 19
    s_add_u32 s59, s58, 32768
    v_cvt_pk_bf16_f32 v42, v10, v11
    v_cvt_pk_bf16_f32 v43, v12, v13
    v_cvt_pk_bf16_f32 v44, v14, v15
    v_cvt_pk_bf16_f32 v45, v16, v17
    v_exp_f32 v18, v18
    v_exp_f32 v19, v19
    v_exp_f32 v20, v20
    v_exp_f32 v21, v21
    ds_write_b128 v2, a[96:99] offset:0
    ds_write_b128 v2, a[100:103] offset:1024
    ds_write_b32 v3, a104 offset:16384
    ds_add_u32 v110, v107 offset:9984
    v_mfma_f32_32x32x16_bf16 a[96:111], a[32:35], v[42:45], 0
    v_xor_b32 v2, 32768, v2
    v_xor_b32 v3, 32768, v3
    s_setprio 0
    v_exp_f32 v22, v22
    v_exp_f32 v23, v23
    v_cvt_pk_bf16_f32 v46, v18, v19
    v_cvt_pk_bf16_f32 v47, v20, v21
    v_and_b32 v109, 124, v110
    buffer_load_dword v109, v109, s[8:11], s38 offen sc1
    s_add_u32 s35, s33, 73728
    v_exp_f32 v24, v24
    v_exp_f32 v25, v25
    v_cvt_pk_bf16_f32 v48, v22, v23
    v_cvt_pk_bf16_f32 v49, v24, v25
    v_exp_f32 v26, v26
    v_exp_f32 v27, v27
    v_mfma_f32_32x32x16_bf16 a[96:111], a[36:39], v[46:49], a[96:111]
    v_exp_f32 v28, v28
    v_exp_f32 v29, v29
    v_exp_f32 v30, v30
    v_exp_f32 v31, v31
    v_exp_f32 v32, v32
    v_exp_f32 v33, v33
    v_mfma_f32_32x32x16_bf16 v[10:25], a[8:11], v[50:53], 0
    v_cvt_pk_bf16_f32 v42, v26, v27
    v_cvt_pk_bf16_f32 v43, v28, v29
    v_cvt_pk_bf16_f32 v44, v30, v31
    v_cvt_pk_bf16_f32 v45, v32, v33
    v_exp_f32 v34, v34
    v_exp_f32 v35, v35
    v_exp_f32 v36, v36
    v_exp_f32 v37, v37
    v_mfma_f32_32x32x16_bf16 a[96:111], a[40:43], v[42:45], a[96:111]
    ds_read_b32 v111, v110 offset:9984
    buffer_load_dwordx4 a[32:35], v1, s[8:11], s58 offen offset:0 sc1
    v_exp_f32 v38, v38
    v_exp_f32 v39, v39
    v_cvt_pk_bf16_f32 v46, v34, v35
    v_cvt_pk_bf16_f32 v47, v36, v37
    v_exp_f32 v40, v40
    v_exp_f32 v41, v41
    v_cvt_pk_bf16_f32 v48, v38, v39
    v_cvt_pk_bf16_f32 v49, v40, v41
    v_exp_f32 v10, v10
    v_exp_f32 v11, v11
    v_mfma_f32_32x32x16_bf16 a[96:111], a[44:47], v[46:49], a[96:111]
    s_waitcnt lgkmcnt(0)
    v_cmp_gt_u32 vcc, s60, v111
    buffer_load_dwordx4 a[36:39], v1, s[8:11], s58 offen offset:1024 sc1
    v_exp_f32 v12, v12
    v_exp_f32 v13, v13
    v_exp_f32 v14, v14
.sbc_fused_kernel_54:
    s_nop 0
    s_cbranch_vccnz .sbs_fused_kernel_55
    s_add_u32 s60, s60, 8
    ds_read_b128 v[94:97], v7 offset:17408
    ds_read_b128 v[98:101], v7 offset:17920
    v_xor_b32 v7, 32768, v7
    v_exp_f32 v15, v15
    v_exp_f32 v16, v16
    v_exp_f32 v17, v17
    v_mfma_f32_32x32x16_bf16 v[26:41], a[12:15], v[50:53], 0
    ds_read_b64 v[70:71], v4 offset:0
    s_setprio 3
    v_cvt_pk_bf16_f32 v42, v10, v11
    v_cvt_pk_bf16_f32 v43, v12, v13
    v_cvt_pk_bf16_f32 v44, v14, v15
    v_cvt_pk_bf16_f32 v45, v16, v17
    v_exp_f32 v18, v18
    v_exp_f32 v19, v19
    v_exp_f32 v20, v20
    v_exp_f32 v21, v21
    v_mfma_f32_32x32x16_bf16 a[96:111], a[48:51], v[42:45], a[96:111]
    ds_read_b64 v[72:73], v4 offset:2048
    buffer_load_dwordx4 a[40:43], v1, s[8:11], s58 offen offset:2048 sc1
    v_exp_f32 v22, v22
    v_exp_f32 v23, v23
    v_cvt_pk_bf16_f32 v46, v18, v19
    v_cvt_pk_bf16_f32 v47, v20, v21
    ds_read_b64 v[74:75], v4 offset:4096
    v_exp_f32 v24, v24
    v_exp_f32 v25, v25
    v_cvt_pk_bf16_f32 v48, v22, v23
    v_cvt_pk_bf16_f32 v49, v24, v25
    v_exp_f32 v26, v26
    v_exp_f32 v27, v27
    v_mfma_f32_32x32x16_bf16 a[96:111], a[52:55], v[46:49], a[96:111]
    ds_read_b64 v[76:77], v4 offset:6144
    buffer_load_dwordx4 a[44:47], v1, s[8:11], s58 offen offset:3072 sc1
    v_exp_f32 v28, v28
    v_exp_f32 v29, v29
    v_exp_f32 v30, v30
    s_waitcnt lgkmcnt(4)
    s_waitcnt vmcnt(13)
    v_mfma_f32_16x16x32_bf16 v[54:57], a[112:115], v[94:97], v[54:57]
    buffer_load_dwordx4 a[112:115], v1, s[8:11], s17 offen offset:0 sc1
    v_exp_f32 v31, v31
    v_exp_f32 v32, v32
    v_exp_f32 v33, v33
    v_mfma_f32_32x32x16_bf16 v[10:25], a[16:19], v[50:53], 0
    ds_read_b64 v[78:79], v4 offset:8192
    v_cvt_pk_bf16_f32 v42, v26, v27
    v_cvt_pk_bf16_f32 v43, v28, v29
    v_cvt_pk_bf16_f32 v44, v30, v31
    v_cvt_pk_bf16_f32 v45, v32, v33
    v_exp_f32 v34, v34
    v_exp_f32 v35, v35
    v_exp_f32 v36, v36
    v_exp_f32 v37, v37
    v_mfma_f32_32x32x16_bf16 a[96:111], a[56:59], v[42:45], a[96:111]
    ds_read_b64 v[80:81], v4 offset:10240
    buffer_load_dwordx4 a[48:51], v1, s[8:11], s59 offen offset:0 sc1
    v_exp_f32 v38, v38
    v_exp_f32 v39, v39
    v_cvt_pk_bf16_f32 v46, v34, v35
    v_cvt_pk_bf16_f32 v47, v36, v37
    s_waitcnt vmcnt(14)
    v_mfma_f32_16x16x32_bf16 v[58:61], a[116:119], v[94:97], v[58:61]
    buffer_load_dwordx4 a[116:119], v1, s[8:11], s17 offen offset:1024 sc1
    v_exp_f32 v40, v40
    v_exp_f32 v41, v41
    v_cvt_pk_bf16_f32 v48, v38, v39
    v_cvt_pk_bf16_f32 v49, v40, v41
    v_exp_f32 v10, v10
    v_exp_f32 v11, v11
    v_mfma_f32_32x32x16_bf16 a[96:111], a[60:63], v[46:49], a[96:111]
    ds_read_b64 v[82:83], v4 offset:12288
    v_exp_f32 v12, v12
    v_exp_f32 v13, v13
    v_exp_f32 v14, v14
    s_waitcnt vmcnt(14)
    v_mfma_f32_16x16x32_bf16 v[62:65], a[120:123], v[94:97], v[62:65]
    buffer_load_dwordx4 a[120:123], v1, s[8:11], s17 offen offset:2048 sc1
    v_exp_f32 v15, v15
    v_exp_f32 v16, v16
    v_exp_f32 v17, v17
    v_mfma_f32_32x32x16_bf16 v[26:41], a[20:23], v[50:53], 0
    ds_read_b64 v[84:85], v4 offset:14336
    v_cvt_pk_bf16_f32 v42, v10, v11
    v_cvt_pk_bf16_f32 v43, v12, v13
    v_cvt_pk_bf16_f32 v44, v14, v15
    v_cvt_pk_bf16_f32 v45, v16, v17
    v_exp_f32 v18, v18
    v_exp_f32 v19, v19
    v_exp_f32 v20, v20
    v_exp_f32 v21, v21
    v_mfma_f32_32x32x16_bf16 a[96:111], a[64:67], v[42:45], a[96:111]
    ds_read_b128 v[86:89], v5 offset:16384
    buffer_load_dwordx4 a[52:55], v1, s[8:11], s59 offen offset:1024 sc1
    v_exp_f32 v22, v22
    v_exp_f32 v23, v23
    v_cvt_pk_bf16_f32 v46, v18, v19
    v_cvt_pk_bf16_f32 v47, v20, v21
    s_waitcnt vmcnt(15)
    v_mfma_f32_16x16x32_bf16 v[66:69], a[124:127], v[94:97], v[66:69]
    buffer_load_dwordx4 a[124:127], v1, s[8:11], s17 offen offset:3072 sc1
    v_exp_f32 v24, v24
    v_exp_f32 v25, v25
    v_cvt_pk_bf16_f32 v48, v22, v23
    v_cvt_pk_bf16_f32 v49, v24, v25
    v_exp_f32 v26, v26
    v_exp_f32 v27, v27
    v_mfma_f32_32x32x16_bf16 a[96:111], a[68:71], v[46:49], a[96:111]
    ds_read_b128 v[90:93], v5 offset:16400
    v_exp_f32 v28, v28
    v_exp_f32 v29, v29
    v_exp_f32 v30, v30
    s_waitcnt vmcnt(15)
    v_mfma_f32_16x16x32_bf16 v[54:57], a[128:131], v[98:101], v[54:57]
    buffer_load_dwordx4 a[128:131], v1, s[8:11], s18 offen offset:0 sc1
    s_setprio 2
    v_exp_f32 v31, v31
    v_exp_f32 v32, v32
    v_exp_f32 v33, v33
    v_mfma_f32_32x32x16_bf16 v[10:25], a[24:27], v[50:53], 0
    s_waitcnt lgkmcnt(0)
    v_pk_add_f32 v[86:87], v[86:87], v[88:89]
    v_pk_add_f32 v[90:91], v[90:91], v[92:93]
    v_pk_add_f32 v[70:71], v[70:71], v[72:73]
    v_pk_add_f32 v[86:87], v[86:87], v[90:91]
    v_pk_add_f32 v[74:75], v[74:75], v[76:77]
    v_pk_add_f32 v[78:79], v[78:79], v[80:81]
    v_add_f32 v86, v86, v87
    v_pk_add_f32 v[82:83], v[82:83], v[84:85]
    v_rcp_f32 v87, v86
    v_cvt_pk_bf16_f32 v42, v26, v27
    v_cvt_pk_bf16_f32 v43, v28, v29
    v_cvt_pk_bf16_f32 v44, v30, v31
    v_cvt_pk_bf16_f32 v45, v32, v33
    v_exp_f32 v34, v34
    v_exp_f32 v35, v35
    v_exp_f32 v36, v36
    v_exp_f32 v37, v37
    v_mfma_f32_32x32x16_bf16 a[96:111], a[72:75], v[42:45], a[96:111]
    buffer_load_dwordx4 a[56:59], v1, s[8:11], s59 offen offset:2048 sc1
    v_exp_f32 v38, v38
    v_exp_f32 v39, v39
    v_cvt_pk_bf16_f32 v46, v34, v35
    v_cvt_pk_bf16_f32 v47, v36, v37
    s_waitcnt vmcnt(16)
    v_mfma_f32_16x16x32_bf16 v[58:61], a[132:135], v[98:101], v[58:61]
    buffer_load_dwordx4 a[132:135], v1, s[8:11], s18 offen offset:1024 sc1
    v_exp_f32 v40, v40
    v_exp_f32 v41, v41
    v_cvt_pk_bf16_f32 v48, v38, v39
    v_cvt_pk_bf16_f32 v49, v40, v41
    v_exp_f32 v10, v10
    v_exp_f32 v11, v11
    v_mfma_f32_32x32x16_bf16 a[96:111], a[76:79], v[46:49], a[96:111]
    v_pk_add_f32 v[70:71], v[70:71], v[74:75]
    v_pk_add_f32 v[78:79], v[78:79], v[82:83]
    v_subrev_u32 v88, s19, v86
    v_pk_add_f32 v[70:71], v[70:71], v[78:79]
    v_cmp_lt_u32 s[26:27], s20, v88
    v_pk_mul_f32 v[70:71], v[70:71], v[86:87] op_sel:[0,1] op_sel_hi:[1,1]
    v_xor_b32 v4, 32768, v4
    v_xor_b32 v5, 32768, v5
    v_cvt_pk_bf16_f32 v70, v70, v71
    s_or_b64 s[24:25], s[24:25], s[26:27]
    ds_write_b32 v6, v70 offset:17408
    v_xor_b32 v6, 32768, v6
    v_exp_f32 v12, v12
    v_exp_f32 v13, v13
    v_exp_f32 v14, v14
    s_waitcnt vmcnt(16)
    v_mfma_f32_16x16x32_bf16 v[62:65], a[136:139], v[98:101], v[62:65]
    buffer_load_dwordx4 a[136:139], v1, s[8:11], s18 offen offset:2048 sc1
    v_exp_f32 v15, v15
    v_exp_f32 v16, v16
    v_exp_f32 v17, v17
    v_mfma_f32_32x32x16_bf16 v[26:41], a[28:31], v[50:53], 0
    v_cvt_pk_bf16_f32 v42, v10, v11
    v_cvt_pk_bf16_f32 v43, v12, v13
    v_cvt_pk_bf16_f32 v44, v14, v15
    v_cvt_pk_bf16_f32 v45, v16, v17
    v_exp_f32 v18, v18
    v_exp_f32 v19, v19
    v_exp_f32 v20, v20
    v_exp_f32 v21, v21
    v_mfma_f32_32x32x16_bf16 a[96:111], a[80:83], v[42:45], a[96:111]
    buffer_load_dwordx4 a[60:63], v1, s[8:11], s59 offen offset:3072 sc1
    v_exp_f32 v22, v22
    v_exp_f32 v23, v23
    v_cvt_pk_bf16_f32 v46, v18, v19
    v_cvt_pk_bf16_f32 v47, v20, v21
    s_waitcnt vmcnt(17)
    v_mfma_f32_16x16x32_bf16 v[66:69], a[140:143], v[98:101], v[66:69]
    buffer_load_dwordx4 a[140:143], v1, s[8:11], s18 offen offset:3072 sc1
    v_exp_f32 v24, v24
    v_exp_f32 v25, v25
    v_cvt_pk_bf16_f32 v48, v22, v23
    v_cvt_pk_bf16_f32 v49, v24, v25
    v_exp_f32 v26, v26
    v_exp_f32 v27, v27
    v_mfma_f32_32x32x16_bf16 a[96:111], a[84:87], v[46:49], a[96:111]
    s_waitcnt vmcnt(17)
    v_min3_u32 v111, v102, v103, v104
    v_min_u32 v111, v111, v105
    v_cmp_eq_u32 vcc, 0, v111
    v_add_u32 v8, s35, v1
    v_exp_f32 v28, v28
    v_exp_f32 v29, v29
    v_exp_f32 v30, v30
    s_setprio 1
    v_exp_f32 v31, v31
    v_exp_f32 v32, v32
    v_exp_f32 v33, v33
    s_cbranch_vccnz .modspin_fused_kernel_57
.modchk_fused_kernel_56:
    s_mov_b32 exec_hi, 0xffff
    ds_write_b128 v8, v[102:105]
    s_mov_b32 exec_hi, -1
    v_cvt_pk_bf16_f32 v42, v26, v27
    v_cvt_pk_bf16_f32 v43, v28, v29
    v_cvt_pk_bf16_f32 v44, v30, v31
    v_cvt_pk_bf16_f32 v45, v32, v33
    v_exp_f32 v34, v34
    v_exp_f32 v35, v35
    v_exp_f32 v36, v36
    v_exp_f32 v37, v37
    v_mfma_f32_32x32x16_bf16 a[96:111], a[88:91], v[42:45], a[96:111]
    v_exp_f32 v38, v38
    v_exp_f32 v39, v39
    v_cvt_pk_bf16_f32 v46, v34, v35
    v_cvt_pk_bf16_f32 v47, v36, v37
    v_exp_f32 v40, v40
    v_exp_f32 v41, v41
    v_cvt_pk_bf16_f32 v48, v38, v39
    v_cvt_pk_bf16_f32 v49, v40, v41
    s_nop 1
    v_mfma_f32_32x32x16_bf16 a[96:111], a[92:95], v[46:49], a[96:111]
    s_branch .tail_fused_kernel_48
.sbs_fused_kernel_51:
    s_sleep 1
    ds_read_b32 v111, v110 offset:9984
    s_waitcnt lgkmcnt(0)
    v_cmp_gt_u32 vcc, s60, v111
    s_nop 4
    s_branch .sbc_fused_kernel_50
.sbs_fused_kernel_53:
    s_sleep 1
    ds_read_b32 v111, v110 offset:9984
    s_waitcnt lgkmcnt(0)
    v_cmp_gt_u32 vcc, s60, v111
    s_nop 4
    s_branch .sbc_fused_kernel_52
.sbs_fused_kernel_55:
    s_sleep 1
    ds_read_b32 v111, v110 offset:9984
    s_waitcnt lgkmcnt(0)
    v_cmp_gt_u32 vcc, s60, v111
    s_nop 4
    s_branch .sbc_fused_kernel_54
.sbs_fused_kernel_60:
    s_sleep 1
    ds_read_b32 v111, v110 offset:9984
    s_waitcnt lgkmcnt(0)
    v_cmp_gt_u32 vcc, s60, v111
    s_nop 4
    s_branch .sbc_fused_kernel_59
.sbs_fused_kernel_62:
    s_sleep 1
    ds_read_b32 v111, v110 offset:9984
    s_waitcnt lgkmcnt(0)
    v_cmp_gt_u32 vcc, s60, v111
    s_nop 4
    s_branch .sbc_fused_kernel_61
.sbs_fused_kernel_64:
    s_sleep 1
    ds_read_b32 v111, v110 offset:9984
    s_waitcnt lgkmcnt(0)
    v_cmp_gt_u32 vcc, s60, v111
    s_nop 4
    s_branch .sbc_fused_kernel_63
.w7_fused_kernel_7:
    s_cmp_lg_u32 s16, 2
    s_cbranch_scc1 .fin_fused_kernel_68
    ds_read_b32 v70, v110 offset:11008
    ds_read_b32 v71, v110 offset:12032
    s_bfe_u32 s34, s21, 0x30003
    s_lshl_b32 s34, s34, 10
    s_and_b32 s35, s21, 7
    s_lshl_b32 s35, s35, 5
    s_add_u32 s34, s34, s35
    s_and_b32 s35, s21, 64
    s_lshl_b32 s35, s35, 3
    s_add_u32 s34, s34, s35
    s_and_b32 s35, s21, 128
    s_lshl_b32 s35, s35, 1
    s_add_u32 s34, s34, s35
    s_add_u32 s34, s34, 5341184
    s_lshr_b32 s35, s21, 6
    s_cmp_eq_u32 s35, 2
    s_cselect_b32 s58, 1.0, 0
    s_cmp_eq_u32 s35, 0
    s_cselect_b32 s59, 1.0, 0x3fb8aa3b
    s_cmp_eq_u32 s35, 3
    s_cselect_b32 s59, 0x3f317218, s59
    s_branch .w7r_fused_kernel_9
.fin_fused_kernel_68:
    v_add_f32 v70, v70, v71
    v_mov_b32 v71, v70
    s_nop 1
    v_permlane32_swap_b32 v70, v71
    v_add_f32 v70, v70, v71
    v_mov_b32 v71, v70
    s_nop 1
    v_permlane16_swap_b32 v70, v71
    v_add_f32 v70, v70, v71
    v_cvt_pk_bf16_f32 v70, v70, v70
    v_lshlrev_b32 v70, 16, v70
    v_add_f32 v70, s58, v70
    v_cvt_pk_bf16_f32 v70, v70, v70
    v_lshlrev_b32 v70, 16, v70
    v_mul_f32 v70, s59, v70
    v_or_b32 v70, 1, v70
    s_mov_b64 exec, 0xff
    buffer_store_dword v70, v110, s[8:11], s34 offen sc1
    s_mov_b64 exec, -1
    s_branch .w7r_fused_kernel_9
.nr_fused_kernel_49:
    v_exp_f32 v12, v12
    v_exp_f32 v13, v13
    v_exp_f32 v14, v14
    v_exp_f32 v15, v15
    v_exp_f32 v16, v16
    v_exp_f32 v17, v17
    v_mfma_f32_32x32x16_bf16 v[26:41], a[4:7], v[50:53], 0
    v_cvt_pk_bf16_f32 v42, v10, v11
    v_cvt_pk_bf16_f32 v43, v12, v13
    v_cvt_pk_bf16_f32 v44, v14, v15
    v_cvt_pk_bf16_f32 v45, v16, v17
    v_exp_f32 v18, v18
    v_exp_f32 v19, v19
    v_exp_f32 v20, v20
    v_exp_f32 v21, v21
    ds_write_b128 v2, a[96:99] offset:0
    ds_write_b128 v2, a[100:103] offset:1024
    ds_write_b32 v3, a104 offset:16384
    ds_add_u32 v110, v107 offset:9984
    v_mfma_f32_32x32x16_bf16 a[96:111], a[32:35], v[42:45], 0
    v_xor_b32 v2, 32768, v2
    v_xor_b32 v3, 32768, v3
    s_setprio 0
    v_exp_f32 v22, v22
    v_exp_f32 v23, v23
    v_cvt_pk_bf16_f32 v46, v18, v19
    v_cvt_pk_bf16_f32 v47, v20, v21
    v_exp_f32 v24, v24
    v_exp_f32 v25, v25
    v_cvt_pk_bf16_f32 v48, v22, v23
    v_cvt_pk_bf16_f32 v49, v24, v25
    v_exp_f32 v26, v26
    v_exp_f32 v27, v27
    v_mfma_f32_32x32x16_bf16 a[96:111], a[36:39], v[46:49], a[96:111]
    v_exp_f32 v28, v28
    v_exp_f32 v29, v29
    v_exp_f32 v30, v30
    v_exp_f32 v31, v31
    v_exp_f32 v32, v32
    v_exp_f32 v33, v33
    v_mfma_f32_32x32x16_bf16 v[10:25], a[8:11], v[50:53], 0
    s_mov_b32 m0, s44
    v_cvt_pk_bf16_f32 v42, v26, v27
    v_cvt_pk_bf16_f32 v43, v28, v29
    v_cvt_pk_bf16_f32 v44, v30, v31
    v_cvt_pk_bf16_f32 v45, v32, v33
    v_exp_f32 v34, v34
    v_exp_f32 v35, v35
    v_exp_f32 v36, v36
    v_exp_f32 v37, v37
    v_mfma_f32_32x32x16_bf16 a[96:111], a[40:43], v[42:45], a[96:111]
    ds_read_b32 v111, v110 offset:9984
    buffer_load_dwordx4 v108, s[48:51], s40 offen lds
    s_add_u32 s40, s40, 458752
    s_add_u32 s44, s44, s45
    v_exp_f32 v38, v38
    v_exp_f32 v39, v39
    v_cvt_pk_bf16_f32 v46, v34, v35
    v_cvt_pk_bf16_f32 v47, v36, v37
    buffer_load_dwordx4 v108, s[48:51], s41 offen offset:1024 lds
    v_exp_f32 v40, v40
    v_exp_f32 v41, v41
    v_cvt_pk_bf16_f32 v48, v38, v39
    v_cvt_pk_bf16_f32 v49, v40, v41
    v_exp_f32 v10, v10
    v_exp_f32 v11, v11
    v_mfma_f32_32x32x16_bf16 a[96:111], a[44:47], v[46:49], a[96:111]
    s_waitcnt lgkmcnt(0)
    v_cmp_gt_u32 vcc, s60, v111
    s_mov_b32 m0, s43
    v_exp_f32 v12, v12
    v_exp_f32 v13, v13
    v_exp_f32 v14, v14
.sbc_fused_kernel_59:
    s_nop 0
    s_cbranch_vccnz .sbs_fused_kernel_60
    s_add_u32 s60, s60, 8
    buffer_load_dword v9, s[52:55], s39 offen lds
    s_add_u32 s39, s39, 10240
    s_add_u32 s41, s40, 27648
    v_exp_f32 v15, v15
    v_exp_f32 v16, v16
    v_exp_f32 v17, v17
    v_mfma_f32_32x32x16_bf16 v[26:41], a[12:15], v[50:53], 0
    s_setprio 3
    v_cvt_pk_bf16_f32 v42, v10, v11
    v_cvt_pk_bf16_f32 v43, v12, v13
    v_cvt_pk_bf16_f32 v44, v14, v15
    v_cvt_pk_bf16_f32 v45, v16, v17
    v_exp_f32 v18, v18
    v_exp_f32 v19, v19
    v_exp_f32 v20, v20
    v_exp_f32 v21, v21
    v_mfma_f32_32x32x16_bf16 a[96:111], a[48:51], v[42:45], a[96:111]
    v_exp_f32 v22, v22
    v_exp_f32 v23, v23
    v_cvt_pk_bf16_f32 v46, v18, v19
    v_cvt_pk_bf16_f32 v47, v20, v21
    v_exp_f32 v24, v24
    v_exp_f32 v25, v25
    v_cvt_pk_bf16_f32 v48, v22, v23
    v_cvt_pk_bf16_f32 v49, v24, v25
    v_exp_f32 v26, v26
    v_exp_f32 v27, v27
    v_mfma_f32_32x32x16_bf16 a[96:111], a[52:55], v[46:49], a[96:111]
    v_exp_f32 v28, v28
    v_exp_f32 v29, v29
    v_exp_f32 v30, v30
    buffer_load_dwordx4 a[112:115], v1, s[8:11], s17 offen offset:0 sc1
    v_exp_f32 v31, v31
    v_exp_f32 v32, v32
    v_exp_f32 v33, v33
    v_mfma_f32_32x32x16_bf16 v[10:25], a[16:19], v[50:53], 0
    v_cvt_pk_bf16_f32 v42, v26, v27
    v_cvt_pk_bf16_f32 v43, v28, v29
    v_cvt_pk_bf16_f32 v44, v30, v31
    v_cvt_pk_bf16_f32 v45, v32, v33
    v_exp_f32 v34, v34
    v_exp_f32 v35, v35
    v_exp_f32 v36, v36
    v_exp_f32 v37, v37
    v_mfma_f32_32x32x16_bf16 a[96:111], a[56:59], v[42:45], a[96:111]
    v_exp_f32 v38, v38
    v_exp_f32 v39, v39
    v_cvt_pk_bf16_f32 v46, v34, v35
    v_cvt_pk_bf16_f32 v47, v36, v37
    buffer_load_dwordx4 a[116:119], v1, s[8:11], s17 offen offset:1024 sc1
    v_exp_f32 v40, v40
    v_exp_f32 v41, v41
    v_cvt_pk_bf16_f32 v48, v38, v39
    v_cvt_pk_bf16_f32 v49, v40, v41
    v_exp_f32 v10, v10
    v_exp_f32 v11, v11
    v_mfma_f32_32x32x16_bf16 a[96:111], a[60:63], v[46:49], a[96:111]
    v_exp_f32 v12, v12
    v_exp_f32 v13, v13
    v_exp_f32 v14, v14
    buffer_load_dwordx4 a[120:123], v1, s[8:11], s17 offen offset:2048 sc1
    v_exp_f32 v15, v15
    v_exp_f32 v16, v16
    v_exp_f32 v17, v17
    v_mfma_f32_32x32x16_bf16 v[26:41], a[20:23], v[50:53], 0
    v_cvt_pk_bf16_f32 v42, v10, v11
    v_cvt_pk_bf16_f32 v43, v12, v13
    v_cvt_pk_bf16_f32 v44, v14, v15
    v_cvt_pk_bf16_f32 v45, v16, v17
    v_exp_f32 v18, v18
    v_exp_f32 v19, v19
    v_exp_f32 v20, v20
    v_exp_f32 v21, v21
    v_mfma_f32_32x32x16_bf16 a[96:111], a[64:67], v[42:45], a[96:111]
    v_exp_f32 v22, v22
    v_exp_f32 v23, v23
    v_cvt_pk_bf16_f32 v46, v18, v19
    v_cvt_pk_bf16_f32 v47, v20, v21
    buffer_load_dwordx4 a[124:127], v1, s[8:11], s17 offen offset:3072 sc1
    v_exp_f32 v24, v24
    v_exp_f32 v25, v25
    v_cvt_pk_bf16_f32 v48, v22, v23
    v_cvt_pk_bf16_f32 v49, v24, v25
    v_exp_f32 v26, v26
    v_exp_f32 v27, v27
    v_mfma_f32_32x32x16_bf16 a[96:111], a[68:71], v[46:49], a[96:111]
    v_exp_f32 v28, v28
    v_exp_f32 v29, v29
    v_exp_f32 v30, v30
    buffer_load_dwordx4 a[128:131], v1, s[8:11], s18 offen offset:0 sc1
    s_setprio 2
    v_exp_f32 v31, v31
    v_exp_f32 v32, v32
    v_exp_f32 v33, v33
    v_mfma_f32_32x32x16_bf16 v[10:25], a[24:27], v[50:53], 0
    v_cvt_pk_bf16_f32 v42, v26, v27
    v_cvt_pk_bf16_f32 v43, v28, v29
    v_cvt_pk_bf16_f32 v44, v30, v31
    v_cvt_pk_bf16_f32 v45, v32, v33
    v_exp_f32 v34, v34
    v_exp_f32 v35, v35
    v_exp_f32 v36, v36
    v_exp_f32 v37, v37
    v_mfma_f32_32x32x16_bf16 a[96:111], a[72:75], v[42:45], a[96:111]
    v_exp_f32 v38, v38
    v_exp_f32 v39, v39
    v_cvt_pk_bf16_f32 v46, v34, v35
    v_cvt_pk_bf16_f32 v47, v36, v37
    buffer_load_dwordx4 a[132:135], v1, s[8:11], s18 offen offset:1024 sc1
    v_exp_f32 v40, v40
    v_exp_f32 v41, v41
    v_cvt_pk_bf16_f32 v48, v38, v39
    v_cvt_pk_bf16_f32 v49, v40, v41
    v_exp_f32 v10, v10
    v_exp_f32 v11, v11
    v_mfma_f32_32x32x16_bf16 a[96:111], a[76:79], v[46:49], a[96:111]
    v_exp_f32 v12, v12
    v_exp_f32 v13, v13
    v_exp_f32 v14, v14
    buffer_load_dwordx4 a[136:139], v1, s[8:11], s18 offen offset:2048 sc1
    s_waitcnt vmcnt(12)
    ds_read_b128 v[94:97], v8 offset:6176
    ds_read_b64_tr_b16 v[98:99], v109 offset:0
    ds_read_b64_tr_b16 v[100:101], v109 offset:128
    v_exp_f32 v15, v15
    v_exp_f32 v16, v16
    v_exp_f32 v17, v17
    v_mfma_f32_32x32x16_bf16 v[26:41], a[28:31], v[50:53], 0
    ds_read_b128 v[50:53], v8
    v_add_u32 v8, 1024, v8
    v_cvt_pk_bf16_f32 v42, v10, v11
    v_cvt_pk_bf16_f32 v43, v12, v13
    v_cvt_pk_bf16_f32 v44, v14, v15
    v_cvt_pk_bf16_f32 v45, v16, v17
    v_exp_f32 v18, v18
    v_exp_f32 v19, v19
    v_exp_f32 v20, v20
    v_exp_f32 v21, v21
    v_mfma_f32_32x32x16_bf16 a[96:111], a[80:83], v[42:45], a[96:111]
    v_exp_f32 v22, v22
    v_exp_f32 v23, v23
    v_cvt_pk_bf16_f32 v46, v18, v19
    v_cvt_pk_bf16_f32 v47, v20, v21
    buffer_load_dwordx4 a[140:143], v1, s[8:11], s18 offen offset:3072 sc1
    v_exp_f32 v24, v24
    v_exp_f32 v25, v25
    v_cvt_pk_bf16_f32 v48, v22, v23
    v_cvt_pk_bf16_f32 v49, v24, v25
    v_exp_f32 v26, v26
    v_exp_f32 v27, v27
    v_mfma_f32_32x32x16_bf16 a[96:111], a[84:87], v[46:49], a[96:111]
    v_exp_f32 v28, v28
    v_exp_f32 v29, v29
    v_exp_f32 v30, v30
    s_add_u32 s17, s17, 65536
    s_bitset0_b32 s17, 19
    s_add_u32 s18, s17, 32768
    s_setprio 1
    v_exp_f32 v31, v31
    v_exp_f32 v32, v32
    v_exp_f32 v33, v33
    s_waitcnt lgkmcnt(0)
    v_mfma_f32_32x32x16_bf16 v[10:25], a[0:3], v[50:53], 0
    v_mfma_f32_16x16x32_bf16 v[102:105], v[94:97], v[98:101], 0
    v_cvt_pk_bf16_f32 v42, v26, v27
    v_cvt_pk_bf16_f32 v43, v28, v29
    v_cvt_pk_bf16_f32 v44, v30, v31
    v_cvt_pk_bf16_f32 v45, v32, v33
    v_exp_f32 v34, v34
    v_exp_f32 v35, v35
    v_exp_f32 v36, v36
    v_exp_f32 v37, v37
    v_mfma_f32_32x32x16_bf16 a[96:111], a[88:91], v[42:45], a[96:111]
    v_exp_f32 v38, v38
    v_exp_f32 v39, v39
    v_cvt_pk_bf16_f32 v46, v34, v35
    v_cvt_pk_bf16_f32 v47, v36, v37
    v_add_f32_dpp v102, v103, v102 row_ror:8 row_mask:0xf bank_mask:0xf
    v_exp_f32 v40, v40
    v_exp_f32 v41, v41
    v_cvt_pk_bf16_f32 v48, v38, v39
    v_cvt_pk_bf16_f32 v49, v40, v41
    v_exp_f32 v10, v10
    v_exp_f32 v11, v11
    v_mfma_f32_32x32x16_bf16 a[96:111], a[92:95], v[46:49], a[96:111]
    s_mov_b64 exec, s[58:59]
    ds_write_b32 v110, v102 offset:12032
    s_mov_b64 exec, -1
.loop_fused_kernel_5:
    v_exp_f32 v12, v12
    v_exp_f32 v13, v13
    v_exp_f32 v14, v14
    v_exp_f32 v15, v15
    v_exp_f32 v16, v16
    v_exp_f32 v17, v17
    v_mfma_f32_32x32x16_bf16 v[26:41], a[4:7], v[50:53], 0
    v_cvt_pk_bf16_f32 v42, v10, v11
    v_cvt_pk_bf16_f32 v43, v12, v13
    v_cvt_pk_bf16_f32 v44, v14, v15
    v_cvt_pk_bf16_f32 v45, v16, v17
    v_exp_f32 v18, v18
    v_exp_f32 v19, v19
    v_exp_f32 v20, v20
    v_exp_f32 v21, v21
    ds_write_b128 v2, a[96:99] offset:0
    ds_write_b128 v2, a[100:103] offset:1024
    ds_write_b32 v3, a104 offset:16384
    ds_add_u32 v110, v107 offset:9984
    v_mfma_f32_32x32x16_bf16 a[96:111], a[32:35], v[42:45], 0
    v_xor_b32 v2, 32768, v2
    v_xor_b32 v3, 32768, v3
    s_setprio 0
    v_exp_f32 v22, v22
    v_exp_f32 v23, v23
    v_cvt_pk_bf16_f32 v46, v18, v19
    v_cvt_pk_bf16_f32 v47, v20, v21
    v_exp_f32 v24, v24
    v_exp_f32 v25, v25
    v_cvt_pk_bf16_f32 v48, v22, v23
    v_cvt_pk_bf16_f32 v49, v24, v25
    v_exp_f32 v26, v26
    v_exp_f32 v27, v27
    v_mfma_f32_32x32x16_bf16 a[96:111], a[36:39], v[46:49], a[96:111]
    v_exp_f32 v28, v28
    v_exp_f32 v29, v29
    v_exp_f32 v30, v30
    v_exp_f32 v31, v31
    v_exp_f32 v32, v32
    v_exp_f32 v33, v33
    v_mfma_f32_32x32x16_bf16 v[10:25], a[8:11], v[50:53], 0
    s_mov_b32 m0, s44
    v_cvt_pk_bf16_f32 v42, v26, v27
    v_cvt_pk_bf16_f32 v43, v28, v29
    v_cvt_pk_bf16_f32 v44, v30, v31
    v_cvt_pk_bf16_f32 v45, v32, v33
    v_exp_f32 v34, v34
    v_exp_f32 v35, v35
    v_exp_f32 v36, v36
    v_exp_f32 v37, v37
    v_mfma_f32_32x32x16_bf16 a[96:111], a[40:43], v[42:45], a[96:111]
    ds_read_b32 v111, v110 offset:9984
    buffer_load_dwordx4 v108, s[48:51], s40 offen lds
    s_add_u32 s40, s40, 458752
    s_add_u32 s44, s44, s45
    v_exp_f32 v38, v38
    v_exp_f32 v39, v39
    v_cvt_pk_bf16_f32 v46, v34, v35
    v_cvt_pk_bf16_f32 v47, v36, v37
    buffer_load_dwordx4 v108, s[48:51], s41 offen offset:1024 lds
    s_cmp_eq_u32 s16, 4
    s_cselect_b32 s40, s42, s40
    v_exp_f32 v40, v40
    v_exp_f32 v41, v41
    v_cvt_pk_bf16_f32 v48, v38, v39
    v_cvt_pk_bf16_f32 v49, v40, v41
    v_exp_f32 v10, v10
    v_exp_f32 v11, v11
    v_mfma_f32_32x32x16_bf16 a[96:111], a[44:47], v[46:49], a[96:111]
    s_waitcnt lgkmcnt(0)
    v_cmp_gt_u32 vcc, s60, v111
    s_cselect_b32 s44, s43, s44
    s_cselect_b32 s45, 0, s45
    s_mov_b32 m0, s43
    v_exp_f32 v12, v12
    v_exp_f32 v13, v13
    v_exp_f32 v14, v14
.sbc_fused_kernel_61:
    s_cbranch_vccnz .sbs_fused_kernel_62
    s_add_u32 s60, s60, 8
    ds_read_b128 v[94:97], v7 offset:17408
    ds_read_b128 v[98:101], v7 offset:17920
    v_xor_b32 v7, 32768, v7
    buffer_load_dword v9, s[52:55], s39 offen lds
    s_add_u32 s39, s39, 10240
    s_add_u32 s41, s40, 27648
    v_exp_f32 v15, v15
    v_exp_f32 v16, v16
    v_exp_f32 v17, v17
    v_mfma_f32_32x32x16_bf16 v[26:41], a[12:15], v[50:53], 0
    s_setprio 3
    v_cvt_pk_bf16_f32 v42, v10, v11
    v_cvt_pk_bf16_f32 v43, v12, v13
    v_cvt_pk_bf16_f32 v44, v14, v15
    v_cvt_pk_bf16_f32 v45, v16, v17
    v_exp_f32 v18, v18
    v_exp_f32 v19, v19
    v_exp_f32 v20, v20
    v_exp_f32 v21, v21
    v_mfma_f32_32x32x16_bf16 a[96:111], a[48:51], v[42:45], a[96:111]
    v_exp_f32 v22, v22
    v_exp_f32 v23, v23
    v_cvt_pk_bf16_f32 v46, v18, v19
    v_cvt_pk_bf16_f32 v47, v20, v21
    v_exp_f32 v24, v24
    v_exp_f32 v25, v25
    v_cvt_pk_bf16_f32 v48, v22, v23
    v_cvt_pk_bf16_f32 v49, v24, v25
    v_exp_f32 v26, v26
    v_exp_f32 v27, v27
    v_mfma_f32_32x32x16_bf16 a[96:111], a[52:55], v[46:49], a[96:111]
    v_exp_f32 v28, v28
    v_exp_f32 v29, v29
    v_exp_f32 v30, v30
    s_waitcnt lgkmcnt(0)
    s_waitcnt vmcnt(10)
    v_mfma_f32_16x16x32_bf16 v[54:57], a[112:115], v[94:97], v[54:57]
    buffer_load_dwordx4 a[112:115], v1, s[8:11], s17 offen offset:0 sc1
    v_exp_f32 v31, v31
    v_exp_f32 v32, v32
    v_exp_f32 v33, v33
    v_mfma_f32_32x32x16_bf16 v[10:25], a[16:19], v[50:53], 0
    v_cvt_pk_bf16_f32 v42, v26, v27
    v_cvt_pk_bf16_f32 v43, v28, v29
    v_cvt_pk_bf16_f32 v44, v30, v31
    v_cvt_pk_bf16_f32 v45, v32, v33
    v_exp_f32 v34, v34
    v_exp_f32 v35, v35
    v_exp_f32 v36, v36
    v_exp_f32 v37, v37
    v_mfma_f32_32x32x16_bf16 a[96:111], a[56:59], v[42:45], a[96:111]
    v_exp_f32 v38, v38
    v_exp_f32 v39, v39
    v_cvt_pk_bf16_f32 v46, v34, v35
    v_cvt_pk_bf16_f32 v47, v36, v37
    s_waitcnt vmcnt(10)
    v_mfma_f32_16x16x32_bf16 v[58:61], a[116:119], v[94:97], v[58:61]
    buffer_load_dwordx4 a[116:119], v1, s[8:11], s17 offen offset:1024 sc1
    v_exp_f32 v40, v40
    v_exp_f32 v41, v41
    v_cvt_pk_bf16_f32 v48, v38, v39
    v_cvt_pk_bf16_f32 v49, v40, v41
    v_exp_f32 v10, v10
    v_exp_f32 v11, v11
    v_mfma_f32_32x32x16_bf16 a[96:111], a[60:63], v[46:49], a[96:111]
    v_exp_f32 v12, v12
    v_exp_f32 v13, v13
    v_exp_f32 v14, v14
    s_waitcnt vmcnt(10)
    v_mfma_f32_16x16x32_bf16 v[62:65], a[120:123], v[94:97], v[62:65]
    buffer_load_dwordx4 a[120:123], v1, s[8:11], s17 offen offset:2048 sc1
    v_exp_f32 v15, v15
    v_exp_f32 v16, v16
    v_exp_f32 v17, v17
    v_mfma_f32_32x32x16_bf16 v[26:41], a[20:23], v[50:53], 0
    v_cvt_pk_bf16_f32 v42, v10, v11
    v_cvt_pk_bf16_f32 v43, v12, v13
    v_cvt_pk_bf16_f32 v44, v14, v15
    v_cvt_pk_bf16_f32 v45, v16, v17
    v_exp_f32 v18, v18
    v_exp_f32 v19, v19
    v_exp_f32 v20, v20
    v_exp_f32 v21, v21
    v_mfma_f32_32x32x16_bf16 a[96:111], a[64:67], v[42:45], a[96:111]
    v_exp_f32 v22, v22
    v_exp_f32 v23, v23
    v_cvt_pk_bf16_f32 v46, v18, v19
    v_cvt_pk_bf16_f32 v47, v20, v21
    s_waitcnt vmcnt(10)
    v_mfma_f32_16x16x32_bf16 v[66:69], a[124:127], v[94:97], v[66:69]
    buffer_load_dwordx4 a[124:127], v1, s[8:11], s17 offen offset:3072 sc1
    v_exp_f32 v24, v24
    v_exp_f32 v25, v25
    v_cvt_pk_bf16_f32 v48, v22, v23
    v_cvt_pk_bf16_f32 v49, v24, v25
    v_exp_f32 v26, v26
    v_exp_f32 v27, v27
    v_mfma_f32_32x32x16_bf16 a[96:111], a[68:71], v[46:49], a[96:111]
    v_exp_f32 v28, v28
    v_exp_f32 v29, v29
    v_exp_f32 v30, v30
    s_waitcnt vmcnt(10)
    v_mfma_f32_16x16x32_bf16 v[54:57], a[128:131], v[98:101], v[54:57]
    buffer_load_dwordx4 a[128:131], v1, s[8:11], s18 offen offset:0 sc1
    s_setprio 2
    v_exp_f32 v31, v31
    v_exp_f32 v32, v32
    v_exp_f32 v33, v33
    v_mfma_f32_32x32x16_bf16 v[10:25], a[24:27], v[50:53], 0
    v_cvt_pk_bf16_f32 v42, v26, v27
    v_cvt_pk_bf16_f32 v43, v28, v29
    v_cvt_pk_bf16_f32 v44, v30, v31
    v_cvt_pk_bf16_f32 v45, v32, v33
    v_exp_f32 v34, v34
    v_exp_f32 v35, v35
    v_exp_f32 v36, v36
    v_exp_f32 v37, v37
    v_mfma_f32_32x32x16_bf16 a[96:111], a[72:75], v[42:45], a[96:111]
    v_exp_f32 v38, v38
    v_exp_f32 v39, v39
    v_cvt_pk_bf16_f32 v46, v34, v35
    v_cvt_pk_bf16_f32 v47, v36, v37
    s_waitcnt vmcnt(10)
    v_mfma_f32_16x16x32_bf16 v[58:61], a[132:135], v[98:101], v[58:61]
    buffer_load_dwordx4 a[132:135], v1, s[8:11], s18 offen offset:1024 sc1
    v_exp_f32 v40, v40
    v_exp_f32 v41, v41
    v_cvt_pk_bf16_f32 v48, v38, v39
    v_cvt_pk_bf16_f32 v49, v40, v41
    v_exp_f32 v10, v10
    v_exp_f32 v11, v11
    v_mfma_f32_32x32x16_bf16 a[96:111], a[76:79], v[46:49], a[96:111]
    v_exp_f32 v12, v12
    v_exp_f32 v13, v13
    v_exp_f32 v14, v14
    s_waitcnt vmcnt(10)
    v_mfma_f32_16x16x32_bf16 v[62:65], a[136:139], v[98:101], v[62:65]
    buffer_load_dwordx4 a[136:139], v1, s[8:11], s18 offen offset:2048 sc1
    v_exp_f32 v15, v15
    v_exp_f32 v16, v16
    v_exp_f32 v17, v17
    v_mfma_f32_32x32x16_bf16 v[26:41], a[28:31], v[50:53], 0
    ds_read_b128 v[50:53], v8
    v_add_u32 v8, 1024, v8
    v_cvt_pk_bf16_f32 v42, v10, v11
    v_cvt_pk_bf16_f32 v43, v12, v13
    v_cvt_pk_bf16_f32 v44, v14, v15
    v_cvt_pk_bf16_f32 v45, v16, v17
    v_exp_f32 v18, v18
    v_exp_f32 v19, v19
    v_exp_f32 v20, v20
    v_exp_f32 v21, v21
    v_mfma_f32_32x32x16_bf16 a[96:111], a[80:83], v[42:45], a[96:111]
    v_exp_f32 v22, v22
    v_exp_f32 v23, v23
    v_cvt_pk_bf16_f32 v46, v18, v19
    v_cvt_pk_bf16_f32 v47, v20, v21
    s_waitcnt vmcnt(10)
    v_mfma_f32_16x16x32_bf16 v[66:69], a[140:143], v[98:101], v[66:69]
    buffer_load_dwordx4 a[140:143], v1, s[8:11], s18 offen offset:3072 sc1
    v_exp_f32 v24, v24
    v_exp_f32 v25, v25
    v_cvt_pk_bf16_f32 v48, v22, v23
    v_cvt_pk_bf16_f32 v49, v24, v25
    v_exp_f32 v26, v26
    v_exp_f32 v27, v27
    v_mfma_f32_32x32x16_bf16 a[96:111], a[84:87], v[46:49], a[96:111]
    v_exp_f32 v28, v28
    v_exp_f32 v29, v29
    v_exp_f32 v30, v30
    s_add_u32 s17, s17, 65536
    s_bitset0_b32 s17, 19
    s_add_u32 s18, s17, 32768
    s_bitcmp1_b32 s56, s16
    s_cbranch_scc1 .w7_fused_kernel_7
.w7r_fused_kernel_9:
    s_setprio 1
    v_exp_f32 v31, v31
    v_exp_f32 v32, v32
    v_exp_f32 v33, v33
    s_waitcnt lgkmcnt(0)
    v_mfma_f32_32x32x16_bf16 v[10:25], a[0:3], v[50:53], 0
    v_cvt_pk_bf16_f32 v42, v26, v27
    v_cvt_pk_bf16_f32 v43, v28, v29
    v_cvt_pk_bf16_f32 v44, v30, v31
    v_cvt_pk_bf16_f32 v45, v32, v33
    v_exp_f32 v34, v34
    v_exp_f32 v35, v35
    v_exp_f32 v36, v36
    v_exp_f32 v37, v37
    v_mfma_f32_32x32x16_bf16 a[96:111], a[88:91], v[42:45], a[96:111]
    v_exp_f32 v38, v38
    v_exp_f32 v39, v39
    v_cvt_pk_bf16_f32 v46, v34, v35
    v_cvt_pk_bf16_f32 v47, v36, v37
    v_exp_f32 v40, v40
    v_exp_f32 v41, v41
    v_cvt_pk_bf16_f32 v48, v38, v39
    v_cvt_pk_bf16_f32 v49, v40, v41
    v_exp_f32 v10, v10
    v_exp_f32 v11, v11
    v_mfma_f32_32x32x16_bf16 a[96:111], a[92:95], v[46:49], a[96:111]
    s_add_u32 s16, s16, 1
    s_cmp_lt_u32 s16, 7
    s_cbranch_scc1 .loop_fused_kernel_5
    v_exp_f32 v12, v12
    v_exp_f32 v13, v13
    v_exp_f32 v14, v14
    s_movk_i32 s43, -2560
    v_lshrrev_b32 v90, 3, v0
    v_mad_i32_i24 v90, v90, s43, v108
    s_bfe_u32 s42, s3, 0x10001
    s_lshl_b32 s42, s42, 3
    s_and_b32 s43, s3, 1
    s_add_u32 s42, s42, s43
    s_lshl_b32 s42, s42, 14
    s_lshr_b32 s43, s2, 5
    s_lshl_b32 s43, s43, 7
    s_add_u32 s42, s42, s43
    v_exp_f32 v15, v15
    v_exp_f32 v16, v16
    v_exp_f32 v17, v17
    v_mfma_f32_32x32x16_bf16 v[26:41], a[4:7], v[50:53], 0
    buffer_load_dwordx4 v[102:105], v1, s[8:11], s57 offen sc1
    s_add_u32 s58, s17, 65536
    s_bitset0_b32 s58, 19
    s_add_u32 s59, s58, 32768
    v_cvt_pk_bf16_f32 v42, v10, v11
    v_cvt_pk_bf16_f32 v43, v12, v13
    v_cvt_pk_bf16_f32 v44, v14, v15
    v_cvt_pk_bf16_f32 v45, v16, v17
    v_exp_f32 v18, v18
    v_exp_f32 v19, v19
    v_exp_f32 v20, v20
    v_exp_f32 v21, v21
    ds_write_b128 v2, a[96:99] offset:0
    ds_write_b128 v2, a[100:103] offset:1024
    ds_write_b32 v3, a104 offset:16384
    ds_add_u32 v110, v107 offset:9984
    v_mfma_f32_32x32x16_bf16 a[96:111], a[32:35], v[42:45], 0
    v_xor_b32 v2, 32768, v2
    v_xor_b32 v3, 32768, v3
    s_add_u32 s41, s42, 589824
    buffer_load_dwordx4 a[0:3], v90, s[52:55], s41 offen
    s_setprio 0
    v_exp_f32 v22, v22
    v_exp_f32 v23, v23
    v_cvt_pk_bf16_f32 v46, v18, v19
    v_cvt_pk_bf16_f32 v47, v20, v21
    v_and_b32 v109, 124, v110
    buffer_load_dword v109, v109, s[8:11], s38 offen sc1
    s_add_u32 s35, s33, 73728
    v_exp_f32 v24, v24
    v_exp_f32 v25, v25
    v_cvt_pk_bf16_f32 v48, v22, v23
    v_cvt_pk_bf16_f32 v49, v24, v25
    v_exp_f32 v26, v26
    v_exp_f32 v27, v27
    v_mfma_f32_32x32x16_bf16 a[96:111], a[36:39], v[46:49], a[96:111]
    s_add_u32 s41, s42, 598016
    buffer_load_dwordx4 a[4:7], v90, s[52:55], s41 offen
    v_exp_f32 v28, v28
    v_exp_f32 v29, v29
    v_exp_f32 v30, v30
    v_exp_f32 v31, v31
    v_exp_f32 v32, v32
    v_exp_f32 v33, v33
    v_mfma_f32_32x32x16_bf16 v[10:25], a[8:11], v[50:53], 0
    s_add_u32 s41, s42, 851968
    buffer_load_dwordx4 a[8:11], v90, s[52:55], s41 offen
    v_cvt_pk_bf16_f32 v42, v26, v27
    v_cvt_pk_bf16_f32 v43, v28, v29
    v_cvt_pk_bf16_f32 v44, v30, v31
    v_cvt_pk_bf16_f32 v45, v32, v33
    v_exp_f32 v34, v34
    v_exp_f32 v35, v35
    v_exp_f32 v36, v36
    v_exp_f32 v37, v37
    v_mfma_f32_32x32x16_bf16 a[96:111], a[40:43], v[42:45], a[96:111]
    ds_read_b32 v111, v110 offset:9984
    buffer_load_dwordx4 a[32:35], v1, s[8:11], s58 offen offset:0 sc1
    v_exp_f32 v38, v38
    v_exp_f32 v39, v39
    v_cvt_pk_bf16_f32 v46, v34, v35
    v_cvt_pk_bf16_f32 v47, v36, v37
    v_exp_f32 v40, v40
    v_exp_f32 v41, v41
    v_cvt_pk_bf16_f32 v48, v38, v39
    v_cvt_pk_bf16_f32 v49, v40, v41
    v_exp_f32 v10, v10
    v_exp_f32 v11, v11
    v_mfma_f32_32x32x16_bf16 a[96:111], a[44:47], v[46:49], a[96:111]
    s_waitcnt lgkmcnt(0)
    v_cmp_gt_u32 vcc, s60, v111
    buffer_load_dwordx4 a[36:39], v1, s[8:11], s58 offen offset:1024 sc1
    v_exp_f32 v12, v12
    v_exp_f32 v13, v13
    v_exp_f32 v14, v14
.sbc_fused_kernel_63:
    s_nop 0
    s_cbranch_vccnz .sbs_fused_kernel_64
    s_add_u32 s60, s60, 8
    ds_read_b128 v[94:97], v7 offset:17408
    ds_read_b128 v[98:101], v7 offset:17920
    v_xor_b32 v7, 32768, v7
    v_exp_f32 v15, v15
    v_exp_f32 v16, v16
    v_exp_f32 v17, v17
    v_mfma_f32_32x32x16_bf16 v[26:41], a[12:15], v[50:53], 0
    s_lshr_b32 s40, s2, 4
    s_min_u32 s40, s40, 13
    s_lshl_b32 s40, s40, 8
    s_and_b32 s44, s3, 3
    s_mul_i32 s41, s44, 57344
    s_add_u32 s40, s40, s41
    s_lshl_b32 s44, s44, 11
    s_setprio 3
    v_cvt_pk_bf16_f32 v42, v10, v11
    v_cvt_pk_bf16_f32 v43, v12, v13
    v_cvt_pk_bf16_f32 v44, v14, v15
    v_cvt_pk_bf16_f32 v45, v16, v17
    v_exp_f32 v18, v18
    v_exp_f32 v19, v19
    v_exp_f32 v20, v20
    v_exp_f32 v21, v21
    v_mfma_f32_32x32x16_bf16 a[96:111], a[48:51], v[42:45], a[96:111]
    buffer_load_dwordx4 a[40:43], v1, s[8:11], s58 offen offset:2048 sc1
    v_exp_f32 v22, v22
    v_exp_f32 v23, v23
    v_cvt_pk_bf16_f32 v46, v18, v19
    v_cvt_pk_bf16_f32 v47, v20, v21
    s_add_u32 m0, s44, 57344
    s_add_u32 s41, s40, 1147008
    buffer_load_dwordx4 v108, s[48:51], s41 offen offset:0 lds
    v_exp_f32 v24, v24
    v_exp_f32 v25, v25
    v_cvt_pk_bf16_f32 v48, v22, v23
    v_cvt_pk_bf16_f32 v49, v24, v25
    v_exp_f32 v26, v26
    v_exp_f32 v27, v27
    v_mfma_f32_32x32x16_bf16 a[96:111], a[52:55], v[46:49], a[96:111]
    buffer_load_dwordx4 a[44:47], v1, s[8:11], s58 offen offset:3072 sc1
    v_exp_f32 v28, v28
    v_exp_f32 v29, v29
    v_exp_f32 v30, v30
    s_waitcnt lgkmcnt(0)
    s_waitcnt vmcnt(17)
    v_mfma_f32_16x16x32_bf16 v[54:57], a[112:115], v[94:97], v[54:57]
    buffer_load_dwordx4 a[112:115], v1, s[8:11], s17 offen offset:0 sc1
    v_exp_f32 v31, v31
    v_exp_f32 v32, v32
    v_exp_f32 v33, v33
    v_mfma_f32_32x32x16_bf16 v[10:25], a[16:19], v[50:53], 0
    s_add_u32 m0, s44, 57344
    s_add_u32 s41, s40, 1174656
    buffer_load_dwordx4 v108, s[48:51], s41 offen offset:1024 lds
    v_cvt_pk_bf16_f32 v42, v26, v27
    v_cvt_pk_bf16_f32 v43, v28, v29
    v_cvt_pk_bf16_f32 v44, v30, v31
    v_cvt_pk_bf16_f32 v45, v32, v33
    v_exp_f32 v34, v34
    v_exp_f32 v35, v35
    v_exp_f32 v36, v36
    v_exp_f32 v37, v37
    v_mfma_f32_32x32x16_bf16 a[96:111], a[56:59], v[42:45], a[96:111]
    buffer_load_dwordx4 a[48:51], v1, s[8:11], s59 offen offset:0 sc1
    v_exp_f32 v38, v38
    v_exp_f32 v39, v39
    v_cvt_pk_bf16_f32 v46, v34, v35
    v_cvt_pk_bf16_f32 v47, v36, v37
    s_waitcnt vmcnt(19)
    v_mfma_f32_16x16x32_bf16 v[58:61], a[116:119], v[94:97], v[58:61]
    buffer_load_dwordx4 a[116:119], v1, s[8:11], s17 offen offset:1024 sc1
    v_exp_f32 v40, v40
    v_exp_f32 v41, v41
    v_cvt_pk_bf16_f32 v48, v38, v39
    v_cvt_pk_bf16_f32 v49, v40, v41
    v_exp_f32 v10, v10
    v_exp_f32 v11, v11
    v_mfma_f32_32x32x16_bf16 a[96:111], a[60:63], v[46:49], a[96:111]
    s_add_u32 m0, s44, 65536
    s_add_u32 s41, s40, 1376384
    buffer_load_dwordx4 v108, s[48:51], s41 offen offset:0 lds
    v_exp_f32 v12, v12
    v_exp_f32 v13, v13
    v_exp_f32 v14, v14
    s_waitcnt vmcnt(20)
    v_mfma_f32_16x16x32_bf16 v[62:65], a[120:123], v[94:97], v[62:65]
    buffer_load_dwordx4 a[120:123], v1, s[8:11], s17 offen offset:2048 sc1
    v_exp_f32 v15, v15
    v_exp_f32 v16, v16
    v_exp_f32 v17, v17
    v_mfma_f32_32x32x16_bf16 v[26:41], a[20:23], v[50:53], 0
    s_add_u32 m0, s44, 65536
    s_add_u32 s41, s40, 1404032
    buffer_load_dwordx4 v108, s[48:51], s41 offen offset:1024 lds
    v_cvt_pk_bf16_f32 v42, v10, v11
    v_cvt_pk_bf16_f32 v43, v12, v13
    v_cvt_pk_bf16_f32 v44, v14, v15
    v_cvt_pk_bf16_f32 v45, v16, v17
    v_exp_f32 v18, v18
    v_exp_f32 v19, v19
    v_exp_f32 v20, v20
    v_exp_f32 v21, v21
    v_mfma_f32_32x32x16_bf16 a[96:111], a[64:67], v[42:45], a[96:111]
    buffer_load_dwordx4 a[52:55], v1, s[8:11], s59 offen offset:1024 sc1
    v_exp_f32 v22, v22
    v_exp_f32 v23, v23
    v_cvt_pk_bf16_f32 v46, v18, v19
    v_cvt_pk_bf16_f32 v47, v20, v21
    s_waitcnt vmcnt(22)
    v_mfma_f32_16x16x32_bf16 v[66:69], a[124:127], v[94:97], v[66:69]
    buffer_load_dwordx4 a[124:127], v1, s[8:11], s17 offen offset:3072 sc1
    v_exp_f32 v24, v24
    v_exp_f32 v25, v25
    v_cvt_pk_bf16_f32 v48, v22, v23
    v_cvt_pk_bf16_f32 v49, v24, v25
    v_exp_f32 v26, v26
    v_exp_f32 v27, v27
    v_mfma_f32_32x32x16_bf16 a[96:111], a[68:71], v[46:49], a[96:111]
    s_add_u32 s41, s42, 860160
    buffer_load_dwordx4 a[12:15], v90, s[52:55], s41 offen
    v_exp_f32 v28, v28
    v_exp_f32 v29, v29
    v_exp_f32 v30, v30
    s_waitcnt vmcnt(23)
    v_mfma_f32_16x16x32_bf16 v[54:57], a[128:131], v[98:101], v[54:57]
    buffer_load_dwordx4 a[128:131], v1, s[8:11], s18 offen offset:0 sc1
    s_setprio 2
    v_exp_f32 v31, v31
    v_exp_f32 v32, v32
    v_exp_f32 v33, v33
    v_mfma_f32_32x32x16_bf16 v[10:25], a[24:27], v[50:53], 0
    s_add_u32 s41, s42, 1114112
    buffer_load_dwordx4 a[16:19], v90, s[52:55], s41 offen
    v_cvt_pk_bf16_f32 v42, v26, v27
    v_cvt_pk_bf16_f32 v43, v28, v29
    v_cvt_pk_bf16_f32 v44, v30, v31
    v_cvt_pk_bf16_f32 v45, v32, v33
    v_exp_f32 v34, v34
    v_exp_f32 v35, v35
    v_exp_f32 v36, v36
    v_exp_f32 v37, v37
    v_mfma_f32_32x32x16_bf16 a[96:111], a[72:75], v[42:45], a[96:111]
    buffer_load_dwordx4 a[56:59], v1, s[8:11], s59 offen offset:2048 sc1
    v_exp_f32 v38, v38
    v_exp_f32 v39, v39
    v_cvt_pk_bf16_f32 v46, v34, v35
    v_cvt_pk_bf16_f32 v47, v36, v37
    s_waitcnt vmcnt(25)
    v_mfma_f32_16x16x32_bf16 v[58:61], a[132:135], v[98:101], v[58:61]
    buffer_load_dwordx4 a[132:135], v1, s[8:11], s18 offen offset:1024 sc1
    v_exp_f32 v40, v40
    v_exp_f32 v41, v41
    v_cvt_pk_bf16_f32 v48, v38, v39
    v_cvt_pk_bf16_f32 v49, v40, v41
    v_exp_f32 v10, v10
    v_exp_f32 v11, v11
    v_mfma_f32_32x32x16_bf16 a[96:111], a[76:79], v[46:49], a[96:111]
    s_add_u32 s41, s42, 1122304
    buffer_load_dwordx4 a[20:23], v90, s[52:55], s41 offen
    v_exp_f32 v12, v12
    v_exp_f32 v13, v13
    v_exp_f32 v14, v14
    s_waitcnt vmcnt(26)
    v_mfma_f32_16x16x32_bf16 v[62:65], a[136:139], v[98:101], v[62:65]
    buffer_load_dwordx4 a[136:139], v1, s[8:11], s18 offen offset:2048 sc1
    v_exp_f32 v15, v15
    v_exp_f32 v16, v16
    v_exp_f32 v17, v17
    v_mfma_f32_32x32x16_bf16 v[26:41], a[28:31], v[50:53], 0
    s_add_u32 s41, s42, 1376256
    buffer_load_dwordx4 a[24:27], v90, s[52:55], s41 offen
    v_cvt_pk_bf16_f32 v42, v10, v11
    v_cvt_pk_bf16_f32 v43, v12, v13
    v_cvt_pk_bf16_f32 v44, v14, v15
    v_cvt_pk_bf16_f32 v45, v16, v17
    v_exp_f32 v18, v18
    v_exp_f32 v19, v19
    v_exp_f32 v20, v20
    v_exp_f32 v21, v21
    v_mfma_f32_32x32x16_bf16 a[96:111], a[80:83], v[42:45], a[96:111]
    buffer_load_dwordx4 a[60:63], v1, s[8:11], s59 offen offset:3072 sc1
    v_exp_f32 v22, v22
    v_exp_f32 v23, v23
    v_cvt_pk_bf16_f32 v46, v18, v19
    v_cvt_pk_bf16_f32 v47, v20, v21
    s_waitcnt vmcnt(28)
    v_mfma_f32_16x16x32_bf16 v[66:69], a[140:143], v[98:101], v[66:69]
    buffer_load_dwordx4 a[140:143], v1, s[8:11], s18 offen offset:3072 sc1
    v_exp_f32 v24, v24
    v_exp_f32 v25, v25
    v_cvt_pk_bf16_f32 v48, v22, v23
    v_cvt_pk_bf16_f32 v49, v24, v25
    v_exp_f32 v26, v26
    v_exp_f32 v27, v27
    v_mfma_f32_32x32x16_bf16 a[96:111], a[84:87], v[46:49], a[96:111]
    s_add_u32 s41, s42, 1384448
    buffer_load_dwordx4 a[28:31], v90, s[52:55], s41 offen
    s_waitcnt vmcnt(29)
    v_min3_u32 v111, v102, v103, v104
    v_min_u32 v111, v111, v105
    v_cmp_eq_u32 vcc, 0, v111
    v_add_u32 v8, s35, v1
    v_exp_f32 v28, v28
    v_exp_f32 v29, v29
    v_exp_f32 v30, v30
    s_add_u32 s41, s42, 1638400
    buffer_load_dwordx4 a[64:67], v90, s[52:55], s41 offen
    s_setprio 1
    v_exp_f32 v31, v31
    v_exp_f32 v32, v32
    v_exp_f32 v33, v33
    s_add_u32 s41, s42, 1646592
    buffer_load_dwordx4 a[68:71], v90, s[52:55], s41 offen
    s_cbranch_vccnz .modspin_fused_kernel_66
.modchk_fused_kernel_65:
    s_mov_b32 exec_hi, 0xffff
    ds_write_b128 v8, v[102:105]
    s_mov_b32 exec_hi, -1
    v_cvt_pk_bf16_f32 v42, v26, v27
    v_cvt_pk_bf16_f32 v43, v28, v29
    v_cvt_pk_bf16_f32 v44, v30, v31
    v_cvt_pk_bf16_f32 v45, v32, v33
    v_exp_f32 v34, v34
    v_exp_f32 v35, v35
    v_exp_f32 v36, v36
    v_exp_f32 v37, v37
    v_mfma_f32_32x32x16_bf16 a[96:111], a[88:91], v[42:45], a[96:111]
    s_add_u32 s41, s42, 98304
    buffer_load_dwordx4 a[72:75], v90, s[52:55], s41 offen
    v_exp_f32 v38, v38
    v_exp_f32 v39, v39
    v_cvt_pk_bf16_f32 v46, v34, v35
    v_cvt_pk_bf16_f32 v47, v36, v37
    s_add_u32 s41, s42, 106496
    buffer_load_dwordx4 a[76:79], v90, s[52:55], s41 offen
    v_exp_f32 v40, v40
    v_exp_f32 v41, v41
    v_cvt_pk_bf16_f32 v48, v38, v39
    v_cvt_pk_bf16_f32 v49, v40, v41
    s_nop 1
    v_mfma_f32_32x32x16_bf16 a[96:111], a[92:95], v[46:49], a[96:111]
    s_add_u32 s41, s42, 360448
    buffer_load_dwordx4 a[80:83], v90, s[52:55], s41 offen
    s_add_u32 s41, s42, 368640
    buffer_load_dwordx4 a[84:87], v90, s[52:55], s41 offen
    v_and_b32 v8, 7, v0
    v_bfe_u32 v9, v0, 3, 1
    v_lshrrev_b32 v50, 4, v0
    v_lshlrev_b32 v51, 7, v8
    v_lshl_add_u32 v51, v9, 6, v51
    v_lshl_add_u32 v51, v50, 3, v51
    v_add_u32 v51, s33, v51
    v_lshlrev_b32 v52, 7, v9
    v_lshl_add_u32 v52, v50, 4, v52
    s_add_u32 s35, s33, 73728
    v_add_u32 v52, s35, v52
    ds_write_b128 v2, a[96:99] offset:0
    ds_write_b128 v2, a[100:103] offset:1024
    ds_write_b32 v3, a104 offset:16384
    ds_read_b64 v[10:11], v51 offset:20480
    ds_read_b64 v[12:13], v51 offset:20512
    ds_read_b128 v[14:17], v52
    ds_read_b128 v[18:21], v52 offset:64
    v_lshlrev_b32 v2, 11, v9
    v_lshl_add_u32 v2, v50, 9, v2
    v_lshl_add_u32 v2, v8, 4, v2
    s_bfe_u32 s33, s21, 0x30002
    s_lshl_b32 s33, s33, 15
    s_add_u32 s33, s33, s4
    s_lshl_b32 s34, s3, 12
    s_add_u32 s33, s33, s34
    s_and_b32 s34, s21, 3
    s_lshl_b32 s34, s34, 7
    s_add_u32 s33, s33, s34
    s_add_u32 s34, s33, 0
    s_add_u32 s35, s33, 1179648
    s_waitcnt lgkmcnt(0)
    s_barrier
    ds_read_b128 v[94:97], v7 offset:17408
    ds_read_b128 v[98:101], v7 offset:17920
    v_xor_b32 v7, 32768, v7
    v_lshlrev_b32 v26, 16, v10
    v_and_b32 v27, 0xffff0000, v10
    v_lshlrev_b32 v28, 16, v11
    v_and_b32 v29, 0xffff0000, v11
    v_lshlrev_b32 v30, 16, v12
    v_and_b32 v31, 0xffff0000, v12
    v_lshlrev_b32 v32, 16, v13
    v_and_b32 v33, 0xffff0000, v13
    s_waitcnt vmcnt(7) lgkmcnt(0)
    s_add_u32 m0, s44, 32768
    s_add_u32 s41, s40, 458880
    buffer_load_dwordx4 v108, s[48:51], s41 offen offset:0 lds
    s_add_u32 m0, s44, 32768
    s_add_u32 s41, s40, 486528
    buffer_load_dwordx4 v108, s[48:51], s41 offen offset:1024 lds
    s_add_u32 m0, s44, 40960
    s_add_u32 s41, s40, 688256
    buffer_load_dwordx4 v108, s[48:51], s41 offen offset:0 lds
    s_add_u32 m0, s44, 40960
    s_add_u32 s41, s40, 715904
    buffer_load_dwordx4 v108, s[48:51], s41 offen offset:1024 lds
    s_mov_b64 vcc, 0
    s_branch .ebj_fused_kernel_69
.tail_fused_kernel_48:
    v_and_b32 v8, 7, v0
    v_bfe_u32 v9, v0, 3, 1
    v_lshrrev_b32 v50, 4, v0
    v_lshlrev_b32 v51, 7, v8
    v_lshl_add_u32 v51, v9, 6, v51
    v_lshl_add_u32 v51, v50, 3, v51
    v_add_u32 v51, s33, v51
    v_lshlrev_b32 v52, 7, v9
    v_lshl_add_u32 v52, v50, 4, v52
    s_add_u32 s35, s33, 73728
    v_add_u32 v52, s35, v52
    ds_write_b128 v2, a[96:99] offset:0
    ds_write_b128 v2, a[100:103] offset:1024
    ds_write_b32 v3, a104 offset:16384
    ds_read_b64 v[10:11], v51 offset:20480
    ds_read_b64 v[12:13], v51 offset:20512
    ds_read_b128 v[14:17], v52
    ds_read_b128 v[18:21], v52 offset:64
    v_lshlrev_b32 v2, 11, v9
    v_lshl_add_u32 v2, v50, 9, v2
    v_lshl_add_u32 v2, v8, 4, v2
    s_bfe_u32 s33, s21, 0x30002
    s_lshl_b32 s33, s33, 15
    s_add_u32 s33, s33, s4
    s_lshl_b32 s34, s3, 12
    s_add_u32 s33, s33, s34
    s_and_b32 s34, s21, 3
    s_lshl_b32 s34, s34, 7
    s_add_u32 s33, s33, s34
    s_add_u32 s34, s33, 0
    s_add_u32 s35, s33, 1179648
    s_waitcnt lgkmcnt(0)
    s_barrier
    ds_read_b64 v[70:71], v4 offset:0
    ds_read_b64 v[72:73], v4 offset:2048
    ds_read_b64 v[74:75], v4 offset:4096
    ds_read_b64 v[76:77], v4 offset:6144
    ds_read_b64 v[78:79], v4 offset:8192
    ds_read_b64 v[80:81], v4 offset:10240
    ds_read_b64 v[82:83], v4 offset:12288
    ds_read_b64 v[84:85], v4 offset:14336
    ds_read_b128 v[86:89], v5 offset:16384
    ds_read_b128 v[90:93], v5 offset:16400
    ds_read_b128 v[94:97], v7 offset:17408
    ds_read_b128 v[98:101], v7 offset:17920
    v_xor_b32 v7, 32768, v7
    v_lshlrev_b32 v26, 16, v10
    v_and_b32 v27, 0xffff0000, v10
    v_lshlrev_b32 v28, 16, v11
    v_and_b32 v29, 0xffff0000, v11
    v_lshlrev_b32 v30, 16, v12
    v_and_b32 v31, 0xffff0000, v12
    v_lshlrev_b32 v32, 16, v13
    v_and_b32 v33, 0xffff0000, v13
    s_waitcnt lgkmcnt(2)
    v_pk_add_f32 v[86:87], v[86:87], v[88:89]
    v_pk_add_f32 v[90:91], v[90:91], v[92:93]
    v_pk_add_f32 v[70:71], v[70:71], v[72:73]
    v_pk_add_f32 v[86:87], v[86:87], v[90:91]
    v_pk_add_f32 v[74:75], v[74:75], v[76:77]
    v_pk_add_f32 v[78:79], v[78:79], v[80:81]
    v_add_f32 v86, v86, v87
    v_pk_add_f32 v[82:83], v[82:83], v[84:85]
    v_rcp_f32 v87, v86
    v_pk_add_f32 v[70:71], v[70:71], v[74:75]
    v_pk_add_f32 v[78:79], v[78:79], v[82:83]
    v_subrev_u32 v88, s19, v86
    v_pk_add_f32 v[70:71], v[70:71], v[78:79]
    v_cmp_lt_u32 s[26:27], s20, v88
    v_pk_mul_f32 v[70:71], v[70:71], v[86:87] op_sel:[0,1] op_sel_hi:[1,1]
    s_nop 0
    v_cvt_pk_bf16_f32 v70, v70, v71
    s_or_b64 s[24:25], s[24:25], s[26:27]
    ds_write_b32 v6, v70 offset:17408
    s_cmp_eq_u64 s[24:25], 0
    s_cbranch_scc1 .ok_fused_kernel_70
    v_mov_b32 v71, 0
    v_mov_b32 v72, 1
    ds_write_b32 v71, v72 offset:30720
.ok_fused_kernel_70:
    s_waitcnt vmcnt(0) lgkmcnt(0)
    s_mov_b64 vcc, -1
.ebj_fused_kernel_69:
    s_barrier
    ds_read_b128 v[42:45], v7 offset:17408
    ds_read_b128 v[46:49], v7 offset:17920
    v_mov_b32 v9, 0
    ds_read_b32 v9, v9 offset:30720
    ds_read_b128 v[70:73], v52 offset:256
    ds_read_b128 v[74:77], v52 offset:320
    ds_read_b128 v[78:81], v52 offset:512
    ds_read_b128 v[82:85], v52 offset:576
    v_mfma_f32_16x16x32_bf16 v[54:57], a[112:115], v[94:97], v[54:57]
    v_mfma_f32_16x16x32_bf16 v[58:61], a[116:119], v[94:97], v[58:61]
    v_mfma_f32_16x16x32_bf16 v[62:65], a[120:123], v[94:97], v[62:65]
    v_mfma_f32_16x16x32_bf16 v[66:69], a[124:127], v[94:97], v[66:69]
    v_mfma_f32_16x16x32_bf16 v[54:57], a[128:131], v[98:101], v[54:57]
    v_mfma_f32_16x16x32_bf16 v[58:61], a[132:135], v[98:101], v[58:61]
    v_mfma_f32_16x16x32_bf16 v[62:65], a[136:139], v[98:101], v[62:65]
    v_mfma_f32_16x16x32_bf16 v[66:69], a[140:143], v[98:101], v[66:69]
    s_waitcnt lgkmcnt(0)
    v_mfma_f32_16x16x32_bf16 v[54:57], a[32:35], v[42:45], v[54:57]
    v_mfma_f32_16x16x32_bf16 v[58:61], a[36:39], v[42:45], v[58:61]
    v_mfma_f32_16x16x32_bf16 v[62:65], a[40:43], v[42:45], v[62:65]
    v_mfma_f32_16x16x32_bf16 v[66:69], a[44:47], v[42:45], v[66:69]
    v_mfma_f32_16x16x32_bf16 v[54:57], a[48:51], v[46:49], v[54:57]
    v_mfma_f32_16x16x32_bf16 v[58:61], a[52:55], v[46:49], v[58:61]
    v_mfma_f32_16x16x32_bf16 v[62:65], a[56:59], v[46:49], v[62:65]
    v_mfma_f32_16x16x32_bf16 v[66:69], a[60:63], v[46:49], v[66:69]
    v_cmp_ne_u32 s[26:27], s46, v109
    v_readfirstlane_b32 s36, v9
    s_nop 0
    s_cmp_eq_u64 s[26:27], 0
    s_cselect_b32 s47, 1, 0
    s_cmp_lg_u32 s36, 0
    s_cbranch_scc1 .fb_fused_kernel_2
    v_mov_b32_dpp v54, v62 quad_perm:[0,1,2,3] row_mask:0xf bank_mask:0xc
    v_mov_b32_dpp v55, v63 quad_perm:[0,1,2,3] row_mask:0xf bank_mask:0xc
    v_mov_b32_dpp v56, v64 quad_perm:[0,1,2,3] row_mask:0xf bank_mask:0xc
    v_mov_b32_dpp v57, v65 quad_perm:[0,1,2,3] row_mask:0xf bank_mask:0xc
    v_mov_b32_dpp v58, v66 quad_perm:[0,1,2,3] row_mask:0xf bank_mask:0xc
    v_mov_b32_dpp v59, v67 quad_perm:[0,1,2,3] row_mask:0xf bank_mask:0xc
    v_mov_b32_dpp v60, v68 quad_perm:[0,1,2,3] row_mask:0xf bank_mask:0xc
    v_mov_b32_dpp v61, v69 quad_perm:[0,1,2,3] row_mask:0xf bank_mask:0xc
    v_fmac_f32 v26, v14, v54
    v_fmac_f32 v27, v15, v55
    v_fmac_f32 v28, v16, v56
    v_fmac_f32 v29, v17, v57
    v_fmac_f32 v30, v18, v58
    v_fmac_f32 v31, v19, v59
    v_fmac_f32 v32, v20, v60
    v_fmac_f32 v33, v21, v61
    v_cvt_pk_bf16_f32 v10, v26, v27
    v_cvt_pk_bf16_f32 v11, v28, v29
    v_cvt_pk_bf16_f32 v12, v30, v31
    v_cvt_pk_bf16_f32 v13, v32, v33
    buffer_store_dwordx4 v[10:13], v2, s[8:11], s34 offen sc1
    v_lshlrev_b32 v26, 16, v10
    v_and_b32 v27, 0xffff0000, v10
    v_lshlrev_b32 v28, 16, v11
    v_and_b32 v29, 0xffff0000, v11
    v_lshlrev_b32 v30, 16, v12
    v_and_b32 v31, 0xffff0000, v12
    v_lshlrev_b32 v32, 16, v13
    v_and_b32 v33, 0xffff0000, v13
    v_add_f32 v34, v26, v27
    v_mul_f32 v35, v26, v26
    v_fmac_f32 v35, v27, v27
    v_add_f32 v34, v34, v28
    v_fmac_f32 v35, v28, v28
    v_add_f32 v34, v34, v29
    v_fmac_f32 v35, v29, v29
    v_add_f32 v34, v34, v30
    v_fmac_f32 v35, v30, v30
    v_add_f32 v34, v34, v31
    v_fmac_f32 v35, v31, v31
    v_add_f32 v34, v34, v32
    v_fmac_f32 v35, v32, v32
    v_add_f32 v34, v34, v33
    v_fmac_f32 v35, v33, v33
    s_nop 1
    v_permlane32_swap_b32 v34, v35
    v_add_f32 v34, v34, v35
    v_mov_b32 v35, v34
    s_nop 1
    v_permlane16_swap_b32 v34, v35
    v_add_f32 v34, v34, v35
    s_nop 1
    v_add_f32_dpp v34, v34, v34 row_ror:8 row_mask:0xf bank_mask:0xf
    v_lshrrev_b32 v35, 5, v0
    v_lshlrev_b32 v35, 8, v35
    v_lshlrev_b32 v8, 5, v8
    s_lshl_b32 s33, s3, 2
    v_add3_u32 v35, v35, v8, s33
    ds_write_b32 v35, v34 offset:30976
    s_waitcnt lgkmcnt(0)
    s_barrier
    ds_read_b128 v[54:57], v8 offset:30976
    ds_read_b128 v[58:61], v8 offset:30992
    ds_read_b128 v[62:65], v8 offset:31232
    ds_read_b128 v[66:69], v8 offset:31248
    s_waitcnt lgkmcnt(0)
    v_pk_add_f32 v[54:55], v[54:55], v[56:57]
    v_pk_add_f32 v[58:59], v[58:59], v[60:61]
    v_pk_add_f32 v[62:63], v[62:63], v[64:65]
    v_pk_add_f32 v[66:67], v[66:67], v[68:69]
    v_pk_add_f32 v[54:55], v[54:55], v[58:59]
    v_pk_add_f32 v[62:63], v[62:63], v[66:67]
    v_add_f32 v54, v54, v55
    v_add_f32 v62, v62, v63
    v_mul_f32 v54, 0x3b000000, v54
    v_mul_f32 v62, 0x3b000000, v62
    v_fma_f32 v62, -v54, v54, v62
    v_max_f32 v62, 0, v62
    v_cvt_pk_bf16_f32 v62, v62, v54
    v_and_b32 v54, 0xffff0000, v62
    v_lshlrev_b32 v62, 16, v62
    v_add_f32 v62, 0x3727c5ac, v62
    v_cvt_pk_bf16_f32 v62, v62, v62
    v_lshlrev_b32 v62, 16, v62
    v_sqrt_f32 v62, v62
    s_nop 0
    v_cvt_pk_bf16_f32 v62, v62, v62
    v_lshlrev_b32 v62, 16, v62
    v_rcp_f32 v34, v62
    s_nop 0
    v_mul_f32 v35, -v54, v34
    v_fma_f32 v26, v26, v34, v35
    v_fma_f32 v27, v27, v34, v35
    v_fma_f32 v28, v28, v34, v35
    v_fma_f32 v29, v29, v34, v35
    v_fma_f32 v30, v30, v34, v35
    v_fma_f32 v31, v31, v34, v35
    v_fma_f32 v32, v32, v34, v35
    v_fma_f32 v33, v33, v34, v35
    v_pk_fma_f32 v[26:27], v[26:27], v[70:71], v[78:79]
    v_pk_fma_f32 v[28:29], v[28:29], v[72:73], v[80:81]
    v_pk_fma_f32 v[30:31], v[30:31], v[74:75], v[82:83]
    v_pk_fma_f32 v[32:33], v[32:33], v[76:77], v[84:85]
    v_cvt_pk_bf16_f32 v54, v26, v27
    v_cvt_pk_bf16_f32 v55, v28, v29
    v_cvt_pk_bf16_f32 v56, v30, v31
    v_cvt_pk_bf16_f32 v57, v32, v33
    buffer_store_dwordx4 v[54:57], v2, s[8:11], s35 offen sc1
.ffn_fused_kernel_3:
    s_lshr_b32 s36, s2, 3
    s_and_b32 s7, s3, 3
    s_add_u32 s38, s4, 1441792
    s_lshl_b32 s30, s36, 5
    s_lshl_b32 s34, s3, 2
    s_add_u32 s34, s34, s30
    s_add_u32 s34, s34, s38
    v_mov_b32 v9, 1
    s_lshr_b32 s40, s36, 1
    s_min_u32 s40, s40, 13
    s_lshl_b32 s29, s7, 11
    s_lshr_b32 s41, s7, 1
    s_lshl_b32 s42, s41, 3
    s_and_b32 s43, s7, 1
    s_add_u32 s42, s42, s43
    s_cmp_ge_u32 s3, 4
    s_cbranch_scc1 .loader_fused_kernel_71
    s_load_dwordx2 s[12:13], s[0:1], 80
    s_and_b32 s35, s2, 7
    s_and_b32 s37, s36, 1
    s_lshl_b32 s37, s37, 2
    s_add_u32 s37, s37, s3
    s_lshl_b32 s16, s37, 15
    s_add_u32 s16, s16, s4
    s_add_u32 s16, s16, 1179648
    s_lshl_b32 s17, s37, 7
    s_add_u32 s17, s17, s38
    s_mul_i32 s19, s37, 114688
    s_lshl_b32 s30, s40, 13
    s_add_u32 s19, s19, s30
    s_add_u32 s39, s4, 262144
    s_add_u32 s19, s19, s39
    s_add_u32 s20, s19, 4096
    s_add_u32 s25, s4, 1442816
    s_lshl_b32 s21, s37, 6
    s_lshl_b32 s30, s40, 2
    s_add_u32 s21, s21, s30
    s_add_u32 s21, s21, s25
    s_and_b32 s37, s36, 3
    s_lshr_b32 s36, s36, 2
    s_lshl_b32 s30, s37, 7
    s_add_u32 s25, s25, s30
    s_lshl_b32 s30, s41, 2
    s_add_u32 s25, s25, s30
    s_lshl_b32 s37, s37, 1
    s_add_u32 s37, s37, s41
    s_xor_b32 s38, s37, 1
    s_lshl_b32 s30, s42, 10
    s_add_u32 s30, s30, s39
    s_mul_i32 s22, s37, 114688
    s_mul_i32 s23, s38, 114688
    s_add_u32 s22, s22, s30
    s_add_u32 s23, s23, s30
    s_lshl_b32 s40, s36, 1
    s_add_u32 s40, s40, s43
    s_lshl_b32 s37, s37, 15
    s_lshl_b32 s26, s40, 11
    s_add_u32 s26, s26, s37
    s_add_u32 s26, s26, s4
    s_lshl_b32 s27, s36, 10
    s_lshl_b32 s30, s43, 7
    s_add_u32 s27, s27, s30
    s_add_u32 s27, s27, 5407488
    s_lshl_b32 s28, s40, 6
    s_add_u32 s28, s28, s37
    s_lshl_b32 s35, s35, 18
    s_add_u32 s28, s28, s35
    s_lshl_b32 s39, s43, 6
    s_add_u32 s39, s39, s29
    s_mov_b32 s31, 200000
    s_mov_b32 s14, 2097152
    v_and_b32 v8, 31, v0
    v_lshlrev_b32 v8, 2, v8
    v_lshrrev_b32 v10, 5, v0
    v_lshl_add_u32 v8, v10, 12, v8
    v_and_b32 v11, 7, v0
    v_min_u32 v11, 6, v11
    v_lshlrev_b32 v11, 3, v11
    v_bfe_u32 v6, v0, 4, 1
    v_lshl_add_u32 v11, v6, 6, v11
    v_lshl_add_u32 v11, v10, 12, v11
    v_bfe_u32 v5, v0, 2, 2
    v_lshl_add_u32 v4, v10, 2, v5
    v_lshlrev_b32 v4, 7, v4
    v_lshl_add_u32 v4, v6, 5, v4
    v_and_b32 v6, 3, v0
    v_lshl_add_u32 v4, v6, 3, v4
    v_lshrrev_b32 v5, 1, v5
    v_lshl_add_u32 v110, v5, 6, v4
    v_add_u32 v4, 98304, v110
    v_xor_b32 v5, 64, v4
    v_add_u32 v6, 32768, v110
    v_xor_b32 v7, 64, v6
    s_waitcnt vmcnt(0)
    s_cmp_eq_u32 s47, 0
    s_cbranch_scc1 .pslow_fused_kernel_72
    buffer_store_dword v9, off, s[8:11], s34 offset:0
.pback_fused_kernel_73:
    buffer_load_dword v10, v8, s[8:11], s17 offen offset:0 sc1
    s_waitcnt lgkmcnt(0)
    ds_read_b64_tr_b16 v[12:13], v4 offset:0
    ds_read_b64_tr_b16 v[14:15], v4 offset:2048
    ds_read_b64_tr_b16 v[16:17], v5 offset:0
    ds_read_b64_tr_b16 v[18:19], v5 offset:2048
    ds_read_b64_tr_b16 v[20:21], v4 offset:1024
    ds_read_b64_tr_b16 v[22:23], v4 offset:3072
    ds_read_b64_tr_b16 v[24:25], v5 offset:1024
    ds_read_b64_tr_b16 v[26:27], v5 offset:3072
    s_waitcnt vmcnt(0)
    v_cmp_ne_u32 s[32:33], 0, v10
    s_nop 1
    s_cmp_lg_u32 s32, -1
    s_cbranch_scc1 .test_fused_kernel_75
.ready_fused_kernel_76:
    buffer_load_dwordx4 a[0:3], v1, s[8:11], s16 offen offset:0 sc1
    buffer_load_dwordx4 a[4:7], v1, s[8:11], s16 offen offset:1024 sc1
    buffer_load_dwordx4 a[8:11], v1, s[8:11], s16 offen offset:2048 sc1
    buffer_load_dwordx4 a[12:15], v1, s[8:11], s16 offen offset:3072 sc1
    s_add_u32 s16, s16, 4096
    buffer_load_dwordx4 a[16:19], v1, s[8:11], s16 offen offset:0 sc1
    buffer_load_dwordx4 a[20:23], v1, s[8:11], s16 offen offset:1024 sc1
    buffer_load_dwordx4 a[24:27], v1, s[8:11], s16 offen offset:2048 sc1
    buffer_load_dwordx4 a[28:31], v1, s[8:11], s16 offen offset:3072 sc1
    s_add_u32 s16, s16, 4096
    v_mov_b32 v8, v11
    s_waitcnt vmcnt(7)
    s_waitcnt lgkmcnt(6)
    v_mfma_f32_32x32x16_bf16 v[28:43], v[12:15], a[0:3], 0
    ds_read_b64_tr_b16 a[128:129], v4 offset:4096
    ds_read_b64_tr_b16 a[130:131], v4 offset:6144
    buffer_load_dwordx4 a[32:35], v1, s[8:11], s16 offen offset:0 sc1
    s_waitcnt lgkmcnt(6)
    v_mfma_f32_32x32x16_bf16 v[44:59], v[16:19], a[0:3], 0
    ds_read_b64_tr_b16 a[132:133], v5 offset:4096
    ds_read_b64_tr_b16 a[134:135], v5 offset:6144
    buffer_load_dwordx4 a[36:39], v1, s[8:11], s16 offen offset:1024 sc1
    s_waitcnt vmcnt(8)
    s_waitcnt lgkmcnt(6)
    v_mfma_f32_32x32x16_bf16 v[28:43], v[20:23], a[4:7], v[28:43]
    ds_read_b64_tr_b16 a[136:137], v4 offset:5120
    ds_read_b64_tr_b16 a[138:139], v4 offset:7168
    buffer_load_dwordx4 a[40:43], v1, s[8:11], s16 offen offset:2048 sc1
    s_waitcnt lgkmcnt(6)
    v_mfma_f32_32x32x16_bf16 v[44:59], v[24:27], a[4:7], v[44:59]
    ds_read_b64_tr_b16 a[140:141], v5 offset:5120
    ds_read_b64_tr_b16 a[142:143], v5 offset:7168
    buffer_load_dwordx4 a[44:47], v1, s[8:11], s16 offen offset:3072 sc1
    s_add_u32 s16, s16, 4096
    s_waitcnt vmcnt(9)
    s_waitcnt lgkmcnt(6)
    v_mfma_f32_32x32x16_bf16 v[28:43], a[128:131], a[8:11], v[28:43]
    ds_read_b64_tr_b16 v[12:13], v4 offset:8192
    ds_read_b64_tr_b16 v[14:15], v4 offset:10240
    buffer_load_dwordx4 a[48:51], v1, s[8:11], s16 offen offset:0 sc1
    s_waitcnt lgkmcnt(6)
    v_mfma_f32_32x32x16_bf16 v[44:59], a[132:135], a[8:11], v[44:59]
    ds_read_b64_tr_b16 v[16:17], v5 offset:8192
    ds_read_b64_tr_b16 v[18:19], v5 offset:10240
    buffer_load_dwordx4 a[52:55], v1, s[8:11], s16 offen offset:1024 sc1
    s_waitcnt vmcnt(10)
    s_waitcnt lgkmcnt(6)
    v_mfma_f32_32x32x16_bf16 v[28:43], a[136:139], a[12:15], v[28:43]
    ds_read_b64_tr_b16 v[20:21], v4 offset:9216
    ds_read_b64_tr_b16 v[22:23], v4 offset:11264
    buffer_load_dwordx4 a[56:59], v1, s[8:11], s16 offen offset:2048 sc1
    s_waitcnt lgkmcnt(6)
    v_mfma_f32_32x32x16_bf16 v[44:59], a[140:143], a[12:15], v[44:59]
    ds_read_b64_tr_b16 v[24:25], v5 offset:9216
    ds_read_b64_tr_b16 v[26:27], v5 offset:11264
    buffer_load_dwordx4 a[60:63], v1, s[8:11], s16 offen offset:3072 sc1
    s_add_u32 s16, s16, 4096
    s_waitcnt vmcnt(11)
    s_waitcnt lgkmcnt(6)
    v_mfma_f32_32x32x16_bf16 v[28:43], v[12:15], a[16:19], v[28:43]
    ds_read_b64_tr_b16 a[128:129], v4 offset:12288
    ds_read_b64_tr_b16 a[130:131], v4 offset:14336
    buffer_load_dwordx4 a[64:67], v1, s[8:11], s16 offen offset:0 sc1
    s_waitcnt lgkmcnt(6)
    v_mfma_f32_32x32x16_bf16 v[44:59], v[16:19], a[16:19], v[44:59]
    ds_read_b64_tr_b16 a[132:133], v5 offset:12288
    ds_read_b64_tr_b16 a[134:135], v5 offset:14336
    buffer_load_dwordx4 a[68:71], v1, s[8:11], s16 offen offset:1024 sc1
    s_waitcnt vmcnt(12)
    s_waitcnt lgkmcnt(6)
    v_mfma_f32_32x32x16_bf16 v[28:43], v[20:23], a[20:23], v[28:43]
    ds_read_b64_tr_b16 a[136:137], v4 offset:13312
    ds_read_b64_tr_b16 a[138:139], v4 offset:15360
    buffer_load_dwordx4 a[72:75], v1, s[8:11], s16 offen offset:2048 sc1
    s_waitcnt lgkmcnt(6)
    v_mfma_f32_32x32x16_bf16 v[44:59], v[24:27], a[20:23], v[44:59]
    ds_read_b64_tr_b16 a[140:141], v5 offset:13312
    ds_read_b64_tr_b16 a[142:143], v5 offset:15360
    buffer_load_dwordx4 a[76:79], v1, s[8:11], s16 offen offset:3072 sc1
    s_add_u32 s16, s16, 4096
    s_waitcnt vmcnt(13)
    s_waitcnt lgkmcnt(6)
    v_mfma_f32_32x32x16_bf16 v[28:43], a[128:131], a[24:27], v[28:43]
    ds_read_b64_tr_b16 v[12:13], v4 offset:16384
    ds_read_b64_tr_b16 v[14:15], v4 offset:18432
    buffer_load_dwordx4 a[80:83], v1, s[8:11], s16 offen offset:0 sc1
    s_waitcnt lgkmcnt(6)
    v_mfma_f32_32x32x16_bf16 v[44:59], a[132:135], a[24:27], v[44:59]
    ds_read_b64_tr_b16 v[16:17], v5 offset:16384
    ds_read_b64_tr_b16 v[18:19], v5 offset:18432
    buffer_load_dwordx4 a[84:87], v1, s[8:11], s16 offen offset:1024 sc1
    s_waitcnt vmcnt(14)
    s_waitcnt lgkmcnt(6)
    v_mfma_f32_32x32x16_bf16 v[28:43], a[136:139], a[28:31], v[28:43]
    ds_read_b64_tr_b16 v[20:21], v4 offset:17408
    ds_read_b64_tr_b16 v[22:23], v4 offset:19456
    buffer_load_dwordx4 a[88:91], v1, s[8:11], s16 offen offset:2048 sc1
    s_waitcnt lgkmcnt(6)
    v_mfma_f32_32x32x16_bf16 v[44:59], a[140:143], a[28:31], v[44:59]
    ds_read_b64_tr_b16 v[24:25], v5 offset:17408
    ds_read_b64_tr_b16 v[26:27], v5 offset:19456
    buffer_load_dwordx4 a[92:95], v1, s[8:11], s16 offen offset:3072 sc1
    s_add_u32 s16, s16, 4096
    s_waitcnt vmcnt(15)
    s_waitcnt lgkmcnt(6)
    v_mfma_f32_32x32x16_bf16 v[28:43], v[12:15], a[32:35], v[28:43]
    ds_read_b64_tr_b16 a[128:129], v4 offset:20480
    ds_read_b64_tr_b16 a[130:131], v4 offset:22528
    buffer_load_dwordx4 a[96:99], v1, s[8:11], s16 offen offset:0 sc1
    s_waitcnt lgkmcnt(6)
    v_mfma_f32_32x32x16_bf16 v[44:59], v[16:19], a[32:35], v[44:59]
    ds_read_b64_tr_b16 a[132:133], v5 offset:20480
    ds_read_b64_tr_b16 a[134:135], v5 offset:22528
    buffer_load_dwordx4 a[100:103], v1, s[8:11], s16 offen offset:1024 sc1
    s_waitcnt vmcnt(16)
    s_waitcnt lgkmcnt(6)
    v_mfma_f32_32x32x16_bf16 v[28:43], v[20:23], a[36:39], v[28:43]
    ds_read_b64_tr_b16 a[136:137], v4 offset:21504
    ds_read_b64_tr_b16 a[138:139], v4 offset:23552
    buffer_load_dwordx4 a[104:107], v1, s[8:11], s16 offen offset:2048 sc1
    s_waitcnt lgkmcnt(6)
    v_mfma_f32_32x32x16_bf16 v[44:59], v[24:27], a[36:39], v[44:59]
    ds_read_b64_tr_b16 a[140:141], v5 offset:21504
    ds_read_b64_tr_b16 a[142:143], v5 offset:23552
    buffer_load_dwordx4 a[108:111], v1, s[8:11], s16 offen offset:3072 sc1
    s_add_u32 s16, s16, 4096
    s_waitcnt vmcnt(17)
    s_waitcnt lgkmcnt(6)
    v_mfma_f32_32x32x16_bf16 v[28:43], a[128:131], a[40:43], v[28:43]
    ds_read_b64_tr_b16 v[12:13], v4 offset:24576
    ds_read_b64_tr_b16 v[14:15], v4 offset:26624
    buffer_load_dwordx4 a[112:115], v1, s[8:11], s16 offen offset:0 sc1
    s_waitcnt lgkmcnt(6)
    v_mfma_f32_32x32x16_bf16 v[44:59], a[132:135], a[40:43], v[44:59]
    ds_read_b64_tr_b16 v[16:17], v5 offset:24576
    ds_read_b64_tr_b16 v[18:19], v5 offset:26624
    buffer_load_dwordx4 a[116:119], v1, s[8:11], s16 offen offset:1024 sc1
    s_waitcnt vmcnt(18)
    s_waitcnt lgkmcnt(6)
    v_mfma_f32_32x32x16_bf16 v[28:43], a[136:139], a[44:47], v[28:43]
    ds_read_b64_tr_b16 v[20:21], v4 offset:25600
    ds_read_b64_tr_b16 v[22:23], v4 offset:27648
    buffer_load_dwordx4 a[120:123], v1, s[8:11], s16 offen offset:2048 sc1
    s_waitcnt lgkmcnt(6)
    v_mfma_f32_32x32x16_bf16 v[44:59], a[140:143], a[44:47], v[44:59]
    ds_read_b64_tr_b16 v[24:25], v5 offset:25600
    ds_read_b64_tr_b16 v[26:27], v5 offset:27648
    buffer_load_dwordx4 a[124:127], v1, s[8:11], s16 offen offset:3072 sc1
    s_waitcnt vmcnt(19)
    s_waitcnt lgkmcnt(6)
    s_barrier
    v_mfma_f32_32x32x16_bf16 v[28:43], v[12:15], a[48:51], v[28:43]
    ds_read_b64_tr_b16 a[128:129], v4 offset:28672
    ds_read_b64_tr_b16 a[130:131], v4 offset:30720
    s_waitcnt lgkmcnt(6)
    v_mfma_f32_32x32x16_bf16 v[44:59], v[16:19], a[48:51], v[44:59]
    ds_read_b64_tr_b16 a[132:133], v5 offset:28672
    ds_read_b64_tr_b16 a[134:135], v5 offset:30720
    s_waitcnt vmcnt(18)
    s_waitcnt lgkmcnt(6)
    v_mfma_f32_32x32x16_bf16 v[28:43], v[20:23], a[52:55], v[28:43]
    ds_read_b64_tr_b16 a[136:137], v4 offset:29696
    ds_read_b64_tr_b16 a[138:139], v4 offset:31744
    s_waitcnt lgkmcnt(6)
    v_mfma_f32_32x32x16_bf16 v[44:59], v[24:27], a[52:55], v[44:59]
    ds_read_b64_tr_b16 a[140:141], v5 offset:29696
    ds_read_b64_tr_b16 a[142:143], v5 offset:31744
    s_waitcnt vmcnt(17)
    s_waitcnt lgkmcnt(6)
    v_mfma_f32_32x32x16_bf16 v[28:43], a[128:131], a[56:59], v[28:43]
    ds_read_b64_tr_b16 v[12:13], v4 offset:32768
    ds_read_b64_tr_b16 v[14:15], v4 offset:34816
    s_waitcnt lgkmcnt(6)
    v_mfma_f32_32x32x16_bf16 v[44:59], a[132:135], a[56:59], v[44:59]
    ds_read_b64_tr_b16 v[16:17], v5 offset:32768
    ds_read_b64_tr_b16 v[18:19], v5 offset:34816
    s_waitcnt vmcnt(16)
    s_waitcnt lgkmcnt(6)
    v_mfma_f32_32x32x16_bf16 v[28:43], a[136:139], a[60:63], v[28:43]
    ds_read_b64_tr_b16 v[20:21], v4 offset:33792
    ds_read_b64_tr_b16 v[22:23], v4 offset:35840
    s_waitcnt lgkmcnt(6)
    v_mfma_f32_32x32x16_bf16 v[44:59], a[140:143], a[60:63], v[44:59]
    ds_read_b64_tr_b16 v[24:25], v5 offset:33792
    ds_read_b64_tr_b16 v[26:27], v5 offset:35840
    s_waitcnt vmcnt(15)
    s_waitcnt lgkmcnt(6)
    v_mfma_f32_32x32x16_bf16 v[28:43], v[12:15], a[64:67], v[28:43]
    ds_read_b64_tr_b16 a[128:129], v4 offset:36864
    ds_read_b64_tr_b16 a[130:131], v4 offset:38912
    s_waitcnt lgkmcnt(6)
    v_mfma_f32_32x32x16_bf16 v[44:59], v[16:19], a[64:67], v[44:59]
    ds_read_b64_tr_b16 a[132:133], v5 offset:36864
    ds_read_b64_tr_b16 a[134:135], v5 offset:38912
    s_waitcnt vmcnt(14)
    s_waitcnt lgkmcnt(6)
    v_mfma_f32_32x32x16_bf16 v[28:43], v[20:23], a[68:71], v[28:43]
    ds_read_b64_tr_b16 a[136:137], v4 offset:37888
    ds_read_b64_tr_b16 a[138:139], v4 offset:39936
    s_waitcnt lgkmcnt(6)
    v_mfma_f32_32x32x16_bf16 v[44:59], v[24:27], a[68:71], v[44:59]
    ds_read_b64_tr_b16 a[140:141], v5 offset:37888
    ds_read_b64_tr_b16 a[142:143], v5 offset:39936
    s_waitcnt vmcnt(13)
    s_waitcnt lgkmcnt(6)
    v_mfma_f32_32x32x16_bf16 v[28:43], a[128:131], a[72:75], v[28:43]
    ds_read_b64_tr_b16 v[12:13], v4 offset:40960
    ds_read_b64_tr_b16 v[14:15], v4 offset:43008
    s_waitcnt lgkmcnt(6)
    v_mfma_f32_32x32x16_bf16 v[44:59], a[132:135], a[72:75], v[44:59]
    ds_read_b64_tr_b16 v[16:17], v5 offset:40960
    ds_read_b64_tr_b16 v[18:19], v5 offset:43008
    s_waitcnt vmcnt(12)
    s_waitcnt lgkmcnt(6)
    v_mfma_f32_32x32x16_bf16 v[28:43], a[136:139], a[76:79], v[28:43]
    ds_read_b64_tr_b16 v[20:21], v4 offset:41984
    ds_read_b64_tr_b16 v[22:23], v4 offset:44032
    s_waitcnt lgkmcnt(6)
    v_mfma_f32_32x32x16_bf16 v[44:59], a[140:143], a[76:79], v[44:59]
    ds_read_b64_tr_b16 v[24:25], v5 offset:41984
    ds_read_b64_tr_b16 v[26:27], v5 offset:44032
    s_waitcnt vmcnt(11)
    s_waitcnt lgkmcnt(6)
    v_mfma_f32_32x32x16_bf16 v[28:43], v[12:15], a[80:83], v[28:43]
    ds_read_b64_tr_b16 a[128:129], v4 offset:45056
    ds_read_b64_tr_b16 a[130:131], v4 offset:47104
    s_waitcnt lgkmcnt(6)
    v_mfma_f32_32x32x16_bf16 v[44:59], v[16:19], a[80:83], v[44:59]
    ds_read_b64_tr_b16 a[132:133], v5 offset:45056
    ds_read_b64_tr_b16 a[134:135], v5 offset:47104
    s_waitcnt vmcnt(10)
    s_waitcnt lgkmcnt(6)
    v_mfma_f32_32x32x16_bf16 v[28:43], v[20:23], a[84:87], v[28:43]
    ds_read_b64_tr_b16 a[136:137], v4 offset:46080
    ds_read_b64_tr_b16 a[138:139], v4 offset:48128
    s_waitcnt lgkmcnt(6)
    v_mfma_f32_32x32x16_bf16 v[44:59], v[24:27], a[84:87], v[44:59]
    ds_read_b64_tr_b16 a[140:141], v5 offset:46080
    ds_read_b64_tr_b16 a[142:143], v5 offset:48128
    s_waitcnt vmcnt(9)
    s_waitcnt lgkmcnt(6)
    v_mfma_f32_32x32x16_bf16 v[28:43], a[128:131], a[88:91], v[28:43]
    ds_read_b64_tr_b16 v[12:13], v4 offset:49152
    ds_read_b64_tr_b16 v[14:15], v4 offset:51200
    s_waitcnt lgkmcnt(6)
    v_mfma_f32_32x32x16_bf16 v[44:59], a[132:135], a[88:91], v[44:59]
    ds_read_b64_tr_b16 v[16:17], v5 offset:49152
    ds_read_b64_tr_b16 v[18:19], v5 offset:51200
    s_waitcnt vmcnt(8)
    s_waitcnt lgkmcnt(6)
    v_mfma_f32_32x32x16_bf16 v[28:43], a[136:139], a[92:95], v[28:43]
    ds_read_b64_tr_b16 v[20:21], v4 offset:50176
    ds_read_b64_tr_b16 v[22:23], v4 offset:52224
    s_waitcnt lgkmcnt(6)
    v_mfma_f32_32x32x16_bf16 v[44:59], a[140:143], a[92:95], v[44:59]
    ds_read_b64_tr_b16 v[24:25], v5 offset:50176
    ds_read_b64_tr_b16 v[26:27], v5 offset:52224
    s_waitcnt vmcnt(7)
    s_waitcnt lgkmcnt(6)
    v_mfma_f32_32x32x16_bf16 v[28:43], v[12:15], a[96:99], v[28:43]
    ds_read_b64_tr_b16 a[128:129], v4 offset:53248
    ds_read_b64_tr_b16 a[130:131], v4 offset:55296
    s_waitcnt lgkmcnt(6)
    v_mfma_f32_32x32x16_bf16 v[44:59], v[16:19], a[96:99], v[44:59]
    ds_read_b64_tr_b16 a[132:133], v5 offset:53248
    ds_read_b64_tr_b16 a[134:135], v5 offset:55296
    s_waitcnt vmcnt(6)
    s_waitcnt lgkmcnt(6)
    v_mfma_f32_32x32x16_bf16 v[28:43], v[20:23], a[100:103], v[28:43]
    ds_read_b64_tr_b16 a[136:137], v4 offset:54272
    ds_read_b64_tr_b16 a[138:139], v4 offset:56320
    s_waitcnt lgkmcnt(6)
    v_mfma_f32_32x32x16_bf16 v[44:59], v[24:27], a[100:103], v[44:59]
    ds_read_b64_tr_b16 a[140:141], v5 offset:54272
    ds_read_b64_tr_b16 a[142:143], v5 offset:56320
    s_waitcnt vmcnt(5)
    s_waitcnt lgkmcnt(6)
    v_mfma_f32_32x32x16_bf16 v[28:43], a[128:131], a[104:107], v[28:43]
    ds_read_b64_tr_b16 v[12:13], v4 offset:57344
    ds_read_b64_tr_b16 v[14:15], v4 offset:59392
    s_waitcnt lgkmcnt(6)
    v_mfma_f32_32x32x16_bf16 v[44:59], a[132:135], a[104:107], v[44:59]
    ds_read_b64_tr_b16 v[16:17], v5 offset:57344
    ds_read_b64_tr_b16 v[18:19], v5 offset:59392
    s_waitcnt vmcnt(4)
    s_waitcnt lgkmcnt(6)
    v_mfma_f32_32x32x16_bf16 v[28:43], a[136:139], a[108:111], v[28:43]
    ds_read_b64_tr_b16 v[20:21], v4 offset:58368
    ds_read_b64_tr_b16 v[22:23], v4 offset:60416
    s_waitcnt lgkmcnt(6)
    v_mfma_f32_32x32x16_bf16 v[44:59], a[140:143], a[108:111], v[44:59]
    ds_read_b64_tr_b16 v[24:25], v5 offset:58368
    ds_read_b64_tr_b16 v[26:27], v5 offset:60416
    s_waitcnt vmcnt(3)
    s_waitcnt lgkmcnt(6)
    v_mfma_f32_32x32x16_bf16 v[28:43], v[12:15], a[112:115], v[28:43]
    ds_read_b64_tr_b16 a[128:129], v4 offset:61440
    ds_read_b64_tr_b16 a[130:131], v4 offset:63488
    s_waitcnt lgkmcnt(6)
    v_mfma_f32_32x32x16_bf16 v[44:59], v[16:19], a[112:115], v[44:59]
    ds_read_b64_tr_b16 a[132:133], v5 offset:61440
    ds_read_b64_tr_b16 a[134:135], v5 offset:63488
    s_waitcnt vmcnt(2)
    s_waitcnt lgkmcnt(6)
    v_mfma_f32_32x32x16_bf16 v[28:43], v[20:23], a[116:119], v[28:43]
    ds_read_b64_tr_b16 a[136:137], v4 offset:62464
    ds_read_b64_tr_b16 a[138:139], v4 offset:64512
    s_waitcnt lgkmcnt(6)
    v_mfma_f32_32x32x16_bf16 v[44:59], v[24:27], a[116:119], v[44:59]
    ds_read_b64_tr_b16 a[140:141], v5 offset:62464
    ds_read_b64_tr_b16 a[142:143], v5 offset:64512
    s_waitcnt vmcnt(1)
    s_waitcnt lgkmcnt(6)
    v_mfma_f32_32x32x16_bf16 v[28:43], a[128:131], a[120:123], v[28:43]
    ds_read_b64_tr_b16 v[12:13], v6 offset:49152
    ds_read_b64_tr_b16 v[14:15], v6 offset:51200
    s_waitcnt lgkmcnt(6)
    v_mfma_f32_32x32x16_bf16 v[44:59], a[132:135], a[120:123], v[44:59]
    ds_read_b64_tr_b16 v[16:17], v7 offset:49152
    ds_read_b64_tr_b16 v[18:19], v7 offset:51200
    s_waitcnt vmcnt(0)
    s_waitcnt lgkmcnt(6)
    v_mfma_f32_32x32x16_bf16 v[28:43], a[136:139], a[124:127], v[28:43]
    ds_read_b64_tr_b16 v[20:21], v6 offset:50176
    ds_read_b64_tr_b16 v[22:23], v6 offset:52224
    s_waitcnt lgkmcnt(6)
    s_barrier
    v_mfma_f32_32x32x16_bf16 v[44:59], a[140:143], a[124:127], v[44:59]
    ds_read_b64_tr_b16 v[24:25], v7 offset:50176
    ds_read_b64_tr_b16 v[26:27], v7 offset:52224
    s_waitcnt lgkmcnt(6)
    v_mfma_f32_32x32x16_bf16 v[60:75], v[12:15], a[0:3], 0
    ds_read_b64_tr_b16 a[128:129], v6 offset:53248
    ds_read_b64_tr_b16 a[130:131], v6 offset:55296
    s_nop 0
    v_exp_f32 v92, -v28
    v_exp_f32 v93, -v29
    v_exp_f32 v94, -v30
    v_exp_f32 v95, -v31
    v_exp_f32 v96, -v32
    v_exp_f32 v97, -v33
    s_waitcnt lgkmcnt(6)
    v_mfma_f32_32x32x16_bf16 v[76:91], v[16:19], a[0:3], 0
    ds_read_b64_tr_b16 a[132:133], v7 offset:53248
    ds_read_b64_tr_b16 a[134:135], v7 offset:55296
    v_exp_f32 v98, -v34
    v_exp_f32 v99, -v35
    v_add_f32 v92, 1.0, v92
    v_add_f32 v93, 1.0, v93
    v_add_f32 v94, 1.0, v94
    v_add_f32 v95, 1.0, v95
    s_waitcnt lgkmcnt(6)
    v_mfma_f32_32x32x16_bf16 v[60:75], v[20:23], a[4:7], v[60:75]
    ds_read_b64_tr_b16 a[136:137], v6 offset:54272
    ds_read_b64_tr_b16 a[138:139], v6 offset:56320
    v_add_f32 v96, 1.0, v96
    v_add_f32 v97, 1.0, v97
    v_add_f32 v98, 1.0, v98
    v_add_f32 v99, 1.0, v99
    v_rcp_f32 v92, v92
    v_rcp_f32 v93, v93
    s_waitcnt lgkmcnt(6)
    v_mfma_f32_32x32x16_bf16 v[76:91], v[24:27], a[4:7], v[76:91]
    ds_read_b64_tr_b16 a[140:141], v7 offset:54272
    ds_read_b64_tr_b16 a[142:143], v7 offset:56320
    v_rcp_f32 v94, v94
    v_rcp_f32 v95, v95
    v_rcp_f32 v96, v96
    v_rcp_f32 v97, v97
    v_rcp_f32 v98, v98
    v_rcp_f32 v99, v99
    s_waitcnt lgkmcnt(6)
    v_mfma_f32_32x32x16_bf16 v[60:75], a[128:131], a[8:11], v[60:75]
    ds_read_b64_tr_b16 v[12:13], v6 offset:57344
    ds_read_b64_tr_b16 v[14:15], v6 offset:59392
    v_mul_f32 v92, v92, v28
    v_mul_f32 v93, v93, v29
    v_mul_f32 v94, v94, v30
    v_mul_f32 v95, v95, v31
    v_mul_f32 v96, v96, v32
    v_mul_f32 v97, v97, v33
    s_waitcnt lgkmcnt(6)
    v_mfma_f32_32x32x16_bf16 v[76:91], a[132:135], a[8:11], v[76:91]
    ds_read_b64_tr_b16 v[16:17], v7 offset:57344
    ds_read_b64_tr_b16 v[18:19], v7 offset:59392
    v_mul_f32 v98, v98, v34
    v_mul_f32 v99, v99, v35
    v_cvt_pk_bf16_f32 v28, v92, v93
    v_cvt_pk_bf16_f32 v29, v94, v95
    v_cvt_pk_bf16_f32 v30, v96, v97
    v_cvt_pk_bf16_f32 v31, v98, v99
    s_waitcnt lgkmcnt(6)
    v_mfma_f32_32x32x16_bf16 v[60:75], a[136:139], a[12:15], v[60:75]
    ds_read_b64_tr_b16 v[20:21], v6 offset:58368
    ds_read_b64_tr_b16 v[22:23], v6 offset:60416
    buffer_store_dwordx4 v[28:31], v1, s[8:11], s19 offen offset:0 sc1
    v_exp_f32 v100, -v36
    v_exp_f32 v101, -v37
    v_exp_f32 v102, -v38
    v_exp_f32 v103, -v39
    v_exp_f32 v104, -v40
    s_waitcnt lgkmcnt(6)
    v_mfma_f32_32x32x16_bf16 v[76:91], a[140:143], a[12:15], v[76:91]
    ds_read_b64_tr_b16 v[24:25], v7 offset:58368
    ds_read_b64_tr_b16 v[26:27], v7 offset:60416
    v_exp_f32 v105, -v41
    v_exp_f32 v106, -v42
    v_exp_f32 v107, -v43
    v_add_f32 v100, 1.0, v100
    v_add_f32 v101, 1.0, v101
    v_add_f32 v102, 1.0, v102
    s_waitcnt lgkmcnt(6)
    v_mfma_f32_32x32x16_bf16 v[60:75], v[12:15], a[16:19], v[60:75]
    ds_read_b64_tr_b16 a[128:129], v6 offset:61440
    ds_read_b64_tr_b16 a[130:131], v6 offset:63488
    v_add_f32 v103, 1.0, v103
    v_add_f32 v104, 1.0, v104
    v_add_f32 v105, 1.0, v105
    v_add_f32 v106, 1.0, v106
    v_add_f32 v107, 1.0, v107
    v_rcp_f32 v100, v100
    s_waitcnt lgkmcnt(6)
    v_mfma_f32_32x32x16_bf16 v[76:91], v[16:19], a[16:19], v[76:91]
    ds_read_b64_tr_b16 a[132:133], v7 offset:61440
    ds_read_b64_tr_b16 a[134:135], v7 offset:63488
    v_rcp_f32 v101, v101
    v_rcp_f32 v102, v102
    v_rcp_f32 v103, v103
    v_rcp_f32 v104, v104
    v_rcp_f32 v105, v105
    v_rcp_f32 v106, v106
    s_waitcnt lgkmcnt(6)
    v_mfma_f32_32x32x16_bf16 v[60:75], v[20:23], a[20:23], v[60:75]
    ds_read_b64_tr_b16 a[136:137], v6 offset:62464
    ds_read_b64_tr_b16 a[138:139], v6 offset:64512
    v_rcp_f32 v107, v107
    v_mul_f32 v100, v100, v36
    v_mul_f32 v101, v101, v37
    v_mul_f32 v102, v102, v38
    v_mul_f32 v103, v103, v39
    v_mul_f32 v104, v104, v40
    s_waitcnt lgkmcnt(6)
    v_mfma_f32_32x32x16_bf16 v[76:91], v[24:27], a[20:23], v[76:91]
    ds_read_b64_tr_b16 a[140:141], v7 offset:62464
    ds_read_b64_tr_b16 a[142:143], v7 offset:64512
    v_mul_f32 v105, v105, v41
    v_mul_f32 v106, v106, v42
    v_mul_f32 v107, v107, v43
    v_cvt_pk_bf16_f32 v36, v100, v101
    v_cvt_pk_bf16_f32 v37, v102, v103
    v_cvt_pk_bf16_f32 v38, v104, v105
    s_waitcnt lgkmcnt(6)
    v_mfma_f32_32x32x16_bf16 v[60:75], a[128:131], a[24:27], v[60:75]
    ds_read_b64_tr_b16 v[12:13], v6 offset:0
    ds_read_b64_tr_b16 v[14:15], v6 offset:2048
    v_cvt_pk_bf16_f32 v39, v106, v107
    buffer_store_dwordx4 v[36:39], v1, s[8:11], s19 offen offset:1024 sc1
    v_exp_f32 v92, -v44
    v_exp_f32 v93, -v45
    v_exp_f32 v94, -v46
    v_exp_f32 v95, -v47
    s_waitcnt lgkmcnt(6)
    v_mfma_f32_32x32x16_bf16 v[76:91], a[132:135], a[24:27], v[76:91]
    ds_read_b64_tr_b16 v[16:17], v7 offset:0
    ds_read_b64_tr_b16 v[18:19], v7 offset:2048
    v_exp_f32 v96, -v48
    v_exp_f32 v97, -v49
    v_exp_f32 v98, -v50
    v_exp_f32 v99, -v51
    v_add_f32 v92, 1.0, v92
    v_add_f32 v93, 1.0, v93
    s_waitcnt lgkmcnt(6)
    v_mfma_f32_32x32x16_bf16 v[60:75], a[136:139], a[28:31], v[60:75]
    ds_read_b64_tr_b16 v[20:21], v6 offset:1024
    ds_read_b64_tr_b16 v[22:23], v6 offset:3072
    v_add_f32 v94, 1.0, v94
    v_add_f32 v95, 1.0, v95
    v_add_f32 v96, 1.0, v96
    v_add_f32 v97, 1.0, v97
    v_add_f32 v98, 1.0, v98
    v_add_f32 v99, 1.0, v99
    s_waitcnt lgkmcnt(6)
    v_mfma_f32_32x32x16_bf16 v[76:91], a[140:143], a[28:31], v[76:91]
    ds_read_b64_tr_b16 v[24:25], v7 offset:1024
    ds_read_b64_tr_b16 v[26:27], v7 offset:3072
    v_rcp_f32 v92, v92
    v_rcp_f32 v93, v93
    v_rcp_f32 v94, v94
    v_rcp_f32 v95, v95
    v_rcp_f32 v96, v96
    v_rcp_f32 v97, v97
    s_waitcnt lgkmcnt(6)
    v_mfma_f32_32x32x16_bf16 v[60:75], v[12:15], a[32:35], v[60:75]
    ds_read_b64_tr_b16 a[128:129], v6 offset:4096
    ds_read_b64_tr_b16 a[130:131], v6 offset:6144
    v_rcp_f32 v98, v98
    v_rcp_f32 v99, v99
    v_mul_f32 v92, v92, v44
    v_mul_f32 v93, v93, v45
    v_mul_f32 v94, v94, v46
    v_mul_f32 v95, v95, v47
    s_waitcnt lgkmcnt(6)
    v_mfma_f32_32x32x16_bf16 v[76:91], v[16:19], a[32:35], v[76:91]
    ds_read_b64_tr_b16 a[132:133], v7 offset:4096
    ds_read_b64_tr_b16 a[134:135], v7 offset:6144
    v_mul_f32 v96, v96, v48
    v_mul_f32 v97, v97, v49
    v_mul_f32 v98, v98, v50
    v_mul_f32 v99, v99, v51
    v_cvt_pk_bf16_f32 v44, v92, v93
    v_cvt_pk_bf16_f32 v45, v94, v95
    s_waitcnt lgkmcnt(6)
    v_mfma_f32_32x32x16_bf16 v[60:75], v[20:23], a[36:39], v[60:75]
    ds_read_b64_tr_b16 a[136:137], v6 offset:5120
    ds_read_b64_tr_b16 a[138:139], v6 offset:7168
    v_cvt_pk_bf16_f32 v46, v96, v97
    v_cvt_pk_bf16_f32 v47, v98, v99
    buffer_store_dwordx4 v[44:47], v1, s[8:11], s19 offen offset:2048 sc1
    v_exp_f32 v100, -v52
    v_exp_f32 v101, -v53
    v_exp_f32 v102, -v54
    s_waitcnt lgkmcnt(6)
    v_mfma_f32_32x32x16_bf16 v[76:91], v[24:27], a[36:39], v[76:91]
    ds_read_b64_tr_b16 a[140:141], v7 offset:5120
    ds_read_b64_tr_b16 a[142:143], v7 offset:7168
    v_exp_f32 v103, -v55
    v_exp_f32 v104, -v56
    v_exp_f32 v105, -v57
    v_exp_f32 v106, -v58
    v_exp_f32 v107, -v59
    v_add_f32 v100, 1.0, v100
    s_waitcnt lgkmcnt(6)
    v_mfma_f32_32x32x16_bf16 v[60:75], a[128:131], a[40:43], v[60:75]
    ds_read_b64_tr_b16 v[12:13], v6 offset:8192
    ds_read_b64_tr_b16 v[14:15], v6 offset:10240
    v_add_f32 v101, 1.0, v101
    v_add_f32 v102, 1.0, v102
    v_add_f32 v103, 1.0, v103
    v_add_f32 v104, 1.0, v104
    v_add_f32 v105, 1.0, v105
    v_add_f32 v106, 1.0, v106
    s_waitcnt lgkmcnt(6)
    v_mfma_f32_32x32x16_bf16 v[76:91], a[132:135], a[40:43], v[76:91]
    ds_read_b64_tr_b16 v[16:17], v7 offset:8192
    ds_read_b64_tr_b16 v[18:19], v7 offset:10240
    v_add_f32 v107, 1.0, v107
    v_rcp_f32 v100, v100
    v_rcp_f32 v101, v101
    v_rcp_f32 v102, v102
    v_rcp_f32 v103, v103
    v_rcp_f32 v104, v104
    s_waitcnt lgkmcnt(6)
    v_mfma_f32_32x32x16_bf16 v[60:75], a[136:139], a[44:47], v[60:75]
    ds_read_b64_tr_b16 v[20:21], v6 offset:9216
    ds_read_b64_tr_b16 v[22:23], v6 offset:11264
    v_rcp_f32 v105, v105
    v_rcp_f32 v106, v106
    v_rcp_f32 v107, v107
    v_mul_f32 v100, v100, v52
    v_mul_f32 v101, v101, v53
    v_mul_f32 v102, v102, v54
    s_waitcnt lgkmcnt(6)
    v_mfma_f32_32x32x16_bf16 v[76:91], a[140:143], a[44:47], v[76:91]
    ds_read_b64_tr_b16 v[24:25], v7 offset:9216
    ds_read_b64_tr_b16 v[26:27], v7 offset:11264
    v_mul_f32 v103, v103, v55
    v_mul_f32 v104, v104, v56
    v_mul_f32 v105, v105, v57
    v_mul_f32 v106, v106, v58
    v_mul_f32 v107, v107, v59
    v_cvt_pk_bf16_f32 v52, v100, v101
    s_waitcnt lgkmcnt(6)
    v_mfma_f32_32x32x16_bf16 v[60:75], v[12:15], a[48:51], v[60:75]
    ds_read_b64_tr_b16 a[128:129], v6 offset:12288
    ds_read_b64_tr_b16 a[130:131], v6 offset:14336
    v_cvt_pk_bf16_f32 v53, v102, v103
    v_cvt_pk_bf16_f32 v54, v104, v105
    v_cvt_pk_bf16_f32 v55, v106, v107
    buffer_store_dwordx4 v[52:55], v1, s[8:11], s19 offen offset:3072 sc1
    s_waitcnt lgkmcnt(6)
    v_mfma_f32_32x32x16_bf16 v[76:91], v[16:19], a[48:51], v[76:91]
    ds_read_b64_tr_b16 a[132:133], v7 offset:12288
    ds_read_b64_tr_b16 a[134:135], v7 offset:14336
    s_waitcnt lgkmcnt(6)
    v_mfma_f32_32x32x16_bf16 v[60:75], v[20:23], a[52:55], v[60:75]
    ds_read_b64_tr_b16 a[136:137], v6 offset:13312
    ds_read_b64_tr_b16 a[138:139], v6 offset:15360
    s_waitcnt lgkmcnt(6)
    v_mfma_f32_32x32x16_bf16 v[76:91], v[24:27], a[52:55], v[76:91]
    ds_read_b64_tr_b16 a[140:141], v7 offset:13312
    ds_read_b64_tr_b16 a[142:143], v7 offset:15360
    s_waitcnt vmcnt(2)
    s_cmp_eq_u32 s47, 0
    s_cbranch_scc1 .pslow_fused_kernel_77
    buffer_store_dword v9, off, s[8:11], s21 offset:0
.pback_fused_kernel_78:
    s_waitcnt lgkmcnt(6)
    v_mfma_f32_32x32x16_bf16 v[60:75], a[128:131], a[56:59], v[60:75]
    ds_read_b64_tr_b16 v[12:13], v6 offset:16384
    ds_read_b64_tr_b16 v[14:15], v6 offset:18432
    s_waitcnt lgkmcnt(6)
    v_mfma_f32_32x32x16_bf16 v[76:91], a[132:135], a[56:59], v[76:91]
    ds_read_b64_tr_b16 v[16:17], v6 offset:17408
    ds_read_b64_tr_b16 v[18:19], v6 offset:19456
    s_waitcnt lgkmcnt(6)
    v_mfma_f32_32x32x16_bf16 v[60:75], a[136:139], a[60:63], v[60:75]
    ds_read_b64_tr_b16 v[20:21], v6 offset:20480
    ds_read_b64_tr_b16 v[22:23], v6 offset:22528
    s_waitcnt lgkmcnt(6)
    s_barrier
    v_mfma_f32_32x32x16_bf16 v[76:91], a[140:143], a[60:63], v[76:91]
    ds_read_b64_tr_b16 v[24:25], v6 offset:21504
    ds_read_b64_tr_b16 v[26:27], v6 offset:23552
    s_waitcnt lgkmcnt(6)
    v_mfma_f32_32x32x16_bf16 v[60:75], v[12:15], a[64:67], v[60:75]
    ds_read_b64_tr_b16 a[128:129], v6 offset:24576
    ds_read_b64_tr_b16 a[130:131], v6 offset:26624
    s_waitcnt lgkmcnt(6)
    v_mfma_f32_32x32x16_bf16 v[60:75], v[16:19], a[68:71], v[60:75]
    ds_read_b64_tr_b16 a[132:133], v6 offset:25600
    ds_read_b64_tr_b16 a[134:135], v6 offset:27648
    s_waitcnt lgkmcnt(6)
    v_mfma_f32_32x32x16_bf16 v[60:75], v[20:23], a[72:75], v[60:75]
    ds_read_b64_tr_b16 a[136:137], v6 offset:28672
    ds_read_b64_tr_b16 a[138:139], v6 offset:30720
    s_waitcnt lgkmcnt(6)
    v_mfma_f32_32x32x16_bf16 v[60:75], v[24:27], a[76:79], v[60:75]
    ds_read_b64_tr_b16 a[140:141], v6 offset:29696
    ds_read_b64_tr_b16 a[142:143], v6 offset:31744
    s_waitcnt lgkmcnt(6)
    v_mfma_f32_32x32x16_bf16 v[60:75], a[128:131], a[80:83], v[60:75]
    ds_read_b64_tr_b16 v[12:13], v6 offset:32768
    ds_read_b64_tr_b16 v[14:15], v6 offset:34816
    s_waitcnt lgkmcnt(6)
    v_mfma_f32_32x32x16_bf16 v[60:75], a[132:135], a[84:87], v[60:75]
    ds_read_b64_tr_b16 v[16:17], v6 offset:33792
    ds_read_b64_tr_b16 v[18:19], v6 offset:35840
    s_waitcnt lgkmcnt(6)
    v_mfma_f32_32x32x16_bf16 v[60:75], a[136:139], a[88:91], v[60:75]
    ds_read_b64_tr_b16 v[20:21], v6 offset:36864
    ds_read_b64_tr_b16 v[22:23], v6 offset:38912
    s_waitcnt lgkmcnt(6)
    v_mfma_f32_32x32x16_bf16 v[60:75], a[140:143], a[92:95], v[60:75]
    ds_read_b64_tr_b16 v[24:25], v6 offset:37888
    ds_read_b64_tr_b16 v[26:27], v6 offset:39936
    s_waitcnt lgkmcnt(6)
    v_mfma_f32_32x32x16_bf16 v[60:75], v[12:15], a[96:99], v[60:75]
    ds_read_b64_tr_b16 a[128:129], v6 offset:40960
    ds_read_b64_tr_b16 a[130:131], v6 offset:43008
    s_waitcnt lgkmcnt(6)
    v_mfma_f32_32x32x16_bf16 v[60:75], v[16:19], a[100:103], v[60:75]
    ds_read_b64_tr_b16 a[132:133], v6 offset:41984
    ds_read_b64_tr_b16 a[134:135], v6 offset:44032
    s_waitcnt lgkmcnt(6)
    v_mfma_f32_32x32x16_bf16 v[60:75], v[20:23], a[104:107], v[60:75]
    ds_read_b64_tr_b16 a[136:137], v6 offset:45056
    ds_read_b64_tr_b16 a[138:139], v6 offset:47104
    s_waitcnt lgkmcnt(6)
    v_mfma_f32_32x32x16_bf16 v[60:75], v[24:27], a[108:111], v[60:75]
    ds_read_b64_tr_b16 a[140:141], v6 offset:46080
    ds_read_b64_tr_b16 a[142:143], v6 offset:48128
    s_waitcnt lgkmcnt(6)
    v_mfma_f32_32x32x16_bf16 v[60:75], a[128:131], a[112:115], v[60:75]
    ds_read_b64_tr_b16 v[12:13], v7 offset:16384
    ds_read_b64_tr_b16 v[14:15], v7 offset:18432
    s_waitcnt lgkmcnt(6)
    v_mfma_f32_32x32x16_bf16 v[60:75], a[132:135], a[116:119], v[60:75]
    ds_read_b64_tr_b16 v[16:17], v7 offset:17408
    ds_read_b64_tr_b16 v[18:19], v7 offset:19456
    s_waitcnt lgkmcnt(6)
    v_mfma_f32_32x32x16_bf16 v[60:75], a[136:139], a[120:123], v[60:75]
    ds_read_b64_tr_b16 v[20:21], v7 offset:20480
    ds_read_b64_tr_b16 v[22:23], v7 offset:22528
    s_waitcnt lgkmcnt(6)
    v_mfma_f32_32x32x16_bf16 v[60:75], a[140:143], a[124:127], v[60:75]
    ds_read_b64_tr_b16 v[24:25], v7 offset:21504
    ds_read_b64_tr_b16 v[26:27], v7 offset:23552
    s_waitcnt vmcnt(1)
    s_cmp_eq_u32 s47, 0
    s_cbranch_scc1 .pslow_fused_kernel_79
    buffer_store_dword v9, off, s[8:11], s21 offset:512
.pback_fused_kernel_80:
    s_waitcnt lgkmcnt(6)
    v_mfma_f32_32x32x16_bf16 v[76:91], v[12:15], a[64:67], v[76:91]
    ds_read_b64_tr_b16 a[128:129], v7 offset:24576
    ds_read_b64_tr_b16 a[130:131], v7 offset:26624
    s_waitcnt lgkmcnt(6)
    v_mfma_f32_32x32x16_bf16 v[76:91], v[16:19], a[68:71], v[76:91]
    ds_read_b64_tr_b16 a[132:133], v7 offset:25600
    ds_read_b64_tr_b16 a[134:135], v7 offset:27648
    v_exp_f32 v92, -v60
    v_exp_f32 v93, -v61
    v_exp_f32 v94, -v62
    s_waitcnt lgkmcnt(6)
    v_mfma_f32_32x32x16_bf16 v[76:91], v[20:23], a[72:75], v[76:91]
    ds_read_b64_tr_b16 a[136:137], v7 offset:28672
    ds_read_b64_tr_b16 a[138:139], v7 offset:30720
    v_exp_f32 v95, -v63
    v_exp_f32 v96, -v64
    v_exp_f32 v97, -v65
    s_waitcnt lgkmcnt(6)
    v_mfma_f32_32x32x16_bf16 v[76:91], v[24:27], a[76:79], v[76:91]
    ds_read_b64_tr_b16 a[140:141], v7 offset:29696
    ds_read_b64_tr_b16 a[142:143], v7 offset:31744
    v_exp_f32 v98, -v66
    v_exp_f32 v99, -v67
    v_add_f32 v92, 1.0, v92
    s_waitcnt lgkmcnt(6)
    v_mfma_f32_32x32x16_bf16 v[76:91], a[128:131], a[80:83], v[76:91]
    ds_read_b64_tr_b16 v[12:13], v7 offset:32768
    ds_read_b64_tr_b16 v[14:15], v7 offset:34816
    v_add_f32 v93, 1.0, v93
    v_add_f32 v94, 1.0, v94
    v_add_f32 v95, 1.0, v95
    buffer_load_dword v10, v8, s[8:11], s25 offen offset:0 sc1
    s_waitcnt lgkmcnt(6)
    v_mfma_f32_32x32x16_bf16 v[76:91], a[132:135], a[84:87], v[76:91]
    ds_read_b64_tr_b16 v[16:17], v7 offset:33792
    ds_read_b64_tr_b16 v[18:19], v7 offset:35840
    v_add_f32 v96, 1.0, v96
    v_add_f32 v97, 1.0, v97
    v_add_f32 v98, 1.0, v98
    s_waitcnt lgkmcnt(6)
    v_mfma_f32_32x32x16_bf16 v[76:91], a[136:139], a[88:91], v[76:91]
    ds_read_b64_tr_b16 v[20:21], v7 offset:36864
    ds_read_b64_tr_b16 v[22:23], v7 offset:38912
    v_add_f32 v99, 1.0, v99
    v_rcp_f32 v92, v92
    v_rcp_f32 v93, v93
    s_waitcnt lgkmcnt(6)
    v_mfma_f32_32x32x16_bf16 v[76:91], a[140:143], a[92:95], v[76:91]
    ds_read_b64_tr_b16 v[24:25], v7 offset:37888
    ds_read_b64_tr_b16 v[26:27], v7 offset:39936
    v_rcp_f32 v94, v94
    v_rcp_f32 v95, v95
    v_rcp_f32 v96, v96
    s_waitcnt lgkmcnt(6)
    v_mfma_f32_32x32x16_bf16 v[76:91], v[12:15], a[96:99], v[76:91]
    ds_read_b64_tr_b16 a[128:129], v7 offset:40960
    ds_read_b64_tr_b16 a[130:131], v7 offset:43008
    v_rcp_f32 v97, v97
    v_rcp_f32 v98, v98
    v_rcp_f32 v99, v99
    s_waitcnt lgkmcnt(6)
    v_mfma_f32_32x32x16_bf16 v[76:91], v[16:19], a[100:103], v[76:91]
    ds_read_b64_tr_b16 a[132:133], v7 offset:41984
    ds_read_b64_tr_b16 a[134:135], v7 offset:44032
    v_mul_f32 v92, v92, v60
    v_mul_f32 v93, v93, v61
    v_mul_f32 v94, v94, v62
    s_waitcnt lgkmcnt(6)
    v_mfma_f32_32x32x16_bf16 v[76:91], v[20:23], a[104:107], v[76:91]
    ds_read_b64_tr_b16 a[136:137], v7 offset:45056
    ds_read_b64_tr_b16 a[138:139], v7 offset:47104
    v_mul_f32 v95, v95, v63
    v_mul_f32 v96, v96, v64
    v_mul_f32 v97, v97, v65
    s_waitcnt lgkmcnt(6)
    v_mfma_f32_32x32x16_bf16 v[76:91], v[24:27], a[108:111], v[76:91]
    ds_read_b64_tr_b16 a[140:141], v7 offset:46080
    ds_read_b64_tr_b16 a[142:143], v7 offset:48128
    v_mul_f32 v98, v98, v66
    v_mul_f32 v99, v99, v67
    v_cvt_pk_bf16_f32 v60, v92, v93
    s_waitcnt lgkmcnt(6)
    v_mfma_f32_32x32x16_bf16 v[76:91], a[128:131], a[112:115], v[76:91]
    v_cvt_pk_bf16_f32 v61, v94, v95
    v_cvt_pk_bf16_f32 v62, v96, v97
    v_cvt_pk_bf16_f32 v63, v98, v99
    s_waitcnt lgkmcnt(4)
    v_mfma_f32_32x32x16_bf16 v[76:91], a[132:135], a[116:119], v[76:91]
    buffer_store_dwordx4 v[60:63], v1, s[8:11], s20 offen offset:0 sc1
    v_exp_f32 v100, -v68
    v_exp_f32 v101, -v69
    s_waitcnt lgkmcnt(2)
    v_mfma_f32_32x32x16_bf16 v[76:91], a[136:139], a[120:123], v[76:91]
    v_exp_f32 v102, -v70
    v_exp_f32 v103, -v71
    v_exp_f32 v104, -v72
    s_waitcnt lgkmcnt(0)
    s_barrier
    v_mfma_f32_32x32x16_bf16 v[76:91], a[140:143], a[124:127], v[76:91]
    v_exp_f32 v105, -v73
    v_exp_f32 v106, -v74
    v_exp_f32 v107, -v75
    v_xor_b32 v110, s39, v110
    v_xor_b32 v111, 64, v110
    v_add_u32 v4, 98304, v110
    v_add_u32 v5, 98304, v111
    v_add_u32 v6, 32768, v110
    v_add_u32 v7, 32768, v111
    s_waitcnt vmcnt(1)
    v_cmp_ne_u32 s[32:33], 0, v10
    s_nop 1
    s_cmp_lg_u32 s32, -1
    s_cbranch_scc1 .test_fused_kernel_82
.ready_fused_kernel_83:
    buffer_load_dword v10, v8, s[8:11], s25 offen offset:512 sc1
    buffer_load_dwordx4 a[0:3], v1, s[8:11], s22 offen sc1
    buffer_load_dwordx4 a[4:7], v1, s[8:11], s23 offen sc1
    v_add_f32 v100, 1.0, v100
    v_add_f32 v101, 1.0, v101
    v_add_f32 v102, 1.0, v102
    v_add_f32 v103, 1.0, v103
    v_add_f32 v104, 1.0, v104
    v_add_f32 v105, 1.0, v105
    v_add_f32 v106, 1.0, v106
    v_add_f32 v107, 1.0, v107
    v_rcp_f32 v100, v100
    v_rcp_f32 v101, v101
    v_rcp_f32 v102, v102
    s_add_u32 s22, s22, 0x4000
    s_add_u32 s23, s23, 0x4000
    buffer_load_dwordx4 a[8:11], v1, s[8:11], s22 offen sc1
    v_rcp_f32 v103, v103
    v_rcp_f32 v104, v104
    v_rcp_f32 v105, v105
    v_rcp_f32 v106, v106
    v_rcp_f32 v107, v107
    v_mul_f32 v100, v100, v68
    v_mul_f32 v101, v101, v69
    v_mul_f32 v102, v102, v70
    v_mul_f32 v103, v103, v71
    v_mul_f32 v104, v104, v72
    v_mul_f32 v105, v105, v73
    buffer_load_dwordx4 a[12:15], v1, s[8:11], s23 offen sc1
    v_mul_f32 v106, v106, v74
    v_mul_f32 v107, v107, v75
    v_cvt_pk_bf16_f32 v68, v100, v101
    v_cvt_pk_bf16_f32 v69, v102, v103
    v_cvt_pk_bf16_f32 v70, v104, v105
    v_cvt_pk_bf16_f32 v71, v106, v107
    buffer_store_dwordx4 v[68:71], v1, s[8:11], s20 offen offset:1024 sc1
    v_exp_f32 v92, -v76
    v_exp_f32 v93, -v77
    v_exp_f32 v94, -v78
    v_exp_f32 v95, -v79
    s_add_u32 s22, s22, 0x4000
    s_add_u32 s23, s23, 0x4000
    buffer_load_dwordx4 a[16:19], v1, s[8:11], s22 offen sc1
    v_exp_f32 v96, -v80
    v_exp_f32 v97, -v81
    v_exp_f32 v98, -v82
    v_exp_f32 v99, -v83
    v_add_f32 v92, 1.0, v92
    v_add_f32 v93, 1.0, v93
    v_add_f32 v94, 1.0, v94
    v_add_f32 v95, 1.0, v95
    v_add_f32 v96, 1.0, v96
    v_add_f32 v97, 1.0, v97
    v_add_f32 v98, 1.0, v98
    buffer_load_dwordx4 a[20:23], v1, s[8:11], s23 offen sc1
    v_add_f32 v99, 1.0, v99
    v_rcp_f32 v92, v92
    v_rcp_f32 v93, v93
    v_rcp_f32 v94, v94
    v_rcp_f32 v95, v95
    v_rcp_f32 v96, v96
    v_rcp_f32 v97, v97
    v_rcp_f32 v98, v98
    v_rcp_f32 v99, v99
    v_mul_f32 v92, v92, v76
    v_mul_f32 v93, v93, v77
    s_add_u32 s22, s22, 0x4000
    s_add_u32 s23, s23, 0x4000
    buffer_load_dwordx4 a[24:27], v1, s[8:11], s22 offen sc1
    v_mul_f32 v94, v94, v78
    v_mul_f32 v95, v95, v79
    v_mul_f32 v96, v96, v80
    v_mul_f32 v97, v97, v81
    v_mul_f32 v98, v98, v82
    v_mul_f32 v99, v99, v83
    v_cvt_pk_bf16_f32 v76, v92, v93
    v_cvt_pk_bf16_f32 v77, v94, v95
    v_cvt_pk_bf16_f32 v78, v96, v97
    v_cvt_pk_bf16_f32 v79, v98, v99
    buffer_store_dwordx4 v[76:79], v1, s[8:11], s20 offen offset:2048 sc1
    buffer_load_dwordx4 a[28:31], v1, s[8:11], s23 offen sc1
    v_exp_f32 v100, -v84
    v_exp_f32 v101, -v85
    v_exp_f32 v102, -v86
    v_exp_f32 v103, -v87
    v_exp_f32 v104, -v88
    v_exp_f32 v105, -v89
    v_exp_f32 v106, -v90
    v_exp_f32 v107, -v91
    v_add_f32 v100, 1.0, v100
    v_add_f32 v101, 1.0, v101
    v_add_f32 v102, 1.0, v102
    s_add_u32 s22, s22, 0x4000
    s_add_u32 s23, s23, 0x4000
    buffer_load_dwordx4 a[32:35], v1, s[8:11], s22 offen sc1
    v_add_f32 v103, 1.0, v103
    v_add_f32 v104, 1.0, v104
    v_add_f32 v105, 1.0, v105
    v_add_f32 v106, 1.0, v106
    v_add_f32 v107, 1.0, v107
    v_rcp_f32 v100, v100
    v_rcp_f32 v101, v101
    v_rcp_f32 v102, v102
    v_rcp_f32 v103, v103
    v_rcp_f32 v104, v104
    v_rcp_f32 v105, v105
    buffer_load_dwordx4 a[36:39], v1, s[8:11], s23 offen sc1
    v_rcp_f32 v106, v106
    v_rcp_f32 v107, v107
    v_mul_f32 v100, v100, v84
    v_mul_f32 v101, v101, v85
    v_mul_f32 v102, v102, v86
    v_mul_f32 v103, v103, v87
    v_mul_f32 v104, v104, v88
    v_mul_f32 v105, v105, v89
    v_mul_f32 v106, v106, v90
    v_mul_f32 v107, v107, v91
    v_cvt_pk_bf16_f32 v84, v100, v101
    v_cvt_pk_bf16_f32 v85, v102, v103
    v_cvt_pk_bf16_f32 v86, v104, v105
    v_cvt_pk_bf16_f32 v87, v106, v107
    buffer_store_dwordx4 v[84:87], v1, s[8:11], s20 offen offset:3072 sc1
    ds_read_b64_tr_b16 v[12:13], v110 offset:0
    ds_read_b64_tr_b16 v[14:15], v110 offset:1024
    ds_read_b64_tr_b16 v[16:17], v111 offset:0
    ds_read_b64_tr_b16 v[18:19], v111 offset:1024
    s_waitcnt lgkmcnt(0)
    ds_read_b64_tr_b16 v[20:21], v110 offset:8192
    ds_read_b64_tr_b16 v[22:23], v110 offset:9216
    ds_read_b64_tr_b16 v[24:25], v111 offset:8192
    ds_read_b64_tr_b16 v[26:27], v111 offset:9216
    s_waitcnt vmcnt(11)
    v_mfma_f32_32x32x16_bf16 v[76:91], v[16:19], a[4:7], 0
    v_mfma_f32_32x32x16_bf16 v[60:75], v[12:15], a[4:7], 0
    v_mfma_f32_32x32x16_bf16 v[44:59], v[16:19], a[0:3], 0
    v_mfma_f32_32x32x16_bf16 v[28:43], v[12:15], a[0:3], 0
    s_add_u32 s22, s22, 0x4000
    s_add_u32 s23, s23, 0x4000
    buffer_load_dwordx4 a[40:43], v1, s[8:11], s22 offen sc1
    buffer_load_dwordx4 a[44:47], v1, s[8:11], s23 offen sc1
    s_waitcnt lgkmcnt(0)
    ds_read_b64_tr_b16 v[12:13], v110 offset:16384
    ds_read_b64_tr_b16 v[14:15], v110 offset:17408
    ds_read_b64_tr_b16 v[16:17], v111 offset:16384
    ds_read_b64_tr_b16 v[18:19], v111 offset:17408
    s_waitcnt vmcnt(11)
    v_mfma_f32_32x32x16_bf16 v[76:91], v[24:27], a[12:15], v[76:91]
    v_mfma_f32_32x32x16_bf16 v[60:75], v[20:23], a[12:15], v[60:75]
    v_mfma_f32_32x32x16_bf16 v[44:59], v[24:27], a[8:11], v[44:59]
    v_mfma_f32_32x32x16_bf16 v[28:43], v[20:23], a[8:11], v[28:43]
    s_waitcnt vmcnt(10)
    s_cmp_eq_u32 s47, 0
    s_cbranch_scc1 .pslow_fused_kernel_84
    buffer_store_dword v9, off, s[8:11], s21 offset:1024
.pback_fused_kernel_85:
    s_add_u32 s22, s22, 0x4000
    s_add_u32 s23, s23, 0x4000
    buffer_load_dwordx4 a[48:51], v1, s[8:11], s22 offen sc1
    buffer_load_dwordx4 a[52:55], v1, s[8:11], s23 offen sc1
    s_waitcnt lgkmcnt(0)
    ds_read_b64_tr_b16 v[20:21], v110 offset:24576
    ds_read_b64_tr_b16 v[22:23], v110 offset:25600
    ds_read_b64_tr_b16 v[24:25], v111 offset:24576
    ds_read_b64_tr_b16 v[26:27], v111 offset:25600
    s_waitcnt vmcnt(11)
    v_mfma_f32_32x32x16_bf16 v[76:91], v[16:19], a[20:23], v[76:91]
    v_mfma_f32_32x32x16_bf16 v[60:75], v[12:15], a[20:23], v[60:75]
    v_mfma_f32_32x32x16_bf16 v[44:59], v[16:19], a[16:19], v[44:59]
    v_mfma_f32_32x32x16_bf16 v[28:43], v[12:15], a[16:19], v[28:43]
    v_cmp_ne_u32 s[32:33], 0, v10
    s_nop 1
    s_cmp_lg_u32 s32, -1
    s_cbranch_scc1 .test_fused_kernel_87
.ready_fused_kernel_88:
    s_add_u32 s22, s22, 0xfffe8800
    s_add_u32 s23, s23, 0xfffe8800
    buffer_load_dwordx4 a[56:59], v1, s[8:11], s22 offen sc1
    buffer_load_dwordx4 a[60:63], v1, s[8:11], s23 offen sc1
    s_waitcnt lgkmcnt(0)
    s_barrier
    ds_read_b64_tr_b16 v[12:13], v4 offset:0
    ds_read_b64_tr_b16 v[14:15], v4 offset:1024
    ds_read_b64_tr_b16 v[16:17], v5 offset:0
    ds_read_b64_tr_b16 v[18:19], v5 offset:1024
    s_waitcnt vmcnt(10)
    v_mfma_f32_32x32x16_bf16 v[76:91], v[24:27], a[28:31], v[76:91]
    v_mfma_f32_32x32x16_bf16 v[60:75], v[20:23], a[28:31], v[60:75]
    v_mfma_f32_32x32x16_bf16 v[44:59], v[24:27], a[24:27], v[44:59]
    v_mfma_f32_32x32x16_bf16 v[28:43], v[20:23], a[24:27], v[28:43]
    s_add_u32 s22, s22, 0x4000
    s_add_u32 s23, s23, 0x4000
    buffer_load_dwordx4 a[64:67], v1, s[8:11], s22 offen sc1
    buffer_load_dwordx4 a[68:71], v1, s[8:11], s23 offen sc1
    s_waitcnt lgkmcnt(0)
    ds_read_b64_tr_b16 v[20:21], v4 offset:8192
    ds_read_b64_tr_b16 v[22:23], v4 offset:9216
    ds_read_b64_tr_b16 v[24:25], v5 offset:8192
    ds_read_b64_tr_b16 v[26:27], v5 offset:9216
    s_waitcnt vmcnt(10)
    v_mfma_f32_32x32x16_bf16 v[76:91], v[16:19], a[36:39], v[76:91]
    v_mfma_f32_32x32x16_bf16 v[60:75], v[12:15], a[36:39], v[60:75]
    v_mfma_f32_32x32x16_bf16 v[44:59], v[16:19], a[32:35], v[44:59]
    v_mfma_f32_32x32x16_bf16 v[28:43], v[12:15], a[32:35], v[28:43]
    s_waitcnt vmcnt(9)
    s_cmp_eq_u32 s47, 0
    s_cbranch_scc1 .pslow_fused_kernel_89
    buffer_store_dword v9, off, s[8:11], s21 offset:1536
.pback_fused_kernel_90:
    s_add_u32 s22, s22, 0x4000
    s_add_u32 s23, s23, 0x4000
    buffer_load_dwordx4 a[72:75], v1, s[8:11], s22 offen sc1
    buffer_load_dwordx4 a[76:79], v1, s[8:11], s23 offen sc1
    s_waitcnt lgkmcnt(0)
    ds_read_b64_tr_b16 v[12:13], v4 offset:16384
    ds_read_b64_tr_b16 v[14:15], v4 offset:17408
    ds_read_b64_tr_b16 v[16:17], v5 offset:16384
    ds_read_b64_tr_b16 v[18:19], v5 offset:17408
    s_waitcnt vmcnt(10)
    v_mfma_f32_32x32x16_bf16 v[76:91], v[24:27], a[44:47], v[76:91]
    v_mfma_f32_32x32x16_bf16 v[60:75], v[20:23], a[44:47], v[60:75]
    v_mfma_f32_32x32x16_bf16 v[44:59], v[24:27], a[40:43], v[44:59]
    v_mfma_f32_32x32x16_bf16 v[28:43], v[20:23], a[40:43], v[28:43]
    buffer_load_dword v10, v8, s[8:11], s25 offen offset:1024 sc1
    s_add_u32 s22, s22, 0x4000
    s_add_u32 s23, s23, 0x4000
    buffer_load_dwordx4 a[80:83], v1, s[8:11], s22 offen sc1
    buffer_load_dwordx4 a[84:87], v1, s[8:11], s23 offen sc1
    s_waitcnt lgkmcnt(0)
    ds_read_b64_tr_b16 v[20:21], v4 offset:24576
    ds_read_b64_tr_b16 v[22:23], v4 offset:25600
    ds_read_b64_tr_b16 v[24:25], v5 offset:24576
    ds_read_b64_tr_b16 v[26:27], v5 offset:25600
    s_waitcnt vmcnt(10)
    v_mfma_f32_32x32x16_bf16 v[76:91], v[16:19], a[52:55], v[76:91]
    v_mfma_f32_32x32x16_bf16 v[60:75], v[12:15], a[52:55], v[60:75]
    v_mfma_f32_32x32x16_bf16 v[44:59], v[16:19], a[48:51], v[44:59]
    v_mfma_f32_32x32x16_bf16 v[28:43], v[12:15], a[48:51], v[28:43]
    s_add_u32 s22, s22, 0x4000
    s_add_u32 s23, s23, 0x4000
    buffer_load_dwordx4 a[88:91], v1, s[8:11], s22 offen sc1
    buffer_load_dwordx4 a[92:95], v1, s[8:11], s23 offen sc1
    s_waitcnt lgkmcnt(0)
    s_barrier
    ds_read_b64_tr_b16 v[12:13], v4 offset:32768
    ds_read_b64_tr_b16 v[14:15], v4 offset:33792
    ds_read_b64_tr_b16 v[16:17], v5 offset:32768
    ds_read_b64_tr_b16 v[18:19], v5 offset:33792
    s_waitcnt vmcnt(10)
    v_mfma_f32_32x32x16_bf16 v[76:91], v[24:27], a[60:63], v[76:91]
    v_mfma_f32_32x32x16_bf16 v[60:75], v[20:23], a[60:63], v[60:75]
    v_mfma_f32_32x32x16_bf16 v[44:59], v[24:27], a[56:59], v[44:59]
    v_mfma_f32_32x32x16_bf16 v[28:43], v[20:23], a[56:59], v[28:43]
    s_add_u32 s22, s22, 0x4000
    s_add_u32 s23, s23, 0x4000
    buffer_load_dwordx4 a[96:99], v1, s[8:11], s22 offen sc1
    buffer_load_dwordx4 a[100:103], v1, s[8:11], s23 offen sc1
    s_waitcnt lgkmcnt(0)
    ds_read_b64_tr_b16 v[20:21], v4 offset:40960
    ds_read_b64_tr_b16 v[22:23], v4 offset:41984
    ds_read_b64_tr_b16 v[24:25], v5 offset:40960
    ds_read_b64_tr_b16 v[26:27], v5 offset:41984
    s_waitcnt vmcnt(10)
    v_mfma_f32_32x32x16_bf16 v[76:91], v[16:19], a[68:71], v[76:91]
    v_mfma_f32_32x32x16_bf16 v[60:75], v[12:15], a[68:71], v[60:75]
    v_mfma_f32_32x32x16_bf16 v[44:59], v[16:19], a[64:67], v[44:59]
    v_mfma_f32_32x32x16_bf16 v[28:43], v[12:15], a[64:67], v[28:43]
    s_add_u32 s22, s22, 0x4000
    s_add_u32 s23, s23, 0x4000
    buffer_load_dwordx4 a[104:107], v1, s[8:11], s22 offen sc1
    buffer_load_dwordx4 a[108:111], v1, s[8:11], s23 offen sc1
    s_waitcnt lgkmcnt(0)
    ds_read_b64_tr_b16 v[12:13], v4 offset:49152
    ds_read_b64_tr_b16 v[14:15], v4 offset:50176
    ds_read_b64_tr_b16 v[16:17], v5 offset:49152
    ds_read_b64_tr_b16 v[18:19], v5 offset:50176
    s_waitcnt vmcnt(9)
    v_mfma_f32_32x32x16_bf16 v[76:91], v[24:27], a[76:79], v[76:91]
    v_mfma_f32_32x32x16_bf16 v[60:75], v[20:23], a[76:79], v[60:75]
    v_mfma_f32_32x32x16_bf16 v[44:59], v[24:27], a[72:75], v[44:59]
    v_mfma_f32_32x32x16_bf16 v[28:43], v[20:23], a[72:75], v[28:43]
    s_waitcnt vmcnt(8)
    v_cmp_ne_u32 s[32:33], 0, v10
    s_nop 1
    s_cmp_lg_u32 s32, -1
    s_cbranch_scc1 .test_fused_kernel_92
.ready_fused_kernel_93:
    s_add_u32 s22, s22, 0xfffe8800
    s_add_u32 s23, s23, 0xfffe8800
    buffer_load_dwordx4 a[112:115], v1, s[8:11], s22 offen sc1
    buffer_load_dwordx4 a[116:119], v1, s[8:11], s23 offen sc1
    s_waitcnt lgkmcnt(0)
    ds_read_b64_tr_b16 v[20:21], v4 offset:57344
    ds_read_b64_tr_b16 v[22:23], v4 offset:58368
    ds_read_b64_tr_b16 v[24:25], v5 offset:57344
    ds_read_b64_tr_b16 v[26:27], v5 offset:58368
    s_waitcnt vmcnt(8)
    v_mfma_f32_32x32x16_bf16 v[76:91], v[16:19], a[84:87], v[76:91]
    v_mfma_f32_32x32x16_bf16 v[60:75], v[12:15], a[84:87], v[60:75]
    v_mfma_f32_32x32x16_bf16 v[44:59], v[16:19], a[80:83], v[44:59]
    v_mfma_f32_32x32x16_bf16 v[28:43], v[12:15], a[80:83], v[28:43]
    s_add_u32 s22, s22, 0x4000
    s_add_u32 s23, s23, 0x4000
    buffer_load_dwordx4 a[120:123], v1, s[8:11], s22 offen sc1
    buffer_load_dwordx4 a[124:127], v1, s[8:11], s23 offen sc1
    s_waitcnt lgkmcnt(0)
    ds_read_b64_tr_b16 v[12:13], v6 offset:0
    ds_read_b64_tr_b16 v[14:15], v6 offset:1024
    ds_read_b64_tr_b16 v[16:17], v7 offset:0
    ds_read_b64_tr_b16 v[18:19], v7 offset:1024
    s_waitcnt vmcnt(8)
    v_mfma_f32_32x32x16_bf16 v[76:91], v[24:27], a[92:95], v[76:91]
    v_mfma_f32_32x32x16_bf16 v[60:75], v[20:23], a[92:95], v[60:75]
    v_mfma_f32_32x32x16_bf16 v[44:59], v[24:27], a[88:91], v[44:59]
    v_mfma_f32_32x32x16_bf16 v[28:43], v[20:23], a[88:91], v[28:43]
    s_add_u32 s22, s22, 0x4000
    s_add_u32 s23, s23, 0x4000
    buffer_load_dwordx4 a[0:3], v1, s[8:11], s22 offen sc1
    buffer_load_dwordx4 a[4:7], v1, s[8:11], s23 offen sc1
    s_waitcnt lgkmcnt(0)
    ds_read_b64_tr_b16 v[20:21], v6 offset:8192
    ds_read_b64_tr_b16 v[22:23], v6 offset:9216
    ds_read_b64_tr_b16 v[24:25], v7 offset:8192
    ds_read_b64_tr_b16 v[26:27], v7 offset:9216
    s_waitcnt vmcnt(8)
    v_mfma_f32_32x32x16_bf16 v[76:91], v[16:19], a[100:103], v[76:91]
    v_mfma_f32_32x32x16_bf16 v[60:75], v[12:15], a[100:103], v[60:75]
    v_mfma_f32_32x32x16_bf16 v[44:59], v[16:19], a[96:99], v[44:59]
    v_mfma_f32_32x32x16_bf16 v[28:43], v[12:15], a[96:99], v[28:43]
    buffer_load_dword v10, v8, s[8:11], s25 offen offset:1536 sc1
    s_add_u32 s22, s22, 0x4000
    s_add_u32 s23, s23, 0x4000
    buffer_load_dwordx4 a[8:11], v1, s[8:11], s22 offen sc1
    buffer_load_dwordx4 a[12:15], v1, s[8:11], s23 offen sc1
    s_waitcnt lgkmcnt(0)
    ds_read_b64_tr_b16 v[12:13], v6 offset:49152
    ds_read_b64_tr_b16 v[14:15], v6 offset:50176
    ds_read_b64_tr_b16 v[16:17], v7 offset:49152
    ds_read_b64_tr_b16 v[18:19], v7 offset:50176
    s_waitcnt vmcnt(9)
    v_mfma_f32_32x32x16_bf16 v[76:91], v[24:27], a[108:111], v[76:91]
    v_mfma_f32_32x32x16_bf16 v[60:75], v[20:23], a[108:111], v[60:75]
    v_mfma_f32_32x32x16_bf16 v[44:59], v[24:27], a[104:107], v[44:59]
    v_mfma_f32_32x32x16_bf16 v[28:43], v[20:23], a[104:107], v[28:43]
    s_add_u32 s22, s22, 0x4000
    s_add_u32 s23, s23, 0x4000
    buffer_load_dwordx4 a[16:19], v1, s[8:11], s22 offen sc1
    buffer_load_dwordx4 a[20:23], v1, s[8:11], s23 offen sc1
    s_waitcnt lgkmcnt(0)
    ds_read_b64_tr_b16 v[20:21], v6 offset:57344
    ds_read_b64_tr_b16 v[22:23], v6 offset:58368
    ds_read_b64_tr_b16 v[24:25], v7 offset:57344
    ds_read_b64_tr_b16 v[26:27], v7 offset:58368
    s_waitcnt vmcnt(9)
    v_mfma_f32_32x32x16_bf16 v[76:91], v[16:19], a[116:119], v[76:91]
    v_mfma_f32_32x32x16_bf16 v[60:75], v[12:15], a[116:119], v[60:75]
    v_mfma_f32_32x32x16_bf16 v[44:59], v[16:19], a[112:115], v[44:59]
    v_mfma_f32_32x32x16_bf16 v[28:43], v[12:15], a[112:115], v[28:43]
    s_add_u32 s22, s22, 0x4000
    s_add_u32 s23, s23, 0x4000
    buffer_load_dwordx4 a[24:27], v1, s[8:11], s22 offen sc1
    buffer_load_dwordx4 a[28:31], v1, s[8:11], s23 offen sc1
    s_waitcnt lgkmcnt(0)
    ds_read_b64_tr_b16 v[12:13], v6 offset:16384
    ds_read_b64_tr_b16 v[14:15], v6 offset:17408
    ds_read_b64_tr_b16 v[16:17], v7 offset:16384
    ds_read_b64_tr_b16 v[18:19], v7 offset:17408
    s_waitcnt vmcnt(9)
    v_mfma_f32_32x32x16_bf16 v[76:91], v[24:27], a[124:127], v[76:91]
    v_mfma_f32_32x32x16_bf16 v[60:75], v[20:23], a[124:127], v[60:75]
    v_mfma_f32_32x32x16_bf16 v[44:59], v[24:27], a[120:123], v[44:59]
    v_mfma_f32_32x32x16_bf16 v[28:43], v[20:23], a[120:123], v[28:43]
    s_add_u32 s22, s22, 0x4000
    s_add_u32 s23, s23, 0x4000
    buffer_load_dwordx4 a[32:35], v1, s[8:11], s22 offen sc1
    buffer_load_dwordx4 a[36:39], v1, s[8:11], s23 offen sc1
    s_waitcnt lgkmcnt(0)
    ds_read_b64_tr_b16 v[20:21], v6 offset:24576
    ds_read_b64_tr_b16 v[22:23], v6 offset:25600
    ds_read_b64_tr_b16 v[24:25], v7 offset:24576
    ds_read_b64_tr_b16 v[26:27], v7 offset:25600
    s_waitcnt vmcnt(9)
    v_mfma_f32_32x32x16_bf16 v[76:91], v[16:19], a[4:7], v[76:91]
    v_mfma_f32_32x32x16_bf16 v[60:75], v[12:15], a[4:7], v[60:75]
    v_mfma_f32_32x32x16_bf16 v[44:59], v[16:19], a[0:3], v[44:59]
    v_mfma_f32_32x32x16_bf16 v[28:43], v[12:15], a[0:3], v[28:43]
    s_waitcnt vmcnt(8)
    v_cmp_ne_u32 s[32:33], 0, v10
    s_nop 1
    s_cmp_lg_u32 s32, -1
    s_cbranch_scc1 .test_fused_kernel_95
.ready_fused_kernel_96:
    s_add_u32 s22, s22, 0xfffe8800
    s_add_u32 s23, s23, 0xfffe8800
    buffer_load_dwordx4 a[40:43], v1, s[8:11], s22 offen sc1
    buffer_load_dwordx4 a[44:47], v1, s[8:11], s23 offen sc1
    s_waitcnt lgkmcnt(0)
    ds_read_b64_tr_b16 v[12:13], v6 offset:32768
    ds_read_b64_tr_b16 v[14:15], v6 offset:33792
    ds_read_b64_tr_b16 v[16:17], v7 offset:32768
    ds_read_b64_tr_b16 v[18:19], v7 offset:33792
    s_waitcnt vmcnt(8)
    v_mfma_f32_32x32x16_bf16 v[76:91], v[24:27], a[12:15], v[76:91]
    v_mfma_f32_32x32x16_bf16 v[60:75], v[20:23], a[12:15], v[60:75]
    v_mfma_f32_32x32x16_bf16 v[44:59], v[24:27], a[8:11], v[44:59]
    v_mfma_f32_32x32x16_bf16 v[28:43], v[20:23], a[8:11], v[28:43]
    s_add_u32 s22, s22, 0x4000
    s_add_u32 s23, s23, 0x4000
    buffer_load_dwordx4 a[48:51], v1, s[8:11], s22 offen sc1
    buffer_load_dwordx4 a[52:55], v1, s[8:11], s23 offen sc1
    s_waitcnt lgkmcnt(0)
    ds_read_b64_tr_b16 v[20:21], v6 offset:40960
    ds_read_b64_tr_b16 v[22:23], v6 offset:41984
    ds_read_b64_tr_b16 v[24:25], v7 offset:40960
    ds_read_b64_tr_b16 v[26:27], v7 offset:41984
    s_waitcnt vmcnt(8)
    v_mfma_f32_32x32x16_bf16 v[76:91], v[16:19], a[20:23], v[76:91]
    v_mfma_f32_32x32x16_bf16 v[60:75], v[12:15], a[20:23], v[60:75]
    v_mfma_f32_32x32x16_bf16 v[44:59], v[16:19], a[16:19], v[44:59]
    v_mfma_f32_32x32x16_bf16 v[28:43], v[12:15], a[16:19], v[28:43]
    s_add_u32 s22, s22, 0x4000
    s_add_u32 s23, s23, 0x4000
    buffer_load_dwordx4 a[56:59], v1, s[8:11], s22 offen sc1
    buffer_load_dwordx4 a[60:63], v1, s[8:11], s23 offen sc1
    s_waitcnt lgkmcnt(0)
    s_barrier
    ds_read_b64_tr_b16 v[12:13], v110 offset:0
    ds_read_b64_tr_b16 v[14:15], v110 offset:1024
    ds_read_b64_tr_b16 v[16:17], v111 offset:0
    ds_read_b64_tr_b16 v[18:19], v111 offset:1024
    s_waitcnt vmcnt(8)
    v_mfma_f32_32x32x16_bf16 v[76:91], v[24:27], a[28:31], v[76:91]
    v_mfma_f32_32x32x16_bf16 v[60:75], v[20:23], a[28:31], v[60:75]
    v_mfma_f32_32x32x16_bf16 v[44:59], v[24:27], a[24:27], v[44:59]
    v_mfma_f32_32x32x16_bf16 v[28:43], v[20:23], a[24:27], v[28:43]
    s_add_u32 s22, s22, 0x4000
    s_add_u32 s23, s23, 0x4000
    buffer_load_dwordx4 a[64:67], v1, s[8:11], s22 offen sc1
    buffer_load_dwordx4 a[68:71], v1, s[8:11], s23 offen sc1
    s_waitcnt lgkmcnt(0)
    ds_read_b64_tr_b16 v[20:21], v110 offset:8192
    ds_read_b64_tr_b16 v[22:23], v110 offset:9216
    ds_read_b64_tr_b16 v[24:25], v111 offset:8192
    ds_read_b64_tr_b16 v[26:27], v111 offset:9216
    s_waitcnt vmcnt(8)
    v_mfma_f32_32x32x16_bf16 v[76:91], v[16:19], a[36:39], v[76:91]
    v_mfma_f32_32x32x16_bf16 v[60:75], v[12:15], a[36:39], v[60:75]
    v_mfma_f32_32x32x16_bf16 v[44:59], v[16:19], a[32:35], v[44:59]
    v_mfma_f32_32x32x16_bf16 v[28:43], v[12:15], a[32:35], v[28:43]
    s_add_u32 s22, s22, 0x4000
    s_add_u32 s23, s23, 0x4000
    buffer_load_dwordx4 a[72:75], v1, s[8:11], s22 offen sc1
    buffer_load_dwordx4 a[76:79], v1, s[8:11], s23 offen sc1
    s_waitcnt lgkmcnt(0)
    ds_read_b64_tr_b16 v[12:13], v110 offset:16384
    ds_read_b64_tr_b16 v[14:15], v110 offset:17408
    ds_read_b64_tr_b16 v[16:17], v111 offset:16384
    ds_read_b64_tr_b16 v[18:19], v111 offset:17408
    s_waitcnt vmcnt(8)
    v_mfma_f32_32x32x16_bf16 v[76:91], v[24:27], a[44:47], v[76:91]
    v_mfma_f32_32x32x16_bf16 v[60:75], v[20:23], a[44:47], v[60:75]
    v_mfma_f32_32x32x16_bf16 v[44:59], v[24:27], a[40:43], v[44:59]
    v_mfma_f32_32x32x16_bf16 v[28:43], v[20:23], a[40:43], v[28:43]
    s_add_u32 s22, s22, 0x4000
    s_add_u32 s23, s23, 0x4000
    buffer_load_dwordx4 a[80:83], v1, s[8:11], s22 offen sc1
    buffer_load_dwordx4 a[84:87], v1, s[8:11], s23 offen sc1
    s_waitcnt lgkmcnt(0)
    ds_read_b64_tr_b16 v[20:21], v110 offset:24576
    ds_read_b64_tr_b16 v[22:23], v110 offset:25600
    ds_read_b64_tr_b16 v[24:25], v111 offset:24576
    ds_read_b64_tr_b16 v[26:27], v111 offset:25600
    s_waitcnt vmcnt(8)
    v_mfma_f32_32x32x16_bf16 v[76:91], v[16:19], a[52:55], v[76:91]
    v_mfma_f32_32x32x16_bf16 v[60:75], v[12:15], a[52:55], v[60:75]
    v_mfma_f32_32x32x16_bf16 v[44:59], v[16:19], a[48:51], v[44:59]
    v_mfma_f32_32x32x16_bf16 v[28:43], v[12:15], a[48:51], v[28:43]
    s_add_u32 s22, s22, 0x4000
    s_add_u32 s23, s23, 0x4000
    buffer_load_dwordx4 a[88:91], v1, s[8:11], s22 offen sc1
    buffer_load_dwordx4 a[92:95], v1, s[8:11], s23 offen sc1
    s_waitcnt lgkmcnt(0)
    ds_read_b64_tr_b16 v[12:13], v4 offset:0
    ds_read_b64_tr_b16 v[14:15], v4 offset:1024
    ds_read_b64_tr_b16 v[16:17], v5 offset:0
    ds_read_b64_tr_b16 v[18:19], v5 offset:1024
    s_waitcnt vmcnt(8)
    v_mfma_f32_32x32x16_bf16 v[76:91], v[24:27], a[60:63], v[76:91]
    v_mfma_f32_32x32x16_bf16 v[60:75], v[20:23], a[60:63], v[60:75]
    v_mfma_f32_32x32x16_bf16 v[44:59], v[24:27], a[56:59], v[44:59]
    v_mfma_f32_32x32x16_bf16 v[28:43], v[20:23], a[56:59], v[28:43]
    buffer_load_dwordx4 a[128:131], v1, s[8:11], s26 offen sc1
    buffer_load_dwordx4 a[132:135], v1, s[8:11], s26 offen offset:1024 sc1
    v_lshrrev_b32 v11, 5, v0
    v_lshlrev_b32 v11, 4, v11
    buffer_load_dwordx4 v[92:95], v11, s[8:11], s27 offen offset:0 sc1
    buffer_load_dwordx4 v[96:99], v11, s[8:11], s27 offen offset:32 sc1
    buffer_load_dwordx4 v[100:103], v11, s[8:11], s27 offen offset:64 sc1
    buffer_load_dwordx4 v[104:107], v11, s[8:11], s27 offen offset:96 sc1
    s_waitcnt lgkmcnt(0)
    ds_read_b64_tr_b16 v[20:21], v4 offset:8192
    ds_read_b64_tr_b16 v[22:23], v4 offset:9216
    ds_read_b64_tr_b16 v[24:25], v5 offset:8192
    ds_read_b64_tr_b16 v[26:27], v5 offset:9216
    s_waitcnt vmcnt(12)
    v_mfma_f32_32x32x16_bf16 v[76:91], v[16:19], a[68:71], v[76:91]
    v_mfma_f32_32x32x16_bf16 v[60:75], v[12:15], a[68:71], v[60:75]
    v_mfma_f32_32x32x16_bf16 v[44:59], v[16:19], a[64:67], v[44:59]
    v_mfma_f32_32x32x16_bf16 v[28:43], v[12:15], a[64:67], v[28:43]
    s_waitcnt lgkmcnt(0)
    ds_read_b64_tr_b16 v[12:13], v4 offset:16384
    ds_read_b64_tr_b16 v[14:15], v4 offset:17408
    ds_read_b64_tr_b16 v[16:17], v5 offset:16384
    ds_read_b64_tr_b16 v[18:19], v5 offset:17408
    s_waitcnt vmcnt(10)
    v_mfma_f32_32x32x16_bf16 v[76:91], v[24:27], a[76:79], v[76:91]
    v_mfma_f32_32x32x16_bf16 v[60:75], v[20:23], a[76:79], v[60:75]
    v_mfma_f32_32x32x16_bf16 v[44:59], v[24:27], a[72:75], v[44:59]
    v_mfma_f32_32x32x16_bf16 v[28:43], v[20:23], a[72:75], v[28:43]
    s_waitcnt lgkmcnt(0)
    ds_read_b64_tr_b16 v[20:21], v4 offset:24576
    ds_read_b64_tr_b16 v[22:23], v4 offset:25600
    ds_read_b64_tr_b16 v[24:25], v5 offset:24576
    ds_read_b64_tr_b16 v[26:27], v5 offset:25600
    s_waitcnt vmcnt(8)
    v_mfma_f32_32x32x16_bf16 v[76:91], v[16:19], a[84:87], v[76:91]
    v_mfma_f32_32x32x16_bf16 v[60:75], v[12:15], a[84:87], v[60:75]
    v_mfma_f32_32x32x16_bf16 v[44:59], v[16:19], a[80:83], v[44:59]
    v_mfma_f32_32x32x16_bf16 v[28:43], v[12:15], a[80:83], v[28:43]
    s_waitcnt lgkmcnt(0)
    s_waitcnt vmcnt(6)
    v_mfma_f32_32x32x16_bf16 v[76:91], v[24:27], a[92:95], v[76:91]
    v_mfma_f32_32x32x16_bf16 v[60:75], v[20:23], a[92:95], v[60:75]
    v_mfma_f32_32x32x16_bf16 v[44:59], v[24:27], a[88:91], v[44:59]
    v_mfma_f32_32x32x16_bf16 v[28:43], v[20:23], a[88:91], v[28:43]
    v_add_u32 v2, s29, v1
    v_add_u32 v2, 32768, v2
    v_xor_b32 v3, 2048, v2
    v_xor_b32 v4, 4096, v2
    v_xor_b32 v5, 6144, v2
    v_and_b32 v7, 31, v0
    v_lshl_add_u32 v7, v7, 10, v11
    s_nop 1
    ds_write_b128 v2, v[76:79] offset:32768
    ds_write_b128 v2, v[80:83] offset:33792
    ds_write_b128 v2, v[84:87] offset:40960
    ds_write_b128 v2, v[88:91] offset:41984
    ds_write_b128 v2, v[60:63] offset:16384
    ds_write_b128 v2, v[64:67] offset:17408
    ds_write_b128 v2, v[68:71] offset:24576
    ds_write_b128 v2, v[72:75] offset:25600
    ds_write_b128 v2, v[44:47] offset:0
    ds_write_b128 v2, v[48:51] offset:1024
    ds_write_b128 v2, v[52:55] offset:8192
    ds_write_b128 v2, v[56:59] offset:9216
    s_waitcnt vmcnt(0)
    v_accvgpr_read_b32 v13, a128
    v_accvgpr_read_b32 v15, a129
    v_lshlrev_b32 v12, 16, v13
    v_and_b32 v13, 0xffff0000, v13
    v_lshlrev_b32 v14, 16, v15
    v_and_b32 v15, 0xffff0000, v15
    v_accvgpr_read_b32 v17, a132
    v_accvgpr_read_b32 v19, a133
    v_lshlrev_b32 v16, 16, v17
    v_and_b32 v17, 0xffff0000, v17
    v_lshlrev_b32 v18, 16, v19
    v_and_b32 v19, 0xffff0000, v19
    v_accvgpr_read_b32 v21, a130
    v_accvgpr_read_b32 v23, a131
    v_lshlrev_b32 v20, 16, v21
    v_and_b32 v21, 0xffff0000, v21
    v_lshlrev_b32 v22, 16, v23
    v_and_b32 v23, 0xffff0000, v23
    v_accvgpr_read_b32 v25, a134
    v_accvgpr_read_b32 v27, a135
    v_lshlrev_b32 v24, 16, v25
    v_and_b32 v25, 0xffff0000, v25
    v_lshlrev_b32 v26, 16, v27
    v_and_b32 v27, 0xffff0000, v27
    s_waitcnt lgkmcnt(0)
    s_barrier
    ds_read_b128 v[44:47], v3 offset:0
    ds_read_b128 v[48:51], v4 offset:16384
    ds_read_b128 v[52:55], v5 offset:32768
    ds_read_b128 v[56:59], v3 offset:1024
    ds_read_b128 v[60:63], v4 offset:17408
    ds_read_b128 v[64:67], v5 offset:33792
    ds_read_b128 v[68:71], v3 offset:8192
    ds_read_b128 v[72:75], v4 offset:24576
    ds_read_b128 v[76:79], v5 offset:40960
    ds_read_b128 v[80:83], v3 offset:9216
    ds_read_b128 v[84:87], v4 offset:25600
    ds_read_b128 v[88:91], v5 offset:41984
    s_waitcnt lgkmcnt(9)
    v_pk_add_f32 v[28:29], v[28:29], v[44:45]
    v_pk_add_f32 v[48:49], v[48:49], v[52:53]
    v_pk_add_f32 v[30:31], v[30:31], v[46:47]
    v_pk_add_f32 v[50:51], v[50:51], v[54:55]
    v_pk_add_f32 v[28:29], v[28:29], v[48:49]
    v_pk_add_f32 v[30:31], v[30:31], v[50:51]
    v_pk_fma_f32 v[28:29], v[28:29], v[92:93], v[12:13]
    v_pk_fma_f32 v[30:31], v[30:31], v[94:95], v[14:15]
    v_cvt_pk_bf16_f32 v12, v28, v29
    v_cvt_pk_bf16_f32 v13, v30, v31
    s_waitcnt lgkmcnt(6)
    v_pk_add_f32 v[32:33], v[32:33], v[56:57]
    v_pk_add_f32 v[60:61], v[60:61], v[64:65]
    v_pk_add_f32 v[34:35], v[34:35], v[58:59]
    v_pk_add_f32 v[62:63], v[62:63], v[66:67]
    v_pk_add_f32 v[32:33], v[32:33], v[60:61]
    v_pk_add_f32 v[34:35], v[34:35], v[62:63]
    v_pk_fma_f32 v[32:33], v[32:33], v[96:97], v[16:17]
    v_pk_fma_f32 v[34:35], v[34:35], v[98:99], v[18:19]
    v_cvt_pk_bf16_f32 v14, v32, v33
    v_cvt_pk_bf16_f32 v15, v34, v35
    s_nop 0
    v_permlane32_swap_b32 v12, v14
    v_permlane32_swap_b32 v13, v15
    buffer_store_dwordx4 v[12:15], v7, s[12:15], s28 offen offset:0
    s_waitcnt lgkmcnt(3)
    v_pk_add_f32 v[36:37], v[36:37], v[68:69]
    v_pk_add_f32 v[72:73], v[72:73], v[76:77]
    v_pk_add_f32 v[38:39], v[38:39], v[70:71]
    v_pk_add_f32 v[74:75], v[74:75], v[78:79]
    v_pk_add_f32 v[36:37], v[36:37], v[72:73]
    v_pk_add_f32 v[38:39], v[38:39], v[74:75]
    v_pk_fma_f32 v[36:37], v[36:37], v[100:101], v[20:21]
    v_pk_fma_f32 v[38:39], v[38:39], v[102:103], v[22:23]
    v_cvt_pk_bf16_f32 v20, v36, v37
    v_cvt_pk_bf16_f32 v21, v38, v39
    s_waitcnt lgkmcnt(0)
    v_pk_add_f32 v[40:41], v[40:41], v[80:81]
    v_pk_add_f32 v[84:85], v[84:85], v[88:89]
    v_pk_add_f32 v[42:43], v[42:43], v[82:83]
    v_pk_add_f32 v[86:87], v[86:87], v[90:91]
    v_pk_add_f32 v[40:41], v[40:41], v[84:85]
    v_pk_add_f32 v[42:43], v[42:43], v[86:87]
    v_pk_fma_f32 v[40:41], v[40:41], v[104:105], v[24:25]
    v_pk_fma_f32 v[42:43], v[42:43], v[106:107], v[26:27]
    v_cvt_pk_bf16_f32 v22, v40, v41
    v_cvt_pk_bf16_f32 v23, v42, v43
    s_nop 0
    v_permlane32_swap_b32 v20, v22
    v_permlane32_swap_b32 v21, v23
    buffer_store_dwordx4 v[20:23], v7, s[12:15], s28 offen offset:32
    s_branch .exit_fused_kernel_4
.loader_fused_kernel_71:
    s_mul_i32 s18, s7, 57344
    s_lshl_b32 s30, s40, 8
    s_add_u32 s18, s18, s30
    s_add_u32 s18, s18, 917632
    v_add_u32 v11, 27648, v108
    s_waitcnt vmcnt(0)
    s_cmp_eq_u32 s47, 0
    s_cbranch_scc1 .pslow_fused_kernel_97
    buffer_store_dword v9, off, s[8:11], s34 offset:0
.pback_fused_kernel_98:
    s_add_u32 m0, s29, 49152
    s_nop 0
    buffer_load_dwordx4 v108, s[48:51], s18 offen lds
    buffer_load_dwordx4 v11, s[48:51], s18 offen offset:1024 lds
    s_add_u32 s18, s18, 688128
    s_lshl_b32 s24, s42, 14
    s_lshr_b32 s36, s36, 2
    s_lshl_b32 s30, s36, 7
    s_add_u32 s24, s24, s30
    v_bfe_u32 v3, v0, 4, 1
    v_lshlrev_b32 v3, 2, v3
    v_xor_b32 v3, v3, v0
    v_and_b32 v3, 7, v3
    v_lshrrev_b32 v2, 3, v0
    v_mul_u32_u24 v2, 1024, v2
    v_lshl_add_u32 v2, v3, 4, v2
    v_add_u32 v3, 7168, v2
    v_add_u32 v4, s29, v1
    v_add_u32 v5, 0x10000, v4
    v_add_u32 v6, 0x20000, v4
    s_add_u32 m0, s29, 73728
    s_nop 0
    buffer_load_dwordx4 v108, s[48:51], s18 offen lds
    buffer_load_dwordx4 v11, s[48:51], s18 offen offset:1024 lds
    s_barrier
    s_add_u32 m0, s29, 0
    s_nop 0
    buffer_load_dwordx4 v2, s[52:55], s24 offen lds
    buffer_load_dwordx4 v3, s[52:55], s24 offen offset:1024 lds
    s_add_u32 s24, s24, 0x40000
    s_add_u32 m0, s29, 8192
    s_nop 0
    buffer_load_dwordx4 v2, s[52:55], s24 offen lds
    buffer_load_dwordx4 v3, s[52:55], s24 offen offset:1024 lds
    s_add_u32 s24, s24, 0x40000
    s_add_u32 m0, s29, 16384
    s_nop 0
    buffer_load_dwordx4 v2, s[52:55], s24 offen lds
    buffer_load_dwordx4 v3, s[52:55], s24 offen offset:1024 lds
    s_add_u32 s24, s24, 0x40000
    s_add_u32 m0, s29, 24576
    s_nop 0
    buffer_load_dwordx4 v2, s[52:55], s24 offen lds
    buffer_load_dwordx4 v3, s[52:55], s24 offen offset:1024 lds
    s_add_u32 s24, s24, 0xfffd8000
    buffer_load_dwordx4 a[88:91], v2, s[52:55], s24 offen
    buffer_load_dwordx4 a[92:95], v3, s[52:55], s24 offen offset:1024
    s_add_u32 s24, s24, 0x40000
    buffer_load_dwordx4 a[96:99], v2, s[52:55], s24 offen
    buffer_load_dwordx4 a[100:103], v3, s[52:55], s24 offen offset:1024
    s_add_u32 s24, s24, 0x40000
    buffer_load_dwordx4 a[104:107], v2, s[52:55], s24 offen
    buffer_load_dwordx4 a[108:111], v3, s[52:55], s24 offen offset:1024
    s_add_u32 s24, s24, 0x40000
    buffer_load_dwordx4 a[112:115], v2, s[52:55], s24 offen
    buffer_load_dwordx4 a[116:119], v3, s[52:55], s24 offen offset:1024
    s_add_u32 s24, s24, 0x40000
    buffer_load_dwordx4 a[120:123], v2, s[52:55], s24 offen
    buffer_load_dwordx4 a[124:127], v3, s[52:55], s24 offen offset:1024
    s_waitcnt vmcnt(18)
    s_barrier
    s_add_u32 s24, s24, 0xfff68000
    s_add_u32 m0, s29, 98304
    s_nop 0
    buffer_load_dwordx4 v2, s[52:55], s24 offen lds
    buffer_load_dwordx4 v3, s[52:55], s24 offen offset:1024 lds
    s_add_u32 s24, s24, 0x40000
    s_add_u32 m0, s29, 106496
    s_nop 0
    buffer_load_dwordx4 v2, s[52:55], s24 offen lds
    buffer_load_dwordx4 v3, s[52:55], s24 offen offset:1024 lds
    s_add_u32 s24, s24, 0x40000
    s_add_u32 m0, s29, 114688
    s_nop 0
    buffer_load_dwordx4 v2, s[52:55], s24 offen lds
    buffer_load_dwordx4 v3, s[52:55], s24 offen offset:1024 lds
    s_add_u32 s24, s24, 0xffe88000
    s_add_u32 m0, s29, 122880
    s_nop 0
    buffer_load_dwordx4 v2, s[52:55], s24 offen lds
    buffer_load_dwordx4 v3, s[52:55], s24 offen offset:1024 lds
    s_add_u32 s24, s24, 0x40000
    s_add_u32 m0, s29, 131072
    s_nop 0
    buffer_load_dwordx4 v2, s[52:55], s24 offen lds
    buffer_load_dwordx4 v3, s[52:55], s24 offen offset:1024 lds
    s_add_u32 s24, s24, 0x40000
    s_add_u32 m0, s29, 139264
    s_nop 0
    buffer_load_dwordx4 v2, s[52:55], s24 offen lds
    buffer_load_dwordx4 v3, s[52:55], s24 offen offset:1024 lds
    s_add_u32 s24, s24, 0x40000
    s_add_u32 m0, s29, 147456
    s_nop 0
    buffer_load_dwordx4 v2, s[52:55], s24 offen lds
    buffer_load_dwordx4 v3, s[52:55], s24 offen offset:1024 lds
    s_add_u32 s24, s24, 0x40000
    s_add_u32 m0, s29, 155648
    s_nop 0
    buffer_load_dwordx4 v2, s[52:55], s24 offen lds
    buffer_load_dwordx4 v3, s[52:55], s24 offen offset:1024 lds
    s_barrier
    s_add_u32 s24, s24, 0x40000
    s_add_u32 m0, s29, 32768
    s_nop 0
    buffer_load_dwordx4 v2, s[52:55], s24 offen lds
    buffer_load_dwordx4 v3, s[52:55], s24 offen offset:1024 lds
    s_add_u32 s24, s24, 0x40000
    s_add_u32 m0, s29, 40960
    s_nop 0
    buffer_load_dwordx4 v2, s[52:55], s24 offen lds
    buffer_load_dwordx4 v3, s[52:55], s24 offen offset:1024 lds
    s_add_u32 s24, s24, 0xffe88000
    s_add_u32 m0, s29, 81920
    s_nop 0
    buffer_load_dwordx4 v2, s[52:55], s24 offen lds
    buffer_load_dwordx4 v3, s[52:55], s24 offen offset:1024 lds
    s_add_u32 s24, s24, 0x40000
    s_add_u32 m0, s29, 90112
    s_nop 0
    buffer_load_dwordx4 v2, s[52:55], s24 offen lds
    buffer_load_dwordx4 v3, s[52:55], s24 offen offset:1024 lds
    s_waitcnt vmcnt(8)
    s_barrier
    ds_write_b128 v4, a[0:3] offset:49152
    ds_write_b128 v4, a[4:7] offset:50176
    ds_write_b128 v4, a[8:11] offset:57344
    ds_write_b128 v4, a[12:15] offset:58368
    ds_write_b128 v5, a[16:19] offset:0
    ds_write_b128 v5, a[20:23] offset:1024
    ds_write_b128 v5, a[24:27] offset:8192
    ds_write_b128 v5, a[28:31] offset:9216
    s_barrier
    ds_write_b128 v4, a[64:67] offset:0
    ds_write_b128 v4, a[68:71] offset:1024
    ds_write_b128 v4, a[72:75] offset:8192
    ds_write_b128 v4, a[76:79] offset:9216
    ds_write_b128 v4, a[80:83] offset:16384
    ds_write_b128 v4, a[84:87] offset:17408
    ds_write_b128 v4, a[88:91] offset:24576
    ds_write_b128 v4, a[92:95] offset:25600
    s_waitcnt vmcnt(0)
    s_waitcnt lgkmcnt(0)
    s_barrier
    ds_write_b128 v5, a[96:99] offset:32768
    ds_write_b128 v5, a[100:103] offset:33792
    ds_write_b128 v5, a[104:107] offset:40960
    ds_write_b128 v5, a[108:111] offset:41984
    ds_write_b128 v5, a[112:115] offset:49152
    ds_write_b128 v5, a[116:119] offset:50176
    ds_write_b128 v5, a[120:123] offset:57344
    ds_write_b128 v5, a[124:127] offset:58368
    s_waitcnt lgkmcnt(0)
    s_barrier
.exit_fused_kernel_4:
.end_fused_kernel_1:
    s_endpgm
.own_fused_kernel_26:
    v_accvgpr_write_b32 a136, v82
    v_accvgpr_write_b32 a137, v83
    v_accvgpr_write_b32 a138, v84
    v_accvgpr_write_b32 a139, v85
    v_accvgpr_write_b32 a140, v98
    v_accvgpr_write_b32 a141, v99
    v_accvgpr_write_b32 a142, v100
    v_accvgpr_write_b32 a143, v101
    s_load_dwordx2 s[40:41], s[0:1], 64
    s_mov_b32 s42, 1024
    s_mov_b32 s43, 0x20000
    v_lshrrev_b32 v86, 5, v0
    v_and_b32 v87, 31, v0
    v_lshlrev_b32 v87, 3, v87
    v_mul_u32_u24 v96, 1572864, v86
    v_add_u32 v87, v87, v96
    v_lshlrev_b32 v86, 9, v86
    s_lshl_b32 s44, s3, 8
    s_xor_b32 s44, s44, 1024
    s_mov_b32 s45, 0
    v_mov_b32 v80, 0
    v_mov_b32 v81, 0
    v_mov_b32 v82, 0
    v_mov_b32 v83, 0
    s_waitcnt lgkmcnt(0)
.ownloop_fused_kernel_27:
    buffer_load_dwordx2 v[84:85], v86, s[40:43], s45 offen
    buffer_load_dwordx2 v[88:89], v87, s[96:99], s44 offen
    s_add_u32 s44, s44, 6144
    buffer_load_dwordx2 v[90:91], v87, s[96:99], s44 offen
    s_add_u32 s44, s44, 6144
    buffer_load_dwordx2 v[92:93], v87, s[96:99], s44 offen
    s_add_u32 s44, s44, 6144
    buffer_load_dwordx2 v[94:95], v87, s[96:99], s44 offen
    s_add_u32 s44, s44, 6144
    s_waitcnt vmcnt(0)
    v_lshlrev_b32 v96, 16, v84
    v_and_b32 v97, 0xffff0000, v84
    v_lshlrev_b32 v98, 16, v85
    v_and_b32 v99, 0xffff0000, v85
    v_mul_f32 v100, 0xbfb8aa3b, v96
    v_mul_f32 v101, 0xbfb8aa3b, v97
    v_mul_f32 v102, 0xbfb8aa3b, v98
    v_mul_f32 v103, 0xbfb8aa3b, v99
    v_exp_f32 v100, v100
    v_exp_f32 v101, v101
    v_exp_f32 v102, v102
    v_exp_f32 v103, v103
    v_add_f32 v100, 1.0, v100
    v_add_f32 v101, 1.0, v101
    v_add_f32 v102, 1.0, v102
    v_add_f32 v103, 1.0, v103
    v_rcp_f32 v100, v100
    v_rcp_f32 v101, v101
    v_rcp_f32 v102, v102
    v_rcp_f32 v103, v103
    v_mul_f32 v96, v96, v100
    v_mul_f32 v97, v97, v101
    v_mul_f32 v98, v98, v102
    v_mul_f32 v99, v99, v103
    v_cvt_pk_bf16_f32 v96, v96, v96
    v_cvt_pk_bf16_f32 v97, v97, v97
    v_cvt_pk_bf16_f32 v98, v98, v98
    v_cvt_pk_bf16_f32 v99, v99, v99
    v_lshlrev_b32 v96, 16, v96
    v_lshlrev_b32 v97, 16, v97
    v_lshlrev_b32 v98, 16, v98
    v_lshlrev_b32 v99, 16, v99
    v_lshlrev_b32 v100, 16, v88
    v_and_b32 v101, 0xffff0000, v88
    v_fmac_f32 v80, v100, v96
    v_fmac_f32 v81, v101, v96
    v_lshlrev_b32 v100, 16, v89
    v_and_b32 v101, 0xffff0000, v89
    v_fmac_f32 v82, v100, v96
    v_fmac_f32 v83, v101, v96
    v_lshlrev_b32 v100, 16, v90
    v_and_b32 v101, 0xffff0000, v90
    v_fmac_f32 v80, v100, v97
    v_fmac_f32 v81, v101, v97
    v_lshlrev_b32 v100, 16, v91
    v_and_b32 v101, 0xffff0000, v91
    v_fmac_f32 v82, v100, v97
    v_fmac_f32 v83, v101, v97
    v_lshlrev_b32 v100, 16, v92
    v_and_b32 v101, 0xffff0000, v92
    v_fmac_f32 v80, v100, v98
    v_fmac_f32 v81, v101, v98
    v_lshlrev_b32 v100, 16, v93
    v_and_b32 v101, 0xffff0000, v93
    v_fmac_f32 v82, v100, v98
    v_fmac_f32 v83, v101, v98
    v_lshlrev_b32 v100, 16, v94
    v_and_b32 v101, 0xffff0000, v94
    v_fmac_f32 v80, v100, v99
    v_fmac_f32 v81, v101, v99
    v_lshlrev_b32 v100, 16, v95
    v_and_b32 v101, 0xffff0000, v95
    v_fmac_f32 v82, v100, v99
    v_fmac_f32 v83, v101, v99
    s_add_u32 s45, s45, 8
    s_cmp_lt_u32 s45, 512
    s_cbranch_scc1 .ownloop_fused_kernel_27
    v_mov_b32 v90, v80
    v_mov_b32 v91, v81
    v_mov_b32 v92, v82
    v_mov_b32 v93, v83
    v_accvgpr_read_b32 v82, a136
    v_accvgpr_read_b32 v83, a137
    v_accvgpr_read_b32 v84, a138
    v_accvgpr_read_b32 v85, a139
    v_accvgpr_read_b32 v98, a140
    v_accvgpr_read_b32 v99, a141
    v_accvgpr_read_b32 v100, a142
    v_accvgpr_read_b32 v101, a143
    s_branch .modgo_fused_kernel_25
.spin_fused_kernel_42:
    s_sleep 1
    buffer_load_dword v88, v111, s[8:11], s59 offen sc1
    s_waitcnt vmcnt(0)
    v_cmp_eq_u32 s[30:31], 1, v88
    s_nop 1
    s_cmp_eq_u64 s[30:31], -1
    s_cbranch_scc1 .seen_fused_kernel_44
    s_sub_u32 s7, s7, 1
    s_cbranch_scc0 .spin_fused_kernel_42
    s_mov_b32 s7, 0
.seen_fused_kernel_44:
    s_branch .ready_fused_kernel_43
.spin_fused_kernel_45:
    s_sleep 1
    buffer_load_dword v106, v105, s[8:11], s61 offen sc1
    s_waitcnt vmcnt(0)
    v_cmp_eq_u32 s[30:31], 1, v106
    s_nop 1
    s_cmp_eq_u64 s[30:31], -1
    s_cbranch_scc1 .seen_fused_kernel_47
    s_sub_u32 s7, s7, 1
    s_cbranch_scc0 .spin_fused_kernel_45
    s_mov_b32 s7, 0
.seen_fused_kernel_47:
    s_branch .ready_fused_kernel_46
.modspin_fused_kernel_57:
    s_sub_u32 s7, s7, 1
    s_cbranch_scc1 .modout_fused_kernel_58
    buffer_load_dwordx4 v[102:105], v1, s[8:11], s57 offen sc1
    s_waitcnt vmcnt(0)
    v_min3_u32 v111, v102, v103, v104
    v_min_u32 v111, v111, v105
    v_cmp_eq_u32 vcc, 0, v111
    s_nop 4
    s_cbranch_vccnz .modspin_fused_kernel_57
    s_branch .modchk_fused_kernel_56
.modout_fused_kernel_58:
    s_mov_b32 s7, 0
    s_branch .modchk_fused_kernel_56
.modspin_fused_kernel_66:
    s_sub_u32 s7, s7, 1
    s_cbranch_scc1 .modout_fused_kernel_67
    buffer_load_dwordx4 v[102:105], v1, s[8:11], s57 offen sc1
    s_waitcnt vmcnt(0)
    v_min3_u32 v111, v102, v103, v104
    v_min_u32 v111, v111, v105
    v_cmp_eq_u32 vcc, 0, v111
    s_nop 4
    s_cbranch_vccnz .modspin_fused_kernel_66
    s_branch .modchk_fused_kernel_65
.modout_fused_kernel_67:
    s_mov_b32 s7, 0
    s_branch .modchk_fused_kernel_65
.pslow_fused_kernel_72:
    s_add_u32 s30, s34, 4096
    buffer_store_dword v9, off, s[8:11], s30 offset:0 sc1
    s_branch .pback_fused_kernel_73
.spin_fused_kernel_74:
    buffer_load_dword v10, v8, s[8:11], s17 offen offset:0 sc1
    s_waitcnt vmcnt(0)
    v_cmp_ne_u32 s[32:33], 0, v10
.test_fused_kernel_75:
    s_nop 1
    s_or_b32 s32, s32, s33
    s_cmp_eq_u32 s32, -1
    s_cbranch_scc1 .ready_fused_kernel_76
    s_sub_u32 s31, s31, 1
    s_cbranch_scc0 .spin_fused_kernel_74
    s_mov_b32 s31, 0
    s_branch .ready_fused_kernel_76
.pslow_fused_kernel_77:
    s_add_u32 s30, s21, 4096
    buffer_store_dword v9, off, s[8:11], s30 offset:0 sc1
    s_branch .pback_fused_kernel_78
.pslow_fused_kernel_79:
    s_add_u32 s30, s21, 4096
    buffer_store_dword v9, off, s[8:11], s30 offset:512 sc1
    s_branch .pback_fused_kernel_80
.spin_fused_kernel_81:
    buffer_load_dword v10, v8, s[8:11], s25 offen offset:0 sc1
    s_waitcnt vmcnt(0)
    v_cmp_ne_u32 s[32:33], 0, v10
.test_fused_kernel_82:
    s_nop 1
    s_or_b32 s32, s32, s33
    s_cmp_eq_u32 s32, -1
    s_cbranch_scc1 .ready_fused_kernel_83
    s_sub_u32 s31, s31, 1
    s_cbranch_scc0 .spin_fused_kernel_81
    s_mov_b32 s31, 0
    s_branch .ready_fused_kernel_83
.pslow_fused_kernel_84:
    s_add_u32 s30, s21, 4096
    buffer_store_dword v9, off, s[8:11], s30 offset:1024 sc1
    s_branch .pback_fused_kernel_85
.spin_fused_kernel_86:
    buffer_load_dword v10, v8, s[8:11], s25 offen offset:512 sc1
    s_waitcnt vmcnt(0)
    v_cmp_ne_u32 s[32:33], 0, v10
.test_fused_kernel_87:
    s_nop 1
    s_or_b32 s32, s32, s33
    s_cmp_eq_u32 s32, -1
    s_cbranch_scc1 .ready_fused_kernel_88
    s_sub_u32 s31, s31, 1
    s_cbranch_scc0 .spin_fused_kernel_86
    s_mov_b32 s31, 0
    s_branch .ready_fused_kernel_88
.pslow_fused_kernel_89:
    s_add_u32 s30, s21, 4096
    buffer_store_dword v9, off, s[8:11], s30 offset:1536 sc1
    s_branch .pback_fused_kernel_90
.spin_fused_kernel_91:
    buffer_load_dword v10, v8, s[8:11], s25 offen offset:1024 sc1
    s_waitcnt vmcnt(0)
    v_cmp_ne_u32 s[32:33], 0, v10
.test_fused_kernel_92:
    s_nop 1
    s_or_b32 s32, s32, s33
    s_cmp_eq_u32 s32, -1
    s_cbranch_scc1 .ready_fused_kernel_93
    s_sub_u32 s31, s31, 1
    s_cbranch_scc0 .spin_fused_kernel_91
    s_mov_b32 s31, 0
    s_branch .ready_fused_kernel_93
.spin_fused_kernel_94:
    buffer_load_dword v10, v8, s[8:11], s25 offen offset:1536 sc1
    s_waitcnt vmcnt(0)
    v_cmp_ne_u32 s[32:33], 0, v10
.test_fused_kernel_95:
    s_nop 1
    s_or_b32 s32, s32, s33
    s_cmp_eq_u32 s32, -1
    s_cbranch_scc1 .ready_fused_kernel_96
    s_sub_u32 s31, s31, 1
    s_cbranch_scc0 .spin_fused_kernel_94
    s_mov_b32 s31, 0
    s_branch .ready_fused_kernel_96
.pslow_fused_kernel_97:
    s_add_u32 s30, s34, 4096
    buffer_store_dword v9, off, s[8:11], s30 offset:0 sc1
    s_branch .pback_fused_kernel_98
.fb_fused_kernel_2:
    s_mov_b32 s22, 0xffff
    s_mov_b32 s23, 0xffff
    s_mov_b32 s19, 0x12800000
    s_mov_b32 s20, 1090519040
    s_and_b32 s21, s2, 7
    s_lshl_b32 s21, s21, 5
    s_lshr_b32 s35, s2, 3
    s_add_u32 s21, s21, s35
    s_lshl_b32 s28, s21, 13
    s_cmp_lt_u32 s3, 4
    s_cselect_b64 vcc, -1, 0
    v_lshrrev_b32 v5, 5, v0
    v_and_b32 v9, 15, v0
    v_lshlrev_b32 v9, 4, v9
    v_lshl_add_u32 v9, v5, 8, v9
    s_add_u32 s34, s28, 2097152
    s_add_u32 s32, s29, 1
    s_and_b32 s32, s32, 7
    s_lshl_b32 s32, s32, 10
    s_add_u32 s32, s32, s34
    s_add_u32 s33, s29, s3
    s_and_b32 s33, s33, 7
    s_lshl_b32 s33, s33, 10
    s_add_u32 s34, s34, s33
    s_lshl_b32 s33, s3, 10
    s_lshl_b32 s36, s3, 11
    s_lshl_b32 s35, s29, 14
    s_add_u32 s36, s36, s35
    s_add_u32 s36, s36, 5242880
    s_lshl_b32 s17, s3, 12
    s_lshl_b32 s35, s29, 16
    s_add_u32 s17, s17, s35
    s_add_u32 s17, s17, 4194304
    s_add_u32 s18, s17, 32768
    s_lshl_b32 s35, s3, 11
    v_add_u32 v2, s35, v1
    v_and_b32 v3, 31, v0
    v_lshlrev_b32 v3, 5, v3
    s_lshl_b32 s35, s3, 2
    v_add_u32 v3, s35, v3
    s_lshl_b32 s35, s3, 9
    v_lshl_add_u32 v4, v0, 3, s35
    v_lshrrev_b32 v5, 1, v0
    v_lshrrev_b32 v6, 4, v5
    v_lshlrev_b32 v6, 9, v6
    v_and_b32 v7, 7, v5
    v_lshl_add_u32 v6, v7, 4, v6
    v_bfe_u32 v7, v5, 3, 1
    v_lshl_add_u32 v6, v7, 3, v6
    v_and_b32 v7, 1, v0
    v_lshl_add_u32 v6, v7, 2, v6
    s_lshl_b32 s35, s3, 7
    v_add_u32 v6, s35, v6
    v_lshlrev_b32 v5, 5, v5
    v_lshrrev_b32 v7, 4, v0
    v_lshlrev_b32 v7, 3, v7
    v_and_b32 v8, 7, v0
    v_add_u32 v7, v7, v8
    v_lshlrev_b32 v7, 4, v7
    v_add_u32 v7, 32768, v7
    v_add_u32 v8, 65536, v1
    s_mov_b32 s16, 1
    s_mov_b64 s[24:25], 0
    s_add_u32 m0, s33, 65536
    s_waitcnt vmcnt(0)
    s_barrier
    buffer_load_dwordx4 v1, s[8:11], s34 offen sc1 lds
    buffer_load_dwordx4 a[0:3], v1, s[8:11], s36 offen sc1
    s_add_u32 s36, s36, 16384
    s_bitset0_b32 s36, 17
    buffer_load_dwordx4 a[4:7], v1, s[8:11], s36 offen sc1
    s_add_u32 s36, s36, 16384
    s_bitset0_b32 s36, 17
    buffer_load_dwordx4 a[8:11], v1, s[8:11], s36 offen sc1
    s_add_u32 s36, s36, 16384
    s_bitset0_b32 s36, 17
    buffer_load_dwordx4 a[12:15], v1, s[8:11], s36 offen sc1
    s_add_u32 s36, s36, 16384
    s_bitset0_b32 s36, 17
    buffer_load_dwordx4 a[16:19], v1, s[8:11], s36 offen sc1
    s_add_u32 s36, s36, 16384
    s_bitset0_b32 s36, 17
    buffer_load_dwordx4 a[20:23], v1, s[8:11], s36 offen sc1
    s_add_u32 s36, s36, 16384
    s_bitset0_b32 s36, 17
    buffer_load_dwordx4 a[24:27], v1, s[8:11], s36 offen sc1
    s_add_u32 s36, s36, 16384
    s_bitset0_b32 s36, 17
    buffer_load_dwordx4 a[28:31], v1, s[8:11], s36 offen sc1
    s_add_u32 s36, s36, 16384
    s_bitset0_b32 s36, 17
    s_waitcnt vmcnt(0)
    s_barrier
    s_mov_b32 s16, 0
    v_add_u32 v8, 65536, v1
    v_and_b32 v9, 31, v0
    v_lshlrev_b32 v9, 5, v9
    v_add_u32 v9, 53248, v9
    s_lshl_b32 s33, s3, 2
    v_add_u32 v7, s33, v9
.fbl_fused_kernel_99:
    ds_read_b128 v[50:53], v8
    v_add_u32 v8, 1024, v8
    v_mov_b32 v70, 0xff800000
    s_waitcnt lgkmcnt(0)
    v_mfma_f32_32x32x16_bf16 v[10:25], a[0:3], v[50:53], 0
    s_nop 11
    v_max3_f32 v70, v70, v10, v11
    v_max3_f32 v70, v70, v12, v13
    v_max3_f32 v70, v70, v14, v15
    v_max3_f32 v70, v70, v16, v17
    v_max3_f32 v70, v70, v18, v19
    v_max3_f32 v70, v70, v20, v21
    v_max3_f32 v70, v70, v22, v23
    v_max3_f32 v70, v70, v24, v25
    v_mfma_f32_32x32x16_bf16 v[10:25], a[4:7], v[50:53], 0
    s_nop 11
    v_max3_f32 v70, v70, v10, v11
    v_max3_f32 v70, v70, v12, v13
    v_max3_f32 v70, v70, v14, v15
    v_max3_f32 v70, v70, v16, v17
    v_max3_f32 v70, v70, v18, v19
    v_max3_f32 v70, v70, v20, v21
    v_max3_f32 v70, v70, v22, v23
    v_max3_f32 v70, v70, v24, v25
    v_mfma_f32_32x32x16_bf16 v[10:25], a[8:11], v[50:53], 0
    s_nop 11
    v_max3_f32 v70, v70, v10, v11
    v_max3_f32 v70, v70, v12, v13
    v_max3_f32 v70, v70, v14, v15
    v_max3_f32 v70, v70, v16, v17
    v_max3_f32 v70, v70, v18, v19
    v_max3_f32 v70, v70, v20, v21
    v_max3_f32 v70, v70, v22, v23
    v_max3_f32 v70, v70, v24, v25
    v_mfma_f32_32x32x16_bf16 v[10:25], a[12:15], v[50:53], 0
    s_nop 11
    v_max3_f32 v70, v70, v10, v11
    v_max3_f32 v70, v70, v12, v13
    v_max3_f32 v70, v70, v14, v15
    v_max3_f32 v70, v70, v16, v17
    v_max3_f32 v70, v70, v18, v19
    v_max3_f32 v70, v70, v20, v21
    v_max3_f32 v70, v70, v22, v23
    v_max3_f32 v70, v70, v24, v25
    v_mfma_f32_32x32x16_bf16 v[10:25], a[16:19], v[50:53], 0
    s_nop 11
    v_max3_f32 v70, v70, v10, v11
    v_max3_f32 v70, v70, v12, v13
    v_max3_f32 v70, v70, v14, v15
    v_max3_f32 v70, v70, v16, v17
    v_max3_f32 v70, v70, v18, v19
    v_max3_f32 v70, v70, v20, v21
    v_max3_f32 v70, v70, v22, v23
    v_max3_f32 v70, v70, v24, v25
    v_mfma_f32_32x32x16_bf16 v[10:25], a[20:23], v[50:53], 0
    s_nop 11
    v_max3_f32 v70, v70, v10, v11
    v_max3_f32 v70, v70, v12, v13
    v_max3_f32 v70, v70, v14, v15
    v_max3_f32 v70, v70, v16, v17
    v_max3_f32 v70, v70, v18, v19
    v_max3_f32 v70, v70, v20, v21
    v_max3_f32 v70, v70, v22, v23
    v_max3_f32 v70, v70, v24, v25
    v_mfma_f32_32x32x16_bf16 v[10:25], a[24:27], v[50:53], 0
    s_nop 11
    v_max3_f32 v70, v70, v10, v11
    v_max3_f32 v70, v70, v12, v13
    v_max3_f32 v70, v70, v14, v15
    v_max3_f32 v70, v70, v16, v17
    v_max3_f32 v70, v70, v18, v19
    v_max3_f32 v70, v70, v20, v21
    v_max3_f32 v70, v70, v22, v23
    v_max3_f32 v70, v70, v24, v25
    v_mfma_f32_32x32x16_bf16 v[10:25], a[28:31], v[50:53], 0
    s_nop 11
    v_max3_f32 v70, v70, v10, v11
    v_max3_f32 v70, v70, v12, v13
    v_max3_f32 v70, v70, v14, v15
    v_max3_f32 v70, v70, v16, v17
    v_max3_f32 v70, v70, v18, v19
    v_max3_f32 v70, v70, v20, v21
    v_max3_f32 v70, v70, v22, v23
    v_max3_f32 v70, v70, v24, v25
    v_mov_b32 v71, v70
    s_nop 1
    v_permlane32_swap_b32 v70, v71
    v_max_f32 v70, v70, v71
    ds_write_b32 v7, v70
    v_add_u32 v7, 1024, v7
    s_add_u32 s16, s16, 1
    s_cmp_lt_u32 s16, 8
    s_cbranch_scc1 .fbl_fused_kernel_99
    s_waitcnt lgkmcnt(0)
    s_barrier
    v_mov_b32 v70, 0
    v_mov_b32 v71, 0
    v_mov_b32 v72, 0
    v_mov_b32 v73, 0x3afe3f80
    v_mov_b32 v74, 0
    v_mov_b32 v75, 0
    v_mov_b32 v76, 0
    v_mov_b32 v77, 0
    s_mov_b64 exec, 0x110000
    v_mov_b32 v77, 0x3f803f80
    s_mov_b64 exec, -1
    s_nop 0
    v_mfma_f32_32x32x16_bf16 a[32:47], v[70:73], v[74:77], 0
    v_mfma_f32_32x32x16_bf16 a[48:63], v[70:73], v[74:77], 0
    v_mfma_f32_32x32x16_bf16 a[64:79], v[70:73], v[74:77], 0
    v_mfma_f32_32x32x16_bf16 a[80:95], v[70:73], v[74:77], 0
    s_mov_b32 s22, 0xffff
    s_mov_b32 s23, 0xffff
    s_mov_b32 s19, 0x12800000
    s_mov_b32 s20, 1090519040
    s_and_b32 s21, s2, 7
    s_lshl_b32 s21, s21, 5
    s_lshr_b32 s35, s2, 3
    s_add_u32 s21, s21, s35
    s_lshl_b32 s28, s21, 13
    s_cmp_lt_u32 s3, 4
    s_cselect_b64 vcc, -1, 0
    v_lshrrev_b32 v5, 5, v0
    v_and_b32 v9, 15, v0
    v_lshlrev_b32 v9, 4, v9
    v_lshl_add_u32 v9, v5, 8, v9
    s_add_u32 s34, s28, 2097152
    s_add_u32 s32, s29, 1
    s_and_b32 s32, s32, 7
    s_lshl_b32 s32, s32, 10
    s_add_u32 s32, s32, s34
    s_add_u32 s33, s29, s3
    s_and_b32 s33, s33, 7
    s_lshl_b32 s33, s33, 10
    s_add_u32 s34, s34, s33
    s_lshl_b32 s33, s3, 10
    s_lshl_b32 s36, s3, 11
    s_lshl_b32 s35, s29, 14
    s_add_u32 s36, s36, s35
    s_add_u32 s36, s36, 5242880
    s_lshl_b32 s17, s3, 12
    s_lshl_b32 s35, s29, 16
    s_add_u32 s17, s17, s35
    s_add_u32 s17, s17, 4194304
    s_add_u32 s18, s17, 32768
    s_lshl_b32 s35, s3, 11
    v_add_u32 v2, s35, v1
    v_and_b32 v3, 31, v0
    v_lshlrev_b32 v3, 5, v3
    s_lshl_b32 s35, s3, 2
    v_add_u32 v3, s35, v3
    s_lshl_b32 s35, s3, 9
    v_lshl_add_u32 v4, v0, 3, s35
    v_lshrrev_b32 v5, 1, v0
    v_lshrrev_b32 v6, 4, v5
    v_lshlrev_b32 v6, 9, v6
    v_and_b32 v7, 7, v5
    v_lshl_add_u32 v6, v7, 4, v6
    v_bfe_u32 v7, v5, 3, 1
    v_lshl_add_u32 v6, v7, 3, v6
    v_and_b32 v7, 1, v0
    v_lshl_add_u32 v6, v7, 2, v6
    s_lshl_b32 s35, s3, 7
    v_add_u32 v6, s35, v6
    v_lshlrev_b32 v5, 5, v5
    v_lshrrev_b32 v7, 4, v0
    v_lshlrev_b32 v7, 3, v7
    v_and_b32 v8, 7, v0
    v_add_u32 v7, v7, v8
    v_lshlrev_b32 v7, 4, v7
    v_add_u32 v7, 32768, v7
    v_add_u32 v8, 65536, v1
    s_mov_b32 s16, 1
    s_mov_b64 s[24:25], 0
    v_mov_b32 v74, 0
    v_mov_b32 v75, 0
    v_mov_b32 v76, 0
    v_mov_b32 v77, 0
    s_nop 1
    v_mfma_f32_32x32x16_bf16 a[112:127], v[74:77], v[74:77], 0
    v_mfma_f32_32x32x16_bf16 a[128:143], v[74:77], v[74:77], 0
    v_mfma_f32_32x32x16_bf16 v[54:69], v[74:77], v[74:77], 0
    v_and_b32 v104, 31, v0
    v_lshlrev_b32 v104, 5, v104
    v_add_u32 v104, 53248, v104
    buffer_load_dwordx4 a[0:3], v1, s[8:11], s36 offen sc1
    s_mov_b64 exec, s[22:23]
    buffer_load_dwordx4 a[32:35], v9, s[8:11], s36 offen offset:1024 sc1
    buffer_load_dwordx4 a[36:39], v9, s[8:11], s36 offen offset:1536 sc1
    s_mov_b64 exec, -1
    s_add_u32 s37, s36, 16384
    s_bitset0_b32 s37, 17
    buffer_load_dwordx4 a[4:7], v1, s[8:11], s37 offen sc1
    s_mov_b64 exec, s[22:23]
    buffer_load_dwordx4 a[40:43], v9, s[8:11], s37 offen offset:1024 sc1
    buffer_load_dwordx4 a[44:47], v9, s[8:11], s37 offen offset:1536 sc1
    s_mov_b64 exec, -1
    s_add_u32 s36, s37, 16384
    s_bitset0_b32 s36, 17
    buffer_load_dwordx4 a[8:11], v1, s[8:11], s36 offen sc1
    ds_read_b128 v[50:53], v8
    ds_write_b128 v1, v[74:77] offset:50176
    ds_write_b32 v74, v74 offset:30720
    v_add_u32 v8, 1024, v8
    ds_read_b128 v[78:81], v104
    ds_read_b128 v[82:85], v104 offset:16
    v_add_u32 v104, 1024, v104
    s_waitcnt lgkmcnt(0)
    v_max3_f32 v78, v78, v79, v80
    v_max3_f32 v81, v81, v82, v83
    v_max3_f32 v78, v78, v84, v85
    v_max_f32 v102, v78, v81
    s_waitcnt vmcnt(6)
    s_waitcnt lgkmcnt(0)
    v_mfma_f32_32x32x16_bf16 v[10:25], a[0:3], v[50:53], 0
    s_nop 11
    v_sub_f32 v10, v10, v102
    v_exp_f32 v10, v10
    v_sub_f32 v11, v11, v102
    v_exp_f32 v11, v11
    v_sub_f32 v12, v12, v102
    v_exp_f32 v12, v12
    v_sub_f32 v13, v13, v102
    v_exp_f32 v13, v13
    v_sub_f32 v14, v14, v102
    v_exp_f32 v14, v14
    s_setprio 3
    s_mov_b64 exec, s[22:23]
    buffer_load_dwordx4 a[48:51], v9, s[8:11], s36 offen offset:1024 sc1
    buffer_load_dwordx4 a[52:55], v9, s[8:11], s36 offen offset:1536 sc1
    s_mov_b64 exec, -1
    s_add_u32 s37, s36, 16384
    s_bitset0_b32 s37, 17
    buffer_load_dwordx4 a[12:15], v1, s[8:11], s37 offen sc1
    v_sub_f32 v15, v15, v102
    v_exp_f32 v15, v15
    v_sub_f32 v16, v16, v102
    v_exp_f32 v16, v16
    v_sub_f32 v17, v17, v102
    v_exp_f32 v17, v17
    s_waitcnt vmcnt(6)
    v_mfma_f32_32x32x16_bf16 v[26:41], a[4:7], v[50:53], 0
    v_cvt_pk_bf16_f32 v42, v10, v11
    v_cvt_pk_bf16_f32 v43, v12, v13
    v_cvt_pk_bf16_f32 v44, v14, v15
    v_cvt_pk_bf16_f32 v45, v16, v17
    v_sub_f32 v18, v18, v102
    v_exp_f32 v18, v18
    v_sub_f32 v19, v19, v102
    v_exp_f32 v19, v19
    v_sub_f32 v20, v20, v102
    v_exp_f32 v20, v20
    v_sub_f32 v21, v21, v102
    v_exp_f32 v21, v21
    s_waitcnt vmcnt(7)
    v_mfma_f32_32x32x16_bf16 a[96:111], a[32:35], v[42:45], 0
    v_sub_f32 v22, v22, v102
    v_exp_f32 v22, v22
    v_sub_f32 v23, v23, v102
    v_exp_f32 v23, v23
    v_cvt_pk_bf16_f32 v46, v18, v19
    v_cvt_pk_bf16_f32 v47, v20, v21
    v_sub_f32 v24, v24, v102
    v_exp_f32 v24, v24
    v_sub_f32 v25, v25, v102
    v_exp_f32 v25, v25
    v_cvt_pk_bf16_f32 v48, v22, v23
    v_cvt_pk_bf16_f32 v49, v24, v25
    v_sub_f32 v26, v26, v102
    v_exp_f32 v26, v26
    v_sub_f32 v27, v27, v102
    v_exp_f32 v27, v27
    v_mfma_f32_32x32x16_bf16 a[96:111], a[36:39], v[46:49], a[96:111]
    v_sub_f32 v28, v28, v102
    v_exp_f32 v28, v28
    v_sub_f32 v29, v29, v102
    v_exp_f32 v29, v29
    v_sub_f32 v30, v30, v102
    v_exp_f32 v30, v30
    s_mov_b64 exec, s[22:23]
    buffer_load_dwordx4 a[56:59], v9, s[8:11], s37 offen offset:1024 sc1
    buffer_load_dwordx4 a[60:63], v9, s[8:11], s37 offen offset:1536 sc1
    s_mov_b64 exec, -1
    s_add_u32 s36, s37, 16384
    s_bitset0_b32 s36, 17
    buffer_load_dwordx4 a[16:19], v1, s[8:11], s36 offen sc1
    v_sub_f32 v31, v31, v102
    v_exp_f32 v31, v31
    v_sub_f32 v32, v32, v102
    v_exp_f32 v32, v32
    v_sub_f32 v33, v33, v102
    v_exp_f32 v33, v33
    s_waitcnt vmcnt(6)
    v_mfma_f32_32x32x16_bf16 v[10:25], a[8:11], v[50:53], 0
    v_cvt_pk_bf16_f32 v42, v26, v27
    v_cvt_pk_bf16_f32 v43, v28, v29
    v_cvt_pk_bf16_f32 v44, v30, v31
    v_cvt_pk_bf16_f32 v45, v32, v33
    v_sub_f32 v34, v34, v102
    v_exp_f32 v34, v34
    v_sub_f32 v35, v35, v102
    v_exp_f32 v35, v35
    v_sub_f32 v36, v36, v102
    v_exp_f32 v36, v36
    v_sub_f32 v37, v37, v102
    v_exp_f32 v37, v37
    s_waitcnt vmcnt(7)
    v_mfma_f32_32x32x16_bf16 a[96:111], a[40:43], v[42:45], a[96:111]
    v_sub_f32 v38, v38, v102
    v_exp_f32 v38, v38
    v_sub_f32 v39, v39, v102
    v_exp_f32 v39, v39
    v_cvt_pk_bf16_f32 v46, v34, v35
    v_cvt_pk_bf16_f32 v47, v36, v37
    v_sub_f32 v40, v40, v102
    v_exp_f32 v40, v40
    v_sub_f32 v41, v41, v102
    v_exp_f32 v41, v41
    v_cvt_pk_bf16_f32 v48, v38, v39
    v_cvt_pk_bf16_f32 v49, v40, v41
    v_sub_f32 v10, v10, v102
    v_exp_f32 v10, v10
    v_sub_f32 v11, v11, v102
    v_exp_f32 v11, v11
    v_mfma_f32_32x32x16_bf16 a[96:111], a[44:47], v[46:49], a[96:111]
    v_sub_f32 v12, v12, v102
    v_exp_f32 v12, v12
    v_sub_f32 v13, v13, v102
    v_exp_f32 v13, v13
    v_sub_f32 v14, v14, v102
    v_exp_f32 v14, v14
    s_mov_b64 exec, s[22:23]
    buffer_load_dwordx4 a[64:67], v9, s[8:11], s36 offen offset:1024 sc1
    buffer_load_dwordx4 a[68:71], v9, s[8:11], s36 offen offset:1536 sc1
    s_mov_b64 exec, -1
    s_add_u32 s37, s36, 16384
    s_bitset0_b32 s37, 17
    buffer_load_dwordx4 a[20:23], v1, s[8:11], s37 offen sc1
    v_sub_f32 v15, v15, v102
    v_exp_f32 v15, v15
    v_sub_f32 v16, v16, v102
    v_exp_f32 v16, v16
    v_sub_f32 v17, v17, v102
    v_exp_f32 v17, v17
    s_waitcnt vmcnt(6)
    v_mfma_f32_32x32x16_bf16 v[26:41], a[12:15], v[50:53], 0
    v_cvt_pk_bf16_f32 v42, v10, v11
    v_cvt_pk_bf16_f32 v43, v12, v13
    v_cvt_pk_bf16_f32 v44, v14, v15
    v_cvt_pk_bf16_f32 v45, v16, v17
    v_sub_f32 v18, v18, v102
    v_exp_f32 v18, v18
    v_sub_f32 v19, v19, v102
    v_exp_f32 v19, v19
    v_sub_f32 v20, v20, v102
    v_exp_f32 v20, v20
    v_sub_f32 v21, v21, v102
    v_exp_f32 v21, v21
    s_waitcnt vmcnt(7)
    v_mfma_f32_32x32x16_bf16 a[96:111], a[48:51], v[42:45], a[96:111]
    v_sub_f32 v22, v22, v102
    v_exp_f32 v22, v22
    v_sub_f32 v23, v23, v102
    v_exp_f32 v23, v23
    v_cvt_pk_bf16_f32 v46, v18, v19
    v_cvt_pk_bf16_f32 v47, v20, v21
    v_sub_f32 v24, v24, v102
    v_exp_f32 v24, v24
    v_sub_f32 v25, v25, v102
    v_exp_f32 v25, v25
    v_cvt_pk_bf16_f32 v48, v22, v23
    v_cvt_pk_bf16_f32 v49, v24, v25
    v_sub_f32 v26, v26, v102
    v_exp_f32 v26, v26
    v_sub_f32 v27, v27, v102
    v_exp_f32 v27, v27
    v_mfma_f32_32x32x16_bf16 a[96:111], a[52:55], v[46:49], a[96:111]
    v_sub_f32 v28, v28, v102
    v_exp_f32 v28, v28
    v_sub_f32 v29, v29, v102
    v_exp_f32 v29, v29
    v_sub_f32 v30, v30, v102
    v_exp_f32 v30, v30
    s_mov_b64 exec, s[22:23]
    buffer_load_dwordx4 a[72:75], v9, s[8:11], s37 offen offset:1024 sc1
    buffer_load_dwordx4 a[76:79], v9, s[8:11], s37 offen offset:1536 sc1
    s_mov_b64 exec, -1
    s_add_u32 s36, s37, 16384
    s_bitset0_b32 s36, 17
    buffer_load_dwordx4 a[24:27], v1, s[8:11], s36 offen sc1
    v_sub_f32 v31, v31, v102
    v_exp_f32 v31, v31
    v_sub_f32 v32, v32, v102
    v_exp_f32 v32, v32
    v_sub_f32 v33, v33, v102
    v_exp_f32 v33, v33
    s_waitcnt vmcnt(6)
    v_mfma_f32_32x32x16_bf16 v[10:25], a[16:19], v[50:53], 0
    v_cvt_pk_bf16_f32 v42, v26, v27
    v_cvt_pk_bf16_f32 v43, v28, v29
    v_cvt_pk_bf16_f32 v44, v30, v31
    v_cvt_pk_bf16_f32 v45, v32, v33
    v_sub_f32 v34, v34, v102
    v_exp_f32 v34, v34
    v_sub_f32 v35, v35, v102
    v_exp_f32 v35, v35
    v_sub_f32 v36, v36, v102
    v_exp_f32 v36, v36
    v_sub_f32 v37, v37, v102
    v_exp_f32 v37, v37
    s_waitcnt vmcnt(7)
    v_mfma_f32_32x32x16_bf16 a[96:111], a[56:59], v[42:45], a[96:111]
    v_sub_f32 v38, v38, v102
    v_exp_f32 v38, v38
    v_sub_f32 v39, v39, v102
    v_exp_f32 v39, v39
    v_cvt_pk_bf16_f32 v46, v34, v35
    v_cvt_pk_bf16_f32 v47, v36, v37
    v_sub_f32 v40, v40, v102
    v_exp_f32 v40, v40
    v_sub_f32 v41, v41, v102
    v_exp_f32 v41, v41
    v_cvt_pk_bf16_f32 v48, v38, v39
    v_cvt_pk_bf16_f32 v49, v40, v41
    v_sub_f32 v10, v10, v102
    v_exp_f32 v10, v10
    v_sub_f32 v11, v11, v102
    v_exp_f32 v11, v11
    v_mfma_f32_32x32x16_bf16 a[96:111], a[60:63], v[46:49], a[96:111]
    v_sub_f32 v12, v12, v102
    v_exp_f32 v12, v12
    v_sub_f32 v13, v13, v102
    v_exp_f32 v13, v13
    v_sub_f32 v14, v14, v102
    v_exp_f32 v14, v14
    s_mov_b64 exec, s[22:23]
    buffer_load_dwordx4 a[80:83], v9, s[8:11], s36 offen offset:1024 sc1
    buffer_load_dwordx4 a[84:87], v9, s[8:11], s36 offen offset:1536 sc1
    s_mov_b64 exec, -1
    s_add_u32 s37, s36, 16384
    s_bitset0_b32 s37, 17
    buffer_load_dwordx4 a[28:31], v1, s[8:11], s37 offen sc1
    v_sub_f32 v15, v15, v102
    v_exp_f32 v15, v15
    v_sub_f32 v16, v16, v102
    v_exp_f32 v16, v16
    v_sub_f32 v17, v17, v102
    v_exp_f32 v17, v17
    s_waitcnt vmcnt(6)
    v_mfma_f32_32x32x16_bf16 v[26:41], a[20:23], v[50:53], 0
    v_cvt_pk_bf16_f32 v42, v10, v11
    v_cvt_pk_bf16_f32 v43, v12, v13
    v_cvt_pk_bf16_f32 v44, v14, v15
    v_cvt_pk_bf16_f32 v45, v16, v17
    v_sub_f32 v18, v18, v102
    v_exp_f32 v18, v18
    v_sub_f32 v19, v19, v102
    v_exp_f32 v19, v19
    v_sub_f32 v20, v20, v102
    v_exp_f32 v20, v20
    v_sub_f32 v21, v21, v102
    v_exp_f32 v21, v21
    s_waitcnt vmcnt(7)
    v_mfma_f32_32x32x16_bf16 a[96:111], a[64:67], v[42:45], a[96:111]
    v_sub_f32 v22, v22, v102
    v_exp_f32 v22, v22
    v_sub_f32 v23, v23, v102
    v_exp_f32 v23, v23
    v_cvt_pk_bf16_f32 v46, v18, v19
    v_cvt_pk_bf16_f32 v47, v20, v21
    v_sub_f32 v24, v24, v102
    v_exp_f32 v24, v24
    v_sub_f32 v25, v25, v102
    v_exp_f32 v25, v25
    v_cvt_pk_bf16_f32 v48, v22, v23
    v_cvt_pk_bf16_f32 v49, v24, v25
    v_sub_f32 v26, v26, v102
    v_exp_f32 v26, v26
    v_sub_f32 v27, v27, v102
    v_exp_f32 v27, v27
    v_mfma_f32_32x32x16_bf16 a[96:111], a[68:71], v[46:49], a[96:111]
    v_sub_f32 v28, v28, v102
    v_exp_f32 v28, v28
    v_sub_f32 v29, v29, v102
    v_exp_f32 v29, v29
    v_sub_f32 v30, v30, v102
    v_exp_f32 v30, v30
    s_setprio 2
    s_mov_b64 exec, s[22:23]
    buffer_load_dwordx4 a[88:91], v9, s[8:11], s37 offen offset:1024 sc1
    buffer_load_dwordx4 a[92:95], v9, s[8:11], s37 offen offset:1536 sc1
    s_mov_b64 exec, -1
    v_sub_f32 v31, v31, v102
    v_exp_f32 v31, v31
    v_sub_f32 v32, v32, v102
    v_exp_f32 v32, v32
    v_sub_f32 v33, v33, v102
    v_exp_f32 v33, v33
    s_waitcnt vmcnt(5)
    v_mfma_f32_32x32x16_bf16 v[10:25], a[24:27], v[50:53], 0
    v_cvt_pk_bf16_f32 v42, v26, v27
    v_cvt_pk_bf16_f32 v43, v28, v29
    v_cvt_pk_bf16_f32 v44, v30, v31
    v_cvt_pk_bf16_f32 v45, v32, v33
    v_sub_f32 v34, v34, v102
    v_exp_f32 v34, v34
    v_sub_f32 v35, v35, v102
    v_exp_f32 v35, v35
    v_sub_f32 v36, v36, v102
    v_exp_f32 v36, v36
    v_sub_f32 v37, v37, v102
    v_exp_f32 v37, v37
    s_waitcnt vmcnt(6)
    v_mfma_f32_32x32x16_bf16 a[96:111], a[72:75], v[42:45], a[96:111]
    v_sub_f32 v38, v38, v102
    v_exp_f32 v38, v38
    v_sub_f32 v39, v39, v102
    v_exp_f32 v39, v39
    v_cvt_pk_bf16_f32 v46, v34, v35
    v_cvt_pk_bf16_f32 v47, v36, v37
    v_sub_f32 v40, v40, v102
    v_exp_f32 v40, v40
    v_sub_f32 v41, v41, v102
    v_exp_f32 v41, v41
    v_cvt_pk_bf16_f32 v48, v38, v39
    v_cvt_pk_bf16_f32 v49, v40, v41
    v_sub_f32 v10, v10, v102
    v_exp_f32 v10, v10
    v_sub_f32 v11, v11, v102
    v_exp_f32 v11, v11
    v_mfma_f32_32x32x16_bf16 a[96:111], a[76:79], v[46:49], a[96:111]
    v_sub_f32 v12, v12, v102
    v_exp_f32 v12, v12
    v_sub_f32 v13, v13, v102
    v_exp_f32 v13, v13
    v_sub_f32 v14, v14, v102
    v_exp_f32 v14, v14
    v_sub_f32 v15, v15, v102
    v_exp_f32 v15, v15
    v_sub_f32 v16, v16, v102
    v_exp_f32 v16, v16
    v_sub_f32 v17, v17, v102
    v_exp_f32 v17, v17
    s_waitcnt vmcnt(2)
    v_mfma_f32_32x32x16_bf16 v[26:41], a[28:31], v[50:53], 0
    ds_read_b128 v[50:53], v8
    v_add_u32 v8, 1024, v8
    v_cvt_pk_bf16_f32 v42, v10, v11
    v_cvt_pk_bf16_f32 v43, v12, v13
    v_cvt_pk_bf16_f32 v44, v14, v15
    v_cvt_pk_bf16_f32 v45, v16, v17
    v_sub_f32 v18, v18, v102
    v_exp_f32 v18, v18
    v_sub_f32 v19, v19, v102
    v_exp_f32 v19, v19
    v_sub_f32 v20, v20, v102
    v_exp_f32 v20, v20
    v_sub_f32 v21, v21, v102
    v_exp_f32 v21, v21
    s_waitcnt vmcnt(3)
    v_mfma_f32_32x32x16_bf16 a[96:111], a[80:83], v[42:45], a[96:111]
    v_sub_f32 v22, v22, v102
    v_exp_f32 v22, v22
    v_sub_f32 v23, v23, v102
    v_exp_f32 v23, v23
    v_cvt_pk_bf16_f32 v46, v18, v19
    v_cvt_pk_bf16_f32 v47, v20, v21
    v_sub_f32 v24, v24, v102
    v_exp_f32 v24, v24
    v_sub_f32 v25, v25, v102
    v_exp_f32 v25, v25
    v_cvt_pk_bf16_f32 v48, v22, v23
    v_cvt_pk_bf16_f32 v49, v24, v25
    v_sub_f32 v26, v26, v102
    v_exp_f32 v26, v26
    v_sub_f32 v27, v27, v102
    v_exp_f32 v27, v27
    v_mfma_f32_32x32x16_bf16 a[96:111], a[84:87], v[46:49], a[96:111]
    v_sub_f32 v28, v28, v102
    v_exp_f32 v28, v28
    v_sub_f32 v29, v29, v102
    v_exp_f32 v29, v29
    v_sub_f32 v30, v30, v102
    v_exp_f32 v30, v30
    s_setprio 1
    v_sub_f32 v31, v31, v102
    v_exp_f32 v31, v31
    v_sub_f32 v32, v32, v102
    v_exp_f32 v32, v32
    v_sub_f32 v33, v33, v102
    v_exp_f32 v33, v33
    ds_read_b128 v[78:81], v104
    ds_read_b128 v[82:85], v104 offset:16
    v_add_u32 v104, 1024, v104
    s_waitcnt lgkmcnt(0)
    v_max3_f32 v78, v78, v79, v80
    v_max3_f32 v81, v81, v82, v83
    v_max3_f32 v78, v78, v84, v85
    v_max_f32 v103, v78, v81
    s_waitcnt lgkmcnt(0)
    v_mfma_f32_32x32x16_bf16 v[10:25], a[0:3], v[50:53], 0
    v_cvt_pk_bf16_f32 v42, v26, v27
    v_cvt_pk_bf16_f32 v43, v28, v29
    v_cvt_pk_bf16_f32 v44, v30, v31
    v_cvt_pk_bf16_f32 v45, v32, v33
    v_sub_f32 v34, v34, v102
    v_exp_f32 v34, v34
    v_sub_f32 v35, v35, v102
    v_exp_f32 v35, v35
    v_sub_f32 v36, v36, v102
    v_exp_f32 v36, v36
    v_sub_f32 v37, v37, v102
    v_exp_f32 v37, v37
    s_waitcnt vmcnt(0)
    v_mfma_f32_32x32x16_bf16 a[96:111], a[88:91], v[42:45], a[96:111]
    v_sub_f32 v38, v38, v102
    v_exp_f32 v38, v38
    v_sub_f32 v39, v39, v102
    v_exp_f32 v39, v39
    v_cvt_pk_bf16_f32 v46, v34, v35
    v_cvt_pk_bf16_f32 v47, v36, v37
    v_sub_f32 v40, v40, v102
    v_exp_f32 v40, v40
    v_sub_f32 v41, v41, v102
    v_exp_f32 v41, v41
    v_cvt_pk_bf16_f32 v48, v38, v39
    v_cvt_pk_bf16_f32 v49, v40, v41
    v_mov_b32 v102, v103
    v_sub_f32 v10, v10, v102
    v_exp_f32 v10, v10
    v_sub_f32 v11, v11, v102
    v_exp_f32 v11, v11
    v_mfma_f32_32x32x16_bf16 a[96:111], a[92:95], v[46:49], a[96:111]
    s_cbranch_vccz .nr_fused_kernel_107
.loop_fused_kernel_101:
    v_sub_f32 v12, v12, v102
    v_exp_f32 v12, v12
    v_sub_f32 v13, v13, v102
    v_exp_f32 v13, v13
    v_sub_f32 v14, v14, v102
    v_exp_f32 v14, v14
    v_sub_f32 v15, v15, v102
    v_exp_f32 v15, v15
    v_sub_f32 v16, v16, v102
    v_exp_f32 v16, v16
    v_sub_f32 v17, v17, v102
    v_exp_f32 v17, v17
    v_mfma_f32_32x32x16_bf16 v[26:41], a[4:7], v[50:53], 0
    v_cvt_pk_bf16_f32 v42, v10, v11
    v_cvt_pk_bf16_f32 v43, v12, v13
    v_cvt_pk_bf16_f32 v44, v14, v15
    v_cvt_pk_bf16_f32 v45, v16, v17
    v_sub_f32 v18, v18, v102
    v_exp_f32 v18, v18
    v_sub_f32 v19, v19, v102
    v_exp_f32 v19, v19
    v_sub_f32 v20, v20, v102
    v_exp_f32 v20, v20
    v_sub_f32 v21, v21, v102
    v_exp_f32 v21, v21
    ds_write_b128 v2, a[96:99] offset:0
    ds_write_b128 v2, a[100:103] offset:1024
    ds_write_b32 v3, a104 offset:16384
    v_mfma_f32_32x32x16_bf16 a[96:111], a[32:35], v[42:45], 0
    v_xor_b32 v2, 32768, v2
    v_xor_b32 v3, 32768, v3
    s_setprio 0
    v_sub_f32 v22, v22, v102
    v_exp_f32 v22, v22
    v_sub_f32 v23, v23, v102
    v_exp_f32 v23, v23
    v_cvt_pk_bf16_f32 v46, v18, v19
    v_cvt_pk_bf16_f32 v47, v20, v21
    v_sub_f32 v24, v24, v102
    v_exp_f32 v24, v24
    v_sub_f32 v25, v25, v102
    v_exp_f32 v25, v25
    v_cvt_pk_bf16_f32 v48, v22, v23
    v_cvt_pk_bf16_f32 v49, v24, v25
    v_sub_f32 v26, v26, v102
    v_exp_f32 v26, v26
    v_sub_f32 v27, v27, v102
    v_exp_f32 v27, v27
    v_mfma_f32_32x32x16_bf16 a[96:111], a[36:39], v[46:49], a[96:111]
    v_sub_f32 v28, v28, v102
    v_exp_f32 v28, v28
    v_sub_f32 v29, v29, v102
    v_exp_f32 v29, v29
    v_sub_f32 v30, v30, v102
    v_exp_f32 v30, v30
    s_waitcnt lgkmcnt(0)
    s_barrier
    ds_read_b128 v[94:97], v7 offset:17408
    ds_read_b128 v[98:101], v7 offset:17920
    v_xor_b32 v7, 32768, v7
    v_sub_f32 v31, v31, v102
    v_exp_f32 v31, v31
    v_sub_f32 v32, v32, v102
    v_exp_f32 v32, v32
    v_sub_f32 v33, v33, v102
    v_exp_f32 v33, v33
    v_mfma_f32_32x32x16_bf16 v[10:25], a[8:11], v[50:53], 0
    v_cvt_pk_bf16_f32 v42, v26, v27
    v_cvt_pk_bf16_f32 v43, v28, v29
    v_cvt_pk_bf16_f32 v44, v30, v31
    v_cvt_pk_bf16_f32 v45, v32, v33
    v_sub_f32 v34, v34, v102
    v_exp_f32 v34, v34
    v_sub_f32 v35, v35, v102
    v_exp_f32 v35, v35
    v_sub_f32 v36, v36, v102
    v_exp_f32 v36, v36
    v_sub_f32 v37, v37, v102
    v_exp_f32 v37, v37
    v_mfma_f32_32x32x16_bf16 a[96:111], a[40:43], v[42:45], a[96:111]
    v_sub_f32 v38, v38, v102
    v_exp_f32 v38, v38
    v_sub_f32 v39, v39, v102
    v_exp_f32 v39, v39
    v_cvt_pk_bf16_f32 v46, v34, v35
    v_cvt_pk_bf16_f32 v47, v36, v37
    v_sub_f32 v40, v40, v102
    v_exp_f32 v40, v40
    v_sub_f32 v41, v41, v102
    v_exp_f32 v41, v41
    v_cvt_pk_bf16_f32 v48, v38, v39
    v_cvt_pk_bf16_f32 v49, v40, v41
    v_sub_f32 v10, v10, v102
    v_exp_f32 v10, v10
    v_sub_f32 v11, v11, v102
    v_exp_f32 v11, v11
    v_mfma_f32_32x32x16_bf16 a[96:111], a[44:47], v[46:49], a[96:111]
    v_sub_f32 v12, v12, v102
    v_exp_f32 v12, v12
    v_sub_f32 v13, v13, v102
    v_exp_f32 v13, v13
    v_sub_f32 v14, v14, v102
    v_exp_f32 v14, v14
    v_sub_f32 v15, v15, v102
    v_exp_f32 v15, v15
    v_sub_f32 v16, v16, v102
    v_exp_f32 v16, v16
    v_sub_f32 v17, v17, v102
    v_exp_f32 v17, v17
    v_mfma_f32_32x32x16_bf16 v[26:41], a[12:15], v[50:53], 0
    ds_read_b64 v[70:71], v4 offset:0
    s_setprio 3
    v_cvt_pk_bf16_f32 v42, v10, v11
    v_cvt_pk_bf16_f32 v43, v12, v13
    v_cvt_pk_bf16_f32 v44, v14, v15
    v_cvt_pk_bf16_f32 v45, v16, v17
    v_sub_f32 v18, v18, v102
    v_exp_f32 v18, v18
    v_sub_f32 v19, v19, v102
    v_exp_f32 v19, v19
    v_sub_f32 v20, v20, v102
    v_exp_f32 v20, v20
    v_sub_f32 v21, v21, v102
    v_exp_f32 v21, v21
    v_mfma_f32_32x32x16_bf16 a[96:111], a[48:51], v[42:45], a[96:111]
    ds_read_b64 v[72:73], v4 offset:2048
    v_sub_f32 v22, v22, v102
    v_exp_f32 v22, v22
    v_sub_f32 v23, v23, v102
    v_exp_f32 v23, v23
    v_cvt_pk_bf16_f32 v46, v18, v19
    v_cvt_pk_bf16_f32 v47, v20, v21
    ds_read_b64 v[74:75], v4 offset:4096
    v_sub_f32 v24, v24, v102
    v_exp_f32 v24, v24
    v_sub_f32 v25, v25, v102
    v_exp_f32 v25, v25
    v_cvt_pk_bf16_f32 v48, v22, v23
    v_cvt_pk_bf16_f32 v49, v24, v25
    v_sub_f32 v26, v26, v102
    v_exp_f32 v26, v26
    v_sub_f32 v27, v27, v102
    v_exp_f32 v27, v27
    v_mfma_f32_32x32x16_bf16 a[96:111], a[52:55], v[46:49], a[96:111]
    ds_read_b64 v[76:77], v4 offset:6144
    v_sub_f32 v28, v28, v102
    v_exp_f32 v28, v28
    v_sub_f32 v29, v29, v102
    v_exp_f32 v29, v29
    v_sub_f32 v30, v30, v102
    v_exp_f32 v30, v30
    s_waitcnt lgkmcnt(4)
    s_waitcnt vmcnt(7)
    v_mfma_f32_16x16x32_bf16 v[54:57], a[112:115], v[94:97], v[54:57]
    buffer_load_dwordx4 a[112:115], v1, s[8:11], s17 offen offset:0 sc1
    v_sub_f32 v31, v31, v102
    v_exp_f32 v31, v31
    v_sub_f32 v32, v32, v102
    v_exp_f32 v32, v32
    v_sub_f32 v33, v33, v102
    v_exp_f32 v33, v33
    v_mfma_f32_32x32x16_bf16 v[10:25], a[16:19], v[50:53], 0
    ds_read_b64 v[78:79], v4 offset:8192
    v_cvt_pk_bf16_f32 v42, v26, v27
    v_cvt_pk_bf16_f32 v43, v28, v29
    v_cvt_pk_bf16_f32 v44, v30, v31
    v_cvt_pk_bf16_f32 v45, v32, v33
    v_sub_f32 v34, v34, v102
    v_exp_f32 v34, v34
    v_sub_f32 v35, v35, v102
    v_exp_f32 v35, v35
    v_sub_f32 v36, v36, v102
    v_exp_f32 v36, v36
    v_sub_f32 v37, v37, v102
    v_exp_f32 v37, v37
    v_mfma_f32_32x32x16_bf16 a[96:111], a[56:59], v[42:45], a[96:111]
    ds_read_b64 v[80:81], v4 offset:10240
    v_sub_f32 v38, v38, v102
    v_exp_f32 v38, v38
    v_sub_f32 v39, v39, v102
    v_exp_f32 v39, v39
    v_cvt_pk_bf16_f32 v46, v34, v35
    v_cvt_pk_bf16_f32 v47, v36, v37
    s_waitcnt vmcnt(7)
    v_mfma_f32_16x16x32_bf16 v[58:61], a[116:119], v[94:97], v[58:61]
    buffer_load_dwordx4 a[116:119], v1, s[8:11], s17 offen offset:1024 sc1
    v_sub_f32 v40, v40, v102
    v_exp_f32 v40, v40
    v_sub_f32 v41, v41, v102
    v_exp_f32 v41, v41
    v_cvt_pk_bf16_f32 v48, v38, v39
    v_cvt_pk_bf16_f32 v49, v40, v41
    v_sub_f32 v10, v10, v102
    v_exp_f32 v10, v10
    v_sub_f32 v11, v11, v102
    v_exp_f32 v11, v11
    v_mfma_f32_32x32x16_bf16 a[96:111], a[60:63], v[46:49], a[96:111]
    ds_read_b64 v[82:83], v4 offset:12288
    v_sub_f32 v12, v12, v102
    v_exp_f32 v12, v12
    v_sub_f32 v13, v13, v102
    v_exp_f32 v13, v13
    v_sub_f32 v14, v14, v102
    v_exp_f32 v14, v14
    s_waitcnt vmcnt(7)
    v_mfma_f32_16x16x32_bf16 v[62:65], a[120:123], v[94:97], v[62:65]
    buffer_load_dwordx4 a[120:123], v1, s[8:11], s17 offen offset:2048 sc1
    v_sub_f32 v15, v15, v102
    v_exp_f32 v15, v15
    v_sub_f32 v16, v16, v102
    v_exp_f32 v16, v16
    v_sub_f32 v17, v17, v102
    v_exp_f32 v17, v17
    v_mfma_f32_32x32x16_bf16 v[26:41], a[20:23], v[50:53], 0
    ds_read_b64 v[84:85], v4 offset:14336
    v_cvt_pk_bf16_f32 v42, v10, v11
    v_cvt_pk_bf16_f32 v43, v12, v13
    v_cvt_pk_bf16_f32 v44, v14, v15
    v_cvt_pk_bf16_f32 v45, v16, v17
    v_sub_f32 v18, v18, v102
    v_exp_f32 v18, v18
    v_sub_f32 v19, v19, v102
    v_exp_f32 v19, v19
    v_sub_f32 v20, v20, v102
    v_exp_f32 v20, v20
    v_sub_f32 v21, v21, v102
    v_exp_f32 v21, v21
    v_mfma_f32_32x32x16_bf16 a[96:111], a[64:67], v[42:45], a[96:111]
    ds_read_b128 v[86:89], v5 offset:16384
    v_sub_f32 v22, v22, v102
    v_exp_f32 v22, v22
    v_sub_f32 v23, v23, v102
    v_exp_f32 v23, v23
    v_cvt_pk_bf16_f32 v46, v18, v19
    v_cvt_pk_bf16_f32 v47, v20, v21
    s_waitcnt vmcnt(7)
    v_mfma_f32_16x16x32_bf16 v[66:69], a[124:127], v[94:97], v[66:69]
    buffer_load_dwordx4 a[124:127], v1, s[8:11], s17 offen offset:3072 sc1
    v_sub_f32 v24, v24, v102
    v_exp_f32 v24, v24
    v_sub_f32 v25, v25, v102
    v_exp_f32 v25, v25
    v_cvt_pk_bf16_f32 v48, v22, v23
    v_cvt_pk_bf16_f32 v49, v24, v25
    v_sub_f32 v26, v26, v102
    v_exp_f32 v26, v26
    v_sub_f32 v27, v27, v102
    v_exp_f32 v27, v27
    v_mfma_f32_32x32x16_bf16 a[96:111], a[68:71], v[46:49], a[96:111]
    ds_read_b128 v[90:93], v5 offset:16400
    v_sub_f32 v28, v28, v102
    v_exp_f32 v28, v28
    v_sub_f32 v29, v29, v102
    v_exp_f32 v29, v29
    v_sub_f32 v30, v30, v102
    v_exp_f32 v30, v30
    s_waitcnt vmcnt(7)
    v_mfma_f32_16x16x32_bf16 v[54:57], a[128:131], v[98:101], v[54:57]
    buffer_load_dwordx4 a[128:131], v1, s[8:11], s18 offen offset:0 sc1
    s_setprio 2
    v_sub_f32 v31, v31, v102
    v_exp_f32 v31, v31
    v_sub_f32 v32, v32, v102
    v_exp_f32 v32, v32
    v_sub_f32 v33, v33, v102
    v_exp_f32 v33, v33
    v_mfma_f32_32x32x16_bf16 v[10:25], a[24:27], v[50:53], 0
    s_waitcnt lgkmcnt(0)
    v_pk_add_f32 v[86:87], v[86:87], v[88:89]
    v_pk_add_f32 v[90:91], v[90:91], v[92:93]
    v_pk_add_f32 v[70:71], v[70:71], v[72:73]
    v_pk_add_f32 v[86:87], v[86:87], v[90:91]
    v_pk_add_f32 v[74:75], v[74:75], v[76:77]
    v_pk_add_f32 v[78:79], v[78:79], v[80:81]
    v_add_f32 v86, v86, v87
    v_pk_add_f32 v[82:83], v[82:83], v[84:85]
    v_rcp_f32 v87, v86
    v_cvt_pk_bf16_f32 v42, v26, v27
    v_cvt_pk_bf16_f32 v43, v28, v29
    v_cvt_pk_bf16_f32 v44, v30, v31
    v_cvt_pk_bf16_f32 v45, v32, v33
    v_sub_f32 v34, v34, v102
    v_exp_f32 v34, v34
    v_sub_f32 v35, v35, v102
    v_exp_f32 v35, v35
    v_sub_f32 v36, v36, v102
    v_exp_f32 v36, v36
    v_sub_f32 v37, v37, v102
    v_exp_f32 v37, v37
    v_mfma_f32_32x32x16_bf16 a[96:111], a[72:75], v[42:45], a[96:111]
    v_sub_f32 v38, v38, v102
    v_exp_f32 v38, v38
    v_sub_f32 v39, v39, v102
    v_exp_f32 v39, v39
    v_cvt_pk_bf16_f32 v46, v34, v35
    v_cvt_pk_bf16_f32 v47, v36, v37
    s_waitcnt vmcnt(7)
    v_mfma_f32_16x16x32_bf16 v[58:61], a[132:135], v[98:101], v[58:61]
    buffer_load_dwordx4 a[132:135], v1, s[8:11], s18 offen offset:1024 sc1
    v_sub_f32 v40, v40, v102
    v_exp_f32 v40, v40
    v_sub_f32 v41, v41, v102
    v_exp_f32 v41, v41
    v_cvt_pk_bf16_f32 v48, v38, v39
    v_cvt_pk_bf16_f32 v49, v40, v41
    v_sub_f32 v10, v10, v102
    v_exp_f32 v10, v10
    v_sub_f32 v11, v11, v102
    v_exp_f32 v11, v11
    v_mfma_f32_32x32x16_bf16 a[96:111], a[76:79], v[46:49], a[96:111]
    v_pk_add_f32 v[70:71], v[70:71], v[74:75]
    v_pk_add_f32 v[78:79], v[78:79], v[82:83]
    v_pk_add_f32 v[70:71], v[70:71], v[78:79]
    v_pk_mul_f32 v[70:71], v[70:71], v[86:87] op_sel:[0,1] op_sel_hi:[1,1]
    v_xor_b32 v4, 32768, v4
    v_xor_b32 v5, 32768, v5
    v_cvt_pk_bf16_f32 v70, v70, v71
    ds_write_b32 v6, v70 offset:17408
    v_xor_b32 v6, 32768, v6
    v_sub_f32 v12, v12, v102
    v_exp_f32 v12, v12
    v_sub_f32 v13, v13, v102
    v_exp_f32 v13, v13
    v_sub_f32 v14, v14, v102
    v_exp_f32 v14, v14
    s_waitcnt vmcnt(7)
    v_mfma_f32_16x16x32_bf16 v[62:65], a[136:139], v[98:101], v[62:65]
    buffer_load_dwordx4 a[136:139], v1, s[8:11], s18 offen offset:2048 sc1
    v_sub_f32 v15, v15, v102
    v_exp_f32 v15, v15
    v_sub_f32 v16, v16, v102
    v_exp_f32 v16, v16
    v_sub_f32 v17, v17, v102
    v_exp_f32 v17, v17
    v_mfma_f32_32x32x16_bf16 v[26:41], a[28:31], v[50:53], 0
    ds_read_b128 v[50:53], v8
    v_add_u32 v8, 1024, v8
    v_cvt_pk_bf16_f32 v42, v10, v11
    v_cvt_pk_bf16_f32 v43, v12, v13
    v_cvt_pk_bf16_f32 v44, v14, v15
    v_cvt_pk_bf16_f32 v45, v16, v17
    v_sub_f32 v18, v18, v102
    v_exp_f32 v18, v18
    v_sub_f32 v19, v19, v102
    v_exp_f32 v19, v19
    v_sub_f32 v20, v20, v102
    v_exp_f32 v20, v20
    v_sub_f32 v21, v21, v102
    v_exp_f32 v21, v21
    v_mfma_f32_32x32x16_bf16 a[96:111], a[80:83], v[42:45], a[96:111]
    v_sub_f32 v22, v22, v102
    v_exp_f32 v22, v22
    v_sub_f32 v23, v23, v102
    v_exp_f32 v23, v23
    v_cvt_pk_bf16_f32 v46, v18, v19
    v_cvt_pk_bf16_f32 v47, v20, v21
    s_waitcnt vmcnt(7)
    v_mfma_f32_16x16x32_bf16 v[66:69], a[140:143], v[98:101], v[66:69]
    buffer_load_dwordx4 a[140:143], v1, s[8:11], s18 offen offset:3072 sc1
    v_sub_f32 v24, v24, v102
    v_exp_f32 v24, v24
    v_sub_f32 v25, v25, v102
    v_exp_f32 v25, v25
    v_cvt_pk_bf16_f32 v48, v22, v23
    v_cvt_pk_bf16_f32 v49, v24, v25
    v_sub_f32 v26, v26, v102
    v_exp_f32 v26, v26
    v_sub_f32 v27, v27, v102
    v_exp_f32 v27, v27
    v_mfma_f32_32x32x16_bf16 a[96:111], a[84:87], v[46:49], a[96:111]
    v_sub_f32 v28, v28, v102
    v_exp_f32 v28, v28
    v_sub_f32 v29, v29, v102
    v_exp_f32 v29, v29
    v_sub_f32 v30, v30, v102
    v_exp_f32 v30, v30
    s_add_u32 s17, s17, 65536
    s_bitset0_b32 s17, 19
    s_add_u32 s18, s17, 32768
    s_cmp_eq_u32 s16, 7
    s_cbranch_scc1 .w7_fused_kernel_103
.w7r_fused_kernel_105:
    s_setprio 1
    v_sub_f32 v31, v31, v102
    v_exp_f32 v31, v31
    v_sub_f32 v32, v32, v102
    v_exp_f32 v32, v32
    v_sub_f32 v33, v33, v102
    v_exp_f32 v33, v33
    ds_read_b128 v[78:81], v104
    ds_read_b128 v[82:85], v104 offset:16
    v_add_u32 v104, 1024, v104
    s_waitcnt lgkmcnt(0)
    v_max3_f32 v78, v78, v79, v80
    v_max3_f32 v81, v81, v82, v83
    v_max3_f32 v78, v78, v84, v85
    v_max_f32 v103, v78, v81
    s_waitcnt lgkmcnt(0)
    v_mfma_f32_32x32x16_bf16 v[10:25], a[0:3], v[50:53], 0
    v_cvt_pk_bf16_f32 v42, v26, v27
    v_cvt_pk_bf16_f32 v43, v28, v29
    v_cvt_pk_bf16_f32 v44, v30, v31
    v_cvt_pk_bf16_f32 v45, v32, v33
    v_sub_f32 v34, v34, v102
    v_exp_f32 v34, v34
    v_sub_f32 v35, v35, v102
    v_exp_f32 v35, v35
    v_sub_f32 v36, v36, v102
    v_exp_f32 v36, v36
    v_sub_f32 v37, v37, v102
    v_exp_f32 v37, v37
    v_mfma_f32_32x32x16_bf16 a[96:111], a[88:91], v[42:45], a[96:111]
    v_sub_f32 v38, v38, v102
    v_exp_f32 v38, v38
    v_sub_f32 v39, v39, v102
    v_exp_f32 v39, v39
    v_cvt_pk_bf16_f32 v46, v34, v35
    v_cvt_pk_bf16_f32 v47, v36, v37
    v_sub_f32 v40, v40, v102
    v_exp_f32 v40, v40
    v_sub_f32 v41, v41, v102
    v_exp_f32 v41, v41
    v_cvt_pk_bf16_f32 v48, v38, v39
    v_cvt_pk_bf16_f32 v49, v40, v41
    v_mov_b32 v102, v103
    v_sub_f32 v10, v10, v102
    v_exp_f32 v10, v10
    v_sub_f32 v11, v11, v102
    v_exp_f32 v11, v11
    v_mfma_f32_32x32x16_bf16 a[96:111], a[92:95], v[46:49], a[96:111]
    s_add_u32 s16, s16, 1
    s_cmp_lt_u32 s16, 8
    s_cbranch_scc1 .loop_fused_kernel_101
    s_branch .tail_fused_kernel_106
.nr_fused_kernel_107:
.loop_fused_kernel_100:
    v_sub_f32 v12, v12, v102
    v_exp_f32 v12, v12
    v_sub_f32 v13, v13, v102
    v_exp_f32 v13, v13
    v_sub_f32 v14, v14, v102
    v_exp_f32 v14, v14
    v_sub_f32 v15, v15, v102
    v_exp_f32 v15, v15
    v_sub_f32 v16, v16, v102
    v_exp_f32 v16, v16
    v_sub_f32 v17, v17, v102
    v_exp_f32 v17, v17
    v_mfma_f32_32x32x16_bf16 v[26:41], a[4:7], v[50:53], 0
    v_cvt_pk_bf16_f32 v42, v10, v11
    v_cvt_pk_bf16_f32 v43, v12, v13
    v_cvt_pk_bf16_f32 v44, v14, v15
    v_cvt_pk_bf16_f32 v45, v16, v17
    v_sub_f32 v18, v18, v102
    v_exp_f32 v18, v18
    v_sub_f32 v19, v19, v102
    v_exp_f32 v19, v19
    v_sub_f32 v20, v20, v102
    v_exp_f32 v20, v20
    v_sub_f32 v21, v21, v102
    v_exp_f32 v21, v21
    ds_write_b128 v2, a[96:99] offset:0
    ds_write_b128 v2, a[100:103] offset:1024
    ds_write_b32 v3, a104 offset:16384
    v_mfma_f32_32x32x16_bf16 a[96:111], a[32:35], v[42:45], 0
    v_xor_b32 v2, 32768, v2
    v_xor_b32 v3, 32768, v3
    s_setprio 0
    v_sub_f32 v22, v22, v102
    v_exp_f32 v22, v22
    v_sub_f32 v23, v23, v102
    v_exp_f32 v23, v23
    v_cvt_pk_bf16_f32 v46, v18, v19
    v_cvt_pk_bf16_f32 v47, v20, v21
    v_sub_f32 v24, v24, v102
    v_exp_f32 v24, v24
    v_sub_f32 v25, v25, v102
    v_exp_f32 v25, v25
    v_cvt_pk_bf16_f32 v48, v22, v23
    v_cvt_pk_bf16_f32 v49, v24, v25
    v_sub_f32 v26, v26, v102
    v_exp_f32 v26, v26
    v_sub_f32 v27, v27, v102
    v_exp_f32 v27, v27
    v_mfma_f32_32x32x16_bf16 a[96:111], a[36:39], v[46:49], a[96:111]
    v_sub_f32 v28, v28, v102
    v_exp_f32 v28, v28
    v_sub_f32 v29, v29, v102
    v_exp_f32 v29, v29
    v_sub_f32 v30, v30, v102
    v_exp_f32 v30, v30
    s_waitcnt lgkmcnt(0)
    s_barrier
    ds_read_b128 v[94:97], v7 offset:17408
    ds_read_b128 v[98:101], v7 offset:17920
    v_xor_b32 v7, 32768, v7
    v_sub_f32 v31, v31, v102
    v_exp_f32 v31, v31
    v_sub_f32 v32, v32, v102
    v_exp_f32 v32, v32
    v_sub_f32 v33, v33, v102
    v_exp_f32 v33, v33
    v_mfma_f32_32x32x16_bf16 v[10:25], a[8:11], v[50:53], 0
    v_cvt_pk_bf16_f32 v42, v26, v27
    v_cvt_pk_bf16_f32 v43, v28, v29
    v_cvt_pk_bf16_f32 v44, v30, v31
    v_cvt_pk_bf16_f32 v45, v32, v33
    v_sub_f32 v34, v34, v102
    v_exp_f32 v34, v34
    v_sub_f32 v35, v35, v102
    v_exp_f32 v35, v35
    v_sub_f32 v36, v36, v102
    v_exp_f32 v36, v36
    v_sub_f32 v37, v37, v102
    v_exp_f32 v37, v37
    v_mfma_f32_32x32x16_bf16 a[96:111], a[40:43], v[42:45], a[96:111]
    v_sub_f32 v38, v38, v102
    v_exp_f32 v38, v38
    v_sub_f32 v39, v39, v102
    v_exp_f32 v39, v39
    v_cvt_pk_bf16_f32 v46, v34, v35
    v_cvt_pk_bf16_f32 v47, v36, v37
    v_sub_f32 v40, v40, v102
    v_exp_f32 v40, v40
    v_sub_f32 v41, v41, v102
    v_exp_f32 v41, v41
    v_cvt_pk_bf16_f32 v48, v38, v39
    v_cvt_pk_bf16_f32 v49, v40, v41
    v_sub_f32 v10, v10, v102
    v_exp_f32 v10, v10
    v_sub_f32 v11, v11, v102
    v_exp_f32 v11, v11
    v_mfma_f32_32x32x16_bf16 a[96:111], a[44:47], v[46:49], a[96:111]
    v_sub_f32 v12, v12, v102
    v_exp_f32 v12, v12
    v_sub_f32 v13, v13, v102
    v_exp_f32 v13, v13
    v_sub_f32 v14, v14, v102
    v_exp_f32 v14, v14
    v_sub_f32 v15, v15, v102
    v_exp_f32 v15, v15
    v_sub_f32 v16, v16, v102
    v_exp_f32 v16, v16
    v_sub_f32 v17, v17, v102
    v_exp_f32 v17, v17
    v_mfma_f32_32x32x16_bf16 v[26:41], a[12:15], v[50:53], 0
    s_setprio 3
    v_cvt_pk_bf16_f32 v42, v10, v11
    v_cvt_pk_bf16_f32 v43, v12, v13
    v_cvt_pk_bf16_f32 v44, v14, v15
    v_cvt_pk_bf16_f32 v45, v16, v17
    v_sub_f32 v18, v18, v102
    v_exp_f32 v18, v18
    v_sub_f32 v19, v19, v102
    v_exp_f32 v19, v19
    v_sub_f32 v20, v20, v102
    v_exp_f32 v20, v20
    v_sub_f32 v21, v21, v102
    v_exp_f32 v21, v21
    v_mfma_f32_32x32x16_bf16 a[96:111], a[48:51], v[42:45], a[96:111]
    v_sub_f32 v22, v22, v102
    v_exp_f32 v22, v22
    v_sub_f32 v23, v23, v102
    v_exp_f32 v23, v23
    v_cvt_pk_bf16_f32 v46, v18, v19
    v_cvt_pk_bf16_f32 v47, v20, v21
    v_sub_f32 v24, v24, v102
    v_exp_f32 v24, v24
    v_sub_f32 v25, v25, v102
    v_exp_f32 v25, v25
    v_cvt_pk_bf16_f32 v48, v22, v23
    v_cvt_pk_bf16_f32 v49, v24, v25
    v_sub_f32 v26, v26, v102
    v_exp_f32 v26, v26
    v_sub_f32 v27, v27, v102
    v_exp_f32 v27, v27
    v_mfma_f32_32x32x16_bf16 a[96:111], a[52:55], v[46:49], a[96:111]
    v_sub_f32 v28, v28, v102
    v_exp_f32 v28, v28
    v_sub_f32 v29, v29, v102
    v_exp_f32 v29, v29
    v_sub_f32 v30, v30, v102
    v_exp_f32 v30, v30
    s_waitcnt lgkmcnt(0)
    s_waitcnt vmcnt(7)
    v_mfma_f32_16x16x32_bf16 v[54:57], a[112:115], v[94:97], v[54:57]
    buffer_load_dwordx4 a[112:115], v1, s[8:11], s17 offen offset:0 sc1
    v_sub_f32 v31, v31, v102
    v_exp_f32 v31, v31
    v_sub_f32 v32, v32, v102
    v_exp_f32 v32, v32
    v_sub_f32 v33, v33, v102
    v_exp_f32 v33, v33
    v_mfma_f32_32x32x16_bf16 v[10:25], a[16:19], v[50:53], 0
    v_cvt_pk_bf16_f32 v42, v26, v27
    v_cvt_pk_bf16_f32 v43, v28, v29
    v_cvt_pk_bf16_f32 v44, v30, v31
    v_cvt_pk_bf16_f32 v45, v32, v33
    v_sub_f32 v34, v34, v102
    v_exp_f32 v34, v34
    v_sub_f32 v35, v35, v102
    v_exp_f32 v35, v35
    v_sub_f32 v36, v36, v102
    v_exp_f32 v36, v36
    v_sub_f32 v37, v37, v102
    v_exp_f32 v37, v37
    v_mfma_f32_32x32x16_bf16 a[96:111], a[56:59], v[42:45], a[96:111]
    v_sub_f32 v38, v38, v102
    v_exp_f32 v38, v38
    v_sub_f32 v39, v39, v102
    v_exp_f32 v39, v39
    v_cvt_pk_bf16_f32 v46, v34, v35
    v_cvt_pk_bf16_f32 v47, v36, v37
    s_waitcnt vmcnt(7)
    v_mfma_f32_16x16x32_bf16 v[58:61], a[116:119], v[94:97], v[58:61]
    buffer_load_dwordx4 a[116:119], v1, s[8:11], s17 offen offset:1024 sc1
    v_sub_f32 v40, v40, v102
    v_exp_f32 v40, v40
    v_sub_f32 v41, v41, v102
    v_exp_f32 v41, v41
    v_cvt_pk_bf16_f32 v48, v38, v39
    v_cvt_pk_bf16_f32 v49, v40, v41
    v_sub_f32 v10, v10, v102
    v_exp_f32 v10, v10
    v_sub_f32 v11, v11, v102
    v_exp_f32 v11, v11
    v_mfma_f32_32x32x16_bf16 a[96:111], a[60:63], v[46:49], a[96:111]
    v_sub_f32 v12, v12, v102
    v_exp_f32 v12, v12
    v_sub_f32 v13, v13, v102
    v_exp_f32 v13, v13
    v_sub_f32 v14, v14, v102
    v_exp_f32 v14, v14
    s_waitcnt vmcnt(7)
    v_mfma_f32_16x16x32_bf16 v[62:65], a[120:123], v[94:97], v[62:65]
    buffer_load_dwordx4 a[120:123], v1, s[8:11], s17 offen offset:2048 sc1
    v_sub_f32 v15, v15, v102
    v_exp_f32 v15, v15
    v_sub_f32 v16, v16, v102
    v_exp_f32 v16, v16
    v_sub_f32 v17, v17, v102
    v_exp_f32 v17, v17
    v_mfma_f32_32x32x16_bf16 v[26:41], a[20:23], v[50:53], 0
    v_cvt_pk_bf16_f32 v42, v10, v11
    v_cvt_pk_bf16_f32 v43, v12, v13
    v_cvt_pk_bf16_f32 v44, v14, v15
    v_cvt_pk_bf16_f32 v45, v16, v17
    v_sub_f32 v18, v18, v102
    v_exp_f32 v18, v18
    v_sub_f32 v19, v19, v102
    v_exp_f32 v19, v19
    v_sub_f32 v20, v20, v102
    v_exp_f32 v20, v20
    v_sub_f32 v21, v21, v102
    v_exp_f32 v21, v21
    v_mfma_f32_32x32x16_bf16 a[96:111], a[64:67], v[42:45], a[96:111]
    v_sub_f32 v22, v22, v102
    v_exp_f32 v22, v22
    v_sub_f32 v23, v23, v102
    v_exp_f32 v23, v23
    v_cvt_pk_bf16_f32 v46, v18, v19
    v_cvt_pk_bf16_f32 v47, v20, v21
    s_waitcnt vmcnt(7)
    v_mfma_f32_16x16x32_bf16 v[66:69], a[124:127], v[94:97], v[66:69]
    buffer_load_dwordx4 a[124:127], v1, s[8:11], s17 offen offset:3072 sc1
    v_sub_f32 v24, v24, v102
    v_exp_f32 v24, v24
    v_sub_f32 v25, v25, v102
    v_exp_f32 v25, v25
    v_cvt_pk_bf16_f32 v48, v22, v23
    v_cvt_pk_bf16_f32 v49, v24, v25
    v_sub_f32 v26, v26, v102
    v_exp_f32 v26, v26
    v_sub_f32 v27, v27, v102
    v_exp_f32 v27, v27
    v_mfma_f32_32x32x16_bf16 a[96:111], a[68:71], v[46:49], a[96:111]
    v_sub_f32 v28, v28, v102
    v_exp_f32 v28, v28
    v_sub_f32 v29, v29, v102
    v_exp_f32 v29, v29
    v_sub_f32 v30, v30, v102
    v_exp_f32 v30, v30
    s_waitcnt vmcnt(7)
    v_mfma_f32_16x16x32_bf16 v[54:57], a[128:131], v[98:101], v[54:57]
    buffer_load_dwordx4 a[128:131], v1, s[8:11], s18 offen offset:0 sc1
    s_setprio 2
    v_sub_f32 v31, v31, v102
    v_exp_f32 v31, v31
    v_sub_f32 v32, v32, v102
    v_exp_f32 v32, v32
    v_sub_f32 v33, v33, v102
    v_exp_f32 v33, v33
    v_mfma_f32_32x32x16_bf16 v[10:25], a[24:27], v[50:53], 0
    v_cvt_pk_bf16_f32 v42, v26, v27
    v_cvt_pk_bf16_f32 v43, v28, v29
    v_cvt_pk_bf16_f32 v44, v30, v31
    v_cvt_pk_bf16_f32 v45, v32, v33
    v_sub_f32 v34, v34, v102
    v_exp_f32 v34, v34
    v_sub_f32 v35, v35, v102
    v_exp_f32 v35, v35
    v_sub_f32 v36, v36, v102
    v_exp_f32 v36, v36
    v_sub_f32 v37, v37, v102
    v_exp_f32 v37, v37
    v_mfma_f32_32x32x16_bf16 a[96:111], a[72:75], v[42:45], a[96:111]
    v_sub_f32 v38, v38, v102
    v_exp_f32 v38, v38
    v_sub_f32 v39, v39, v102
    v_exp_f32 v39, v39
    v_cvt_pk_bf16_f32 v46, v34, v35
    v_cvt_pk_bf16_f32 v47, v36, v37
    s_waitcnt vmcnt(7)
    v_mfma_f32_16x16x32_bf16 v[58:61], a[132:135], v[98:101], v[58:61]
    buffer_load_dwordx4 a[132:135], v1, s[8:11], s18 offen offset:1024 sc1
    v_sub_f32 v40, v40, v102
    v_exp_f32 v40, v40
    v_sub_f32 v41, v41, v102
    v_exp_f32 v41, v41
    v_cvt_pk_bf16_f32 v48, v38, v39
    v_cvt_pk_bf16_f32 v49, v40, v41
    v_sub_f32 v10, v10, v102
    v_exp_f32 v10, v10
    v_sub_f32 v11, v11, v102
    v_exp_f32 v11, v11
    v_mfma_f32_32x32x16_bf16 a[96:111], a[76:79], v[46:49], a[96:111]
    v_sub_f32 v12, v12, v102
    v_exp_f32 v12, v12
    v_sub_f32 v13, v13, v102
    v_exp_f32 v13, v13
    v_sub_f32 v14, v14, v102
    v_exp_f32 v14, v14
    s_waitcnt vmcnt(7)
    v_mfma_f32_16x16x32_bf16 v[62:65], a[136:139], v[98:101], v[62:65]
    buffer_load_dwordx4 a[136:139], v1, s[8:11], s18 offen offset:2048 sc1
    v_sub_f32 v15, v15, v102
    v_exp_f32 v15, v15
    v_sub_f32 v16, v16, v102
    v_exp_f32 v16, v16
    v_sub_f32 v17, v17, v102
    v_exp_f32 v17, v17
    v_mfma_f32_32x32x16_bf16 v[26:41], a[28:31], v[50:53], 0
    ds_read_b128 v[50:53], v8
    v_add_u32 v8, 1024, v8
    v_cvt_pk_bf16_f32 v42, v10, v11
    v_cvt_pk_bf16_f32 v43, v12, v13
    v_cvt_pk_bf16_f32 v44, v14, v15
    v_cvt_pk_bf16_f32 v45, v16, v17
    v_sub_f32 v18, v18, v102
    v_exp_f32 v18, v18
    v_sub_f32 v19, v19, v102
    v_exp_f32 v19, v19
    v_sub_f32 v20, v20, v102
    v_exp_f32 v20, v20
    v_sub_f32 v21, v21, v102
    v_exp_f32 v21, v21
    v_mfma_f32_32x32x16_bf16 a[96:111], a[80:83], v[42:45], a[96:111]
    v_sub_f32 v22, v22, v102
    v_exp_f32 v22, v22
    v_sub_f32 v23, v23, v102
    v_exp_f32 v23, v23
    v_cvt_pk_bf16_f32 v46, v18, v19
    v_cvt_pk_bf16_f32 v47, v20, v21
    s_waitcnt vmcnt(7)
    v_mfma_f32_16x16x32_bf16 v[66:69], a[140:143], v[98:101], v[66:69]
    buffer_load_dwordx4 a[140:143], v1, s[8:11], s18 offen offset:3072 sc1
    v_sub_f32 v24, v24, v102
    v_exp_f32 v24, v24
    v_sub_f32 v25, v25, v102
    v_exp_f32 v25, v25
    v_cvt_pk_bf16_f32 v48, v22, v23
    v_cvt_pk_bf16_f32 v49, v24, v25
    v_sub_f32 v26, v26, v102
    v_exp_f32 v26, v26
    v_sub_f32 v27, v27, v102
    v_exp_f32 v27, v27
    v_mfma_f32_32x32x16_bf16 a[96:111], a[84:87], v[46:49], a[96:111]
    v_sub_f32 v28, v28, v102
    v_exp_f32 v28, v28
    v_sub_f32 v29, v29, v102
    v_exp_f32 v29, v29
    v_sub_f32 v30, v30, v102
    v_exp_f32 v30, v30
    s_add_u32 s17, s17, 65536
    s_bitset0_b32 s17, 19
    s_add_u32 s18, s17, 32768
    s_cmp_eq_u32 s16, 7
    s_cbranch_scc1 .w7_fused_kernel_102
.w7r_fused_kernel_104:
    s_setprio 1
    v_sub_f32 v31, v31, v102
    v_exp_f32 v31, v31
    v_sub_f32 v32, v32, v102
    v_exp_f32 v32, v32
    v_sub_f32 v33, v33, v102
    v_exp_f32 v33, v33
    ds_read_b128 v[78:81], v104
    ds_read_b128 v[82:85], v104 offset:16
    v_add_u32 v104, 1024, v104
    s_waitcnt lgkmcnt(0)
    v_max3_f32 v78, v78, v79, v80
    v_max3_f32 v81, v81, v82, v83
    v_max3_f32 v78, v78, v84, v85
    v_max_f32 v103, v78, v81
    s_waitcnt lgkmcnt(0)
    v_mfma_f32_32x32x16_bf16 v[10:25], a[0:3], v[50:53], 0
    v_cvt_pk_bf16_f32 v42, v26, v27
    v_cvt_pk_bf16_f32 v43, v28, v29
    v_cvt_pk_bf16_f32 v44, v30, v31
    v_cvt_pk_bf16_f32 v45, v32, v33
    v_sub_f32 v34, v34, v102
    v_exp_f32 v34, v34
    v_sub_f32 v35, v35, v102
    v_exp_f32 v35, v35
    v_sub_f32 v36, v36, v102
    v_exp_f32 v36, v36
    v_sub_f32 v37, v37, v102
    v_exp_f32 v37, v37
    v_mfma_f32_32x32x16_bf16 a[96:111], a[88:91], v[42:45], a[96:111]
    v_sub_f32 v38, v38, v102
    v_exp_f32 v38, v38
    v_sub_f32 v39, v39, v102
    v_exp_f32 v39, v39
    v_cvt_pk_bf16_f32 v46, v34, v35
    v_cvt_pk_bf16_f32 v47, v36, v37
    v_sub_f32 v40, v40, v102
    v_exp_f32 v40, v40
    v_sub_f32 v41, v41, v102
    v_exp_f32 v41, v41
    v_cvt_pk_bf16_f32 v48, v38, v39
    v_cvt_pk_bf16_f32 v49, v40, v41
    v_mov_b32 v102, v103
    v_sub_f32 v10, v10, v102
    v_exp_f32 v10, v10
    v_sub_f32 v11, v11, v102
    v_exp_f32 v11, v11
    v_mfma_f32_32x32x16_bf16 a[96:111], a[92:95], v[46:49], a[96:111]
    s_add_u32 s16, s16, 1
    s_cmp_lt_u32 s16, 8
    s_cbranch_scc1 .loop_fused_kernel_100
.tail_fused_kernel_106:
    v_and_b32 v8, 7, v0
    v_bfe_u32 v9, v0, 3, 1
    v_lshrrev_b32 v50, 4, v0
    v_lshlrev_b32 v51, 7, v8
    v_lshl_add_u32 v51, v9, 6, v51
    v_lshl_add_u32 v51, v50, 3, v51
    v_add_u32 v51, s33, v51
    v_lshlrev_b32 v52, 7, v9
    v_lshl_add_u32 v52, v50, 4, v52
    s_add_u32 s35, s33, 73728
    v_add_u32 v52, s35, v52
    ds_write_b128 v2, a[96:99] offset:0
    ds_write_b128 v2, a[100:103] offset:1024
    ds_write_b32 v3, a104 offset:16384
    ds_read_b64 v[10:11], v51 offset:20480
    ds_read_b64 v[12:13], v51 offset:20512
    ds_read_b128 v[14:17], v52
    ds_read_b128 v[18:21], v52 offset:64
    v_lshlrev_b32 v2, 11, v9
    v_lshl_add_u32 v2, v50, 9, v2
    v_lshl_add_u32 v2, v8, 4, v2
    s_bfe_u32 s33, s21, 0x30002
    s_lshl_b32 s33, s33, 15
    s_add_u32 s33, s33, s4
    s_lshl_b32 s34, s3, 12
    s_add_u32 s33, s33, s34
    s_and_b32 s34, s21, 3
    s_lshl_b32 s34, s34, 7
    s_add_u32 s33, s33, s34
    s_add_u32 s34, s33, 0
    s_add_u32 s35, s33, 1179648
    s_waitcnt lgkmcnt(0)
    s_barrier
    s_cbranch_vccz .nr_fused_kernel_108
    ds_read_b64 v[70:71], v4 offset:0
    ds_read_b64 v[72:73], v4 offset:2048
    ds_read_b64 v[74:75], v4 offset:4096
    ds_read_b64 v[76:77], v4 offset:6144
    ds_read_b64 v[78:79], v4 offset:8192
    ds_read_b64 v[80:81], v4 offset:10240
    ds_read_b64 v[82:83], v4 offset:12288
    ds_read_b64 v[84:85], v4 offset:14336
    ds_read_b128 v[86:89], v5 offset:16384
    ds_read_b128 v[90:93], v5 offset:16400
.nr_fused_kernel_108:
    ds_read_b128 v[94:97], v7 offset:17408
    ds_read_b128 v[98:101], v7 offset:17920
    v_xor_b32 v7, 32768, v7
    v_lshlrev_b32 v26, 16, v10
    v_and_b32 v27, 0xffff0000, v10
    v_lshlrev_b32 v28, 16, v11
    v_and_b32 v29, 0xffff0000, v11
    v_lshlrev_b32 v30, 16, v12
    v_and_b32 v31, 0xffff0000, v12
    v_lshlrev_b32 v32, 16, v13
    v_and_b32 v33, 0xffff0000, v13
    s_cbranch_vccz .nr_fused_kernel_109
    s_waitcnt lgkmcnt(2)
    v_pk_add_f32 v[86:87], v[86:87], v[88:89]
    v_pk_add_f32 v[90:91], v[90:91], v[92:93]
    v_pk_add_f32 v[70:71], v[70:71], v[72:73]
    v_pk_add_f32 v[86:87], v[86:87], v[90:91]
    v_pk_add_f32 v[74:75], v[74:75], v[76:77]
    v_pk_add_f32 v[78:79], v[78:79], v[80:81]
    v_add_f32 v86, v86, v87
    v_pk_add_f32 v[82:83], v[82:83], v[84:85]
    v_rcp_f32 v87, v86
    v_pk_add_f32 v[70:71], v[70:71], v[74:75]
    v_pk_add_f32 v[78:79], v[78:79], v[82:83]
    v_pk_add_f32 v[70:71], v[70:71], v[78:79]
    v_pk_mul_f32 v[70:71], v[70:71], v[86:87] op_sel:[0,1] op_sel_hi:[1,1]
    s_nop 0
    v_cvt_pk_bf16_f32 v70, v70, v71
    ds_write_b32 v6, v70 offset:17408
.nr_fused_kernel_109:
    s_waitcnt vmcnt(8) lgkmcnt(0)
    s_barrier
    ds_read_b128 v[42:45], v7 offset:17408
    ds_read_b128 v[46:49], v7 offset:17920
    v_mov_b32 v9, 0
    ds_read_b32 v9, v9 offset:30720
    ds_read_b128 v[70:73], v52 offset:256
    ds_read_b128 v[74:77], v52 offset:320
    ds_read_b128 v[78:81], v52 offset:512
    ds_read_b128 v[82:85], v52 offset:576
    v_mfma_f32_16x16x32_bf16 v[54:57], a[112:115], v[94:97], v[54:57]
    v_mfma_f32_16x16x32_bf16 v[58:61], a[116:119], v[94:97], v[58:61]
    v_mfma_f32_16x16x32_bf16 v[62:65], a[120:123], v[94:97], v[62:65]
    v_mfma_f32_16x16x32_bf16 v[66:69], a[124:127], v[94:97], v[66:69]
    v_mfma_f32_16x16x32_bf16 v[54:57], a[128:131], v[98:101], v[54:57]
    v_mfma_f32_16x16x32_bf16 v[58:61], a[132:135], v[98:101], v[58:61]
    v_mfma_f32_16x16x32_bf16 v[62:65], a[136:139], v[98:101], v[62:65]
    v_mfma_f32_16x16x32_bf16 v[66:69], a[140:143], v[98:101], v[66:69]
    s_waitcnt vmcnt(0) lgkmcnt(0)
    v_mfma_f32_16x16x32_bf16 v[54:57], a[32:35], v[42:45], v[54:57]
    v_mfma_f32_16x16x32_bf16 v[58:61], a[36:39], v[42:45], v[58:61]
    v_mfma_f32_16x16x32_bf16 v[62:65], a[40:43], v[42:45], v[62:65]
    v_mfma_f32_16x16x32_bf16 v[66:69], a[44:47], v[42:45], v[66:69]
    v_mfma_f32_16x16x32_bf16 v[54:57], a[48:51], v[46:49], v[54:57]
    v_mfma_f32_16x16x32_bf16 v[58:61], a[52:55], v[46:49], v[58:61]
    v_mfma_f32_16x16x32_bf16 v[62:65], a[56:59], v[46:49], v[62:65]
    v_mfma_f32_16x16x32_bf16 v[66:69], a[60:63], v[46:49], v[66:69]
    s_nop 6
    v_mov_b32_dpp v54, v62 quad_perm:[0,1,2,3] row_mask:0xf bank_mask:0xc
    v_mov_b32_dpp v55, v63 quad_perm:[0,1,2,3] row_mask:0xf bank_mask:0xc
    v_mov_b32_dpp v56, v64 quad_perm:[0,1,2,3] row_mask:0xf bank_mask:0xc
    v_mov_b32_dpp v57, v65 quad_perm:[0,1,2,3] row_mask:0xf bank_mask:0xc
    v_mov_b32_dpp v58, v66 quad_perm:[0,1,2,3] row_mask:0xf bank_mask:0xc
    v_mov_b32_dpp v59, v67 quad_perm:[0,1,2,3] row_mask:0xf bank_mask:0xc
    v_mov_b32_dpp v60, v68 quad_perm:[0,1,2,3] row_mask:0xf bank_mask:0xc
    v_mov_b32_dpp v61, v69 quad_perm:[0,1,2,3] row_mask:0xf bank_mask:0xc
    v_fmac_f32 v26, v14, v54
    v_fmac_f32 v27, v15, v55
    v_fmac_f32 v28, v16, v56
    v_fmac_f32 v29, v17, v57
    v_fmac_f32 v30, v18, v58
    v_fmac_f32 v31, v19, v59
    v_fmac_f32 v32, v20, v60
    v_fmac_f32 v33, v21, v61
    v_cvt_pk_bf16_f32 v10, v26, v27
    v_cvt_pk_bf16_f32 v11, v28, v29
    v_cvt_pk_bf16_f32 v12, v30, v31
    v_cvt_pk_bf16_f32 v13, v32, v33
    buffer_store_dwordx4 v[10:13], v2, s[8:11], s34 offen sc1
    v_lshlrev_b32 v26, 16, v10
    v_and_b32 v27, 0xffff0000, v10
    v_lshlrev_b32 v28, 16, v11
    v_and_b32 v29, 0xffff0000, v11
    v_lshlrev_b32 v30, 16, v12
    v_and_b32 v31, 0xffff0000, v12
    v_lshlrev_b32 v32, 16, v13
    v_and_b32 v33, 0xffff0000, v13
    v_add_f32 v34, v26, v27
    v_mul_f32 v35, v26, v26
    v_fmac_f32 v35, v27, v27
    v_add_f32 v34, v34, v28
    v_fmac_f32 v35, v28, v28
    v_add_f32 v34, v34, v29
    v_fmac_f32 v35, v29, v29
    v_add_f32 v34, v34, v30
    v_fmac_f32 v35, v30, v30
    v_add_f32 v34, v34, v31
    v_fmac_f32 v35, v31, v31
    v_add_f32 v34, v34, v32
    v_fmac_f32 v35, v32, v32
    v_add_f32 v34, v34, v33
    v_fmac_f32 v35, v33, v33
    s_nop 1
    v_permlane32_swap_b32 v34, v35
    v_add_f32 v34, v34, v35
    v_mov_b32 v35, v34
    s_nop 1
    v_permlane16_swap_b32 v34, v35
    v_add_f32 v34, v34, v35
    s_nop 1
    v_add_f32_dpp v34, v34, v34 row_ror:8 row_mask:0xf bank_mask:0xf
    v_lshrrev_b32 v35, 5, v0
    v_lshlrev_b32 v35, 8, v35
    v_lshlrev_b32 v8, 5, v8
    s_lshl_b32 s33, s3, 2
    v_add3_u32 v35, v35, v8, s33
    ds_write_b32 v35, v34 offset:30976
    s_waitcnt lgkmcnt(0)
    s_barrier
    ds_read_b128 v[54:57], v8 offset:30976
    ds_read_b128 v[58:61], v8 offset:30992
    ds_read_b128 v[62:65], v8 offset:31232
    ds_read_b128 v[66:69], v8 offset:31248
    s_waitcnt lgkmcnt(0)
    v_pk_add_f32 v[54:55], v[54:55], v[56:57]
    v_pk_add_f32 v[58:59], v[58:59], v[60:61]
    v_pk_add_f32 v[62:63], v[62:63], v[64:65]
    v_pk_add_f32 v[66:67], v[66:67], v[68:69]
    v_pk_add_f32 v[54:55], v[54:55], v[58:59]
    v_pk_add_f32 v[62:63], v[62:63], v[66:67]
    v_add_f32 v54, v54, v55
    v_add_f32 v62, v62, v63
    v_mul_f32 v54, 0x3b000000, v54
    v_mul_f32 v62, 0x3b000000, v62
    v_fma_f32 v62, -v54, v54, v62
    v_max_f32 v62, 0, v62
    v_cvt_pk_bf16_f32 v62, v62, v54
    v_and_b32 v54, 0xffff0000, v62
    v_lshlrev_b32 v62, 16, v62
    v_add_f32 v62, 0x3727c5ac, v62
    v_cvt_pk_bf16_f32 v62, v62, v62
    v_lshlrev_b32 v62, 16, v62
    v_sqrt_f32 v62, v62
    s_nop 0
    v_cvt_pk_bf16_f32 v62, v62, v62
    v_lshlrev_b32 v62, 16, v62
    v_rcp_f32 v34, v62
    s_nop 0
    v_mul_f32 v35, -v54, v34
    v_fma_f32 v26, v26, v34, v35
    v_fma_f32 v27, v27, v34, v35
    v_fma_f32 v28, v28, v34, v35
    v_fma_f32 v29, v29, v34, v35
    v_fma_f32 v30, v30, v34, v35
    v_fma_f32 v31, v31, v34, v35
    v_fma_f32 v32, v32, v34, v35
    v_fma_f32 v33, v33, v34, v35
    v_pk_fma_f32 v[26:27], v[26:27], v[70:71], v[78:79]
    v_pk_fma_f32 v[28:29], v[28:29], v[72:73], v[80:81]
    v_pk_fma_f32 v[30:31], v[30:31], v[74:75], v[82:83]
    v_pk_fma_f32 v[32:33], v[32:33], v[76:77], v[84:85]
    v_cvt_pk_bf16_f32 v54, v26, v27
    v_cvt_pk_bf16_f32 v55, v28, v29
    v_cvt_pk_bf16_f32 v56, v30, v31
    v_cvt_pk_bf16_f32 v57, v32, v33
    buffer_store_dwordx4 v[54:57], v2, s[8:11], s35 offen sc1
    s_cmp_lt_u32 s3, 4
    s_cbranch_scc1 .ffn_fused_kernel_3
    s_lshr_b32 s40, s2, 4
    s_min_u32 s40, s40, 13
    s_lshl_b32 s40, s40, 8
    s_and_b32 s44, s3, 3
    s_mul_i32 s41, s44, 57344
    s_add_u32 s40, s40, s41
    s_lshl_b32 s44, s44, 11
    s_add_u32 m0, s44, 32768
    s_add_u32 s41, s40, 458880
    buffer_load_dwordx4 v108, s[48:51], s41 offen offset:0 lds
    s_add_u32 m0, s44, 32768
    s_add_u32 s41, s40, 486528
    buffer_load_dwordx4 v108, s[48:51], s41 offen offset:1024 lds
    s_add_u32 m0, s44, 40960
    s_add_u32 s41, s40, 688256
    buffer_load_dwordx4 v108, s[48:51], s41 offen offset:0 lds
    s_add_u32 m0, s44, 40960
    s_add_u32 s41, s40, 715904
    buffer_load_dwordx4 v108, s[48:51], s41 offen offset:1024 lds
    s_add_u32 m0, s44, 57344
    s_add_u32 s41, s40, 1147008
    buffer_load_dwordx4 v108, s[48:51], s41 offen offset:0 lds
    s_add_u32 m0, s44, 57344
    s_add_u32 s41, s40, 1174656
    buffer_load_dwordx4 v108, s[48:51], s41 offen offset:1024 lds
    s_add_u32 m0, s44, 65536
    s_add_u32 s41, s40, 1376384
    buffer_load_dwordx4 v108, s[48:51], s41 offen offset:0 lds
    s_add_u32 m0, s44, 65536
    s_add_u32 s41, s40, 1404032
    buffer_load_dwordx4 v108, s[48:51], s41 offen offset:1024 lds
    s_movk_i32 s43, -2560
    v_lshrrev_b32 v90, 3, v0
    v_mad_i32_i24 v90, v90, s43, v108
    s_bfe_u32 s42, s3, 0x10001
    s_lshl_b32 s42, s42, 3
    s_and_b32 s43, s3, 1
    s_add_u32 s42, s42, s43
    s_lshl_b32 s42, s42, 14
    s_lshr_b32 s43, s2, 5
    s_lshl_b32 s43, s43, 7
    s_add_u32 s42, s42, s43
    s_add_u32 s41, s42, 589824
    buffer_load_dwordx4 a[0:3], v90, s[52:55], s41 offen
    s_add_u32 s41, s42, 598016
    buffer_load_dwordx4 a[4:7], v90, s[52:55], s41 offen
    s_add_u32 s41, s42, 851968
    buffer_load_dwordx4 a[8:11], v90, s[52:55], s41 offen
    s_add_u32 s41, s42, 860160
    buffer_load_dwordx4 a[12:15], v90, s[52:55], s41 offen
    s_add_u32 s41, s42, 1114112
    buffer_load_dwordx4 a[16:19], v90, s[52:55], s41 offen
    s_add_u32 s41, s42, 1122304
    buffer_load_dwordx4 a[20:23], v90, s[52:55], s41 offen
    s_add_u32 s41, s42, 1376256
    buffer_load_dwordx4 a[24:27], v90, s[52:55], s41 offen
    s_add_u32 s41, s42, 1384448
    buffer_load_dwordx4 a[28:31], v90, s[52:55], s41 offen
    s_add_u32 s41, s42, 1638400
    buffer_load_dwordx4 a[64:67], v90, s[52:55], s41 offen
    s_add_u32 s41, s42, 1646592
    buffer_load_dwordx4 a[68:71], v90, s[52:55], s41 offen
    s_add_u32 s41, s42, 98304
    buffer_load_dwordx4 a[72:75], v90, s[52:55], s41 offen
    s_add_u32 s41, s42, 106496
    buffer_load_dwordx4 a[76:79], v90, s[52:55], s41 offen
    s_add_u32 s41, s42, 360448
    buffer_load_dwordx4 a[80:83], v90, s[52:55], s41 offen
    s_add_u32 s41, s42, 368640
    buffer_load_dwordx4 a[84:87], v90, s[52:55], s41 offen
    s_waitcnt vmcnt(0)
    s_branch .ffn_fused_kernel_3
.w7_fused_kernel_102:
    buffer_load_dwordx4 a[32:35], v1, s[8:11], s17 offen offset:0 sc1
    buffer_load_dwordx4 a[36:39], v1, s[8:11], s17 offen offset:1024 sc1
    buffer_load_dwordx4 a[40:43], v1, s[8:11], s17 offen offset:2048 sc1
    buffer_load_dwordx4 a[44:47], v1, s[8:11], s17 offen offset:3072 sc1
    buffer_load_dwordx4 a[48:51], v1, s[8:11], s18 offen offset:0 sc1
    buffer_load_dwordx4 a[52:55], v1, s[8:11], s18 offen offset:1024 sc1
    buffer_load_dwordx4 a[56:59], v1, s[8:11], s18 offen offset:2048 sc1
    buffer_load_dwordx4 a[60:63], v1, s[8:11], s18 offen offset:3072 sc1
    s_branch .w7r_fused_kernel_104
.w7_fused_kernel_103:
    buffer_load_dwordx4 a[32:35], v1, s[8:11], s17 offen offset:0 sc1
    buffer_load_dwordx4 a[36:39], v1, s[8:11], s17 offen offset:1024 sc1
    buffer_load_dwordx4 a[40:43], v1, s[8:11], s17 offen offset:2048 sc1
    buffer_load_dwordx4 a[44:47], v1, s[8:11], s17 offen offset:3072 sc1
    buffer_load_dwordx4 a[48:51], v1, s[8:11], s18 offen offset:0 sc1
    buffer_load_dwordx4 a[52:55], v1, s[8:11], s18 offen offset:1024 sc1
    buffer_load_dwordx4 a[56:59], v1, s[8:11], s18 offen offset:2048 sc1
    buffer_load_dwordx4 a[60:63], v1, s[8:11], s18 offen offset:3072 sc1
    s_branch .w7r_fused_kernel_105
code_end_label:
.section .rodata,"a"
.p2align 6
.amdhsa_kernel fused_kernel
  .amdhsa_next_free_vgpr 256
  .amdhsa_next_free_sgpr 102
  .amdhsa_accum_offset 112
  .amdhsa_group_segment_fixed_size 0
  .amdhsa_kernarg_size 104
  .amdhsa_user_sgpr_count 2
  .amdhsa_user_sgpr_kernarg_segment_ptr 1
  .amdhsa_system_sgpr_workgroup_id_x 1
.end_amdhsa_kernel
```
